```python
import torch

def _softmax(x, axis=-1):
    return torch.softmax(x, dim=axis)
def _gelu(x):
    return torch.nn.functional.gelu(x, approximate="tanh")
def _silu(x):
    return torch.nn.functional.silu(x)
def _sigmoid(x):
    return torch.sigmoid(x)
def _layernorm(x, axis=-1, eps=1e-5):
    m = x.mean(dim=axis, keepdim=True)
    v = x.var(dim=axis, keepdim=True, unbiased=False)
    return (x - m) / torch.sqrt(v + eps)
def _scatter_add(tgt, idx, src, axis=0):
    return tgt.clone().index_add_(axis, idx, src)
def _segment_sum(src, seg, n):
    out = torch.zeros((n,) + src.shape[1:], dtype=src.dtype)
    return out.index_add_(0, seg, src)
def _pad(x, pw):
    flat = tuple(v for pair in reversed(pw) for v in pair)
    return torch.nn.functional.pad(x, flat)

kernel_name = 'recurrent_scan__sliding_block__moe_arch_mod__prompt'

def setup_inputs():

    _w = (lambda a: (lambda t: t.to(torch.bfloat16) if t.is_floating_point() else t)(torch.as_tensor(a)))
    def _A_setup():
        B, S, D = 1, 2048, 512
        return {
            "x": _w((lambda *s: torch.randn(*s, dtype=torch.bfloat16) * 0.05)(B, S, D)),
            "wqkv": _w((lambda *s: torch.randn(*s, dtype=torch.bfloat16) * 0.05)(D, 3 * D)),
            "wo": _w((lambda *s: torch.randn(*s, dtype=torch.bfloat16) * 0.05)(D, D)),
        }
    _A_in = _A_setup()

    def _B_setup():
        B, S, D, F, C = 1, 2048, 512, 1792, 8
        return {
            "x": _w((lambda *s: torch.randn(*s, dtype=torch.bfloat16) * 0.05)(B, S, D)),
            "w_r": _w((lambda *s: torch.randn(*s, dtype=torch.bfloat16) * 0.05)(D)),
            "w_gate": _w((lambda *s: torch.randn(*s, dtype=torch.bfloat16) * 0.05)(D, F)),
            "w_up": _w((lambda *s: torch.randn(*s, dtype=torch.bfloat16) * 0.05)(D, F)),
            "w_down": _w((lambda *s: torch.randn(*s, dtype=torch.bfloat16) * 0.05)(F, D)),
        }
    _B_in = _B_setup()

    return {
        "A_x": _A_in["x"],
        "A_wqkv": _A_in["wqkv"],
        "A_wo": _A_in["wo"],
        "B_x": _B_in["x"],
        "B_w_r": _B_in["w_r"],
        "B_w_gate": _B_in["w_gate"],
        "B_w_up": _B_in["w_up"],
        "B_w_down": _B_in["w_down"],
    }

def reference(A_x, A_wqkv, A_wo, B_x, B_w_r, B_w_gate, B_w_up, B_w_down):
    def _A_ref(x, wqkv, wo):
        B, S, D = x.shape
        H = 32; Dh = D // H; W = 256
        qkv = (lambda x, *d: x.permute(*d))((x @ wqkv).reshape(B, S, 3, H, Dh), 2, 0, 3, 1, 4)
        q, k, v = qkv[0], qkv[1], qkv[2]
        scores = torch.einsum("bhqd,bhkd->bhqk", q, k) * (Dh ** -0.5)
        idx = torch.arange(S)
        mask = (idx[:, None] - idx[None, :] >= 0) & (idx[:, None] - idx[None, :] < W)
        scores = torch.where(mask[None, None], scores, -1e9)
        p = _softmax(scores, axis=-1)
        o = torch.einsum("bhqk,bhkd->bhqd", p, v)
        return (lambda x, *d: x.permute(*d))(o, 0, 2, 1, 3).reshape(B, S, D) @ wo

    def _B_ref(x, w_r, w_gate, w_up, w_down):
        B, S, D = x.shape
        C = 8
        r = x @ w_r
        idx = torch.argsort(-r, axis=-1)[:, :C]
        idx_e = (lambda x, n, axis: torch.repeat_interleave(x, n, dim=axis))(idx.reshape(B, C, 1), D, axis=2)
        x_sel = (lambda x, i, axis: torch.take_along_dim(x, i, dim=axis))(x, idx_e, axis=1)
        g = _silu(x_sel @ w_gate)
        u = x_sel @ w_up
        y = (g * u) @ w_down
        r_sel = _sigmoid((lambda x, i, axis: torch.take_along_dim(x, i, dim=axis))(r, idx, axis=1))
        y = y * r_sel.reshape(B, C, 1)
        b_off = (torch.arange(B) * S).reshape(B, 1)
        flat_idx = (idx + b_off).reshape(B * C)
        zero = (x * 0.0).reshape(B * S, D)
        upd = _scatter_add(zero, flat_idx, y.reshape(B * C, D), axis=0)
        return x + upd.reshape(B, S, D)

    x = A_x
    xn = _layernorm(x, axis=-1)
    s = _A_ref(xn, A_wqkv, A_wo)
    g = _silu(_B_ref(xn, B_w_r, B_w_gate, B_w_up, B_w_down))
    return x + s * g
```

```asm
; @launch grid=(256,1,1) block=(512,1,1) lds=163840
.amdgcn_target "amdgcn-amd-amdhsa--gfx950"
.text
.globl recurrent_scan__sliding_block__moe_arch_mod__prompt_kernel
.p2align 8
.type recurrent_scan__sliding_block__moe_arch_mod__prompt_kernel,@function
recurrent_scan__sliding_block__moe_arch_mod__prompt_kernel:
    s_cmp_ge_u32 s2, 256
    s_cbranch_scc1 L_end
    v_lshrrev_b32 v3, 6, v0
    v_and_b32 v1, 63, v0
    v_mov_b32 v2, 148480
    v_readfirstlane_b32 s3, v3
    s_load_dwordx16 s[4:19], s[0:1], 0
    s_load_dwordx4 s[20:23], s[0:1], 64
    s_load_dwordx2 s[24:25], s[0:1], 80
    s_cmp_eq_u32 s3, 7
    s_cbranch_scc0 L_kc
    s_getpc_b64 s[28:29]
L_pc:
    s_sub_u32 s28, s28, L_pc-recurrent_scan__sliding_block__moe_arch_mod__prompt_kernel
    s_subb_u32 s29, s29, 0
    s_and_b32 s29, s29, 0xffff
    s_mov_b32 s30, L_end+4-recurrent_scan__sliding_block__moe_arch_mod__prompt_kernel
    s_mov_b32 s31, 0x00020000
    s_lshr_b32 s68, s2, 3
    s_lshl_b32 s68, s68, 11
    v_lshlrev_b32 v3, 5, v1
    buffer_load_dword v255, v3, s[28:31], s68 offen
L_kc:
    s_cmp_eq_u32 s3, 0
    s_cbranch_scc0 L_ka
    v_lshl_add_u32 v3, v1, 4, v2
    v_mov_b32 v4, 0
    v_mov_b32 v5, 0
    v_mov_b32 v6, 0
    v_mov_b32 v7, 0
    ds_write_b128 v3, v[4:7]
    ds_write_b128 v3, v[4:7] offset:1024
    v_and_b32 v3, 3, v1
    v_lshl_add_u32 v3, v3, 9, v2
    v_mov_b32 v8, 0x3f803f80
    v_mov_b32 v9, 0x3f803f80
    v_mov_b32 v10, 0x3f803f80
    v_mov_b32 v11, 0x3f803f80
    ds_write_b128 v3, v[8:11] offset:2048
L_ka:
    s_cmp_eq_u32 s3, 1
    s_cbranch_scc0 L_kb
    v_lshrrev_b32 v3, 4, v1
    v_and_b32 v4, 15, v1
    v_lshl_add_u32 v5, v3, 9, v2
    v_lshl_add_u32 v5, v4, 4, v5
    v_lshl_add_u32 v3, v4, 2, v3
    v_mov_b32 v4, 0xf149f2ca
    v_cmp_le_u32 vcc, 32, v3
    v_cmp_le_u32 s[72:73], 31, v3
    v_cmp_le_u32 s[74:75], 30, v3
    v_cmp_le_u32 s[76:77], 29, v3
    v_cndmask_b32 v8, 0, v4, vcc
    v_cndmask_b32_e64 v9, 0, v4, s[72:73]
    v_cndmask_b32_e64 v10, 0, v4, s[74:75]
    v_cndmask_b32_e64 v11, 0, v4, s[76:77]
    ds_write_b128 v5, v[8:11] offset:2064
    v_sub_f32 v8, v4, v8
    v_sub_f32 v9, v4, v9
    v_sub_f32 v10, v4, v10
    v_sub_f32 v11, v4, v11
    s_mov_b32 exec_lo, 0xff80ff80
    s_mov_b32 exec_hi, 0xff80ff80
    ds_write_b128 v5, v[8:11] offset:2192
    s_mov_b64 exec, -1
L_kb:
    s_and_b32 s68, s2, 7
    s_lshr_b32 s69, s2, 3
    s_and_b32 s27, s68, 1
    s_lshl_b32 s27, s27, 2
    s_and_b32 s70, s69, 3
    s_or_b32 s27, s27, s70
    s_lshr_b32 s26, s68, 1
    s_lshl_b32 s26, s26, 3
    s_lshr_b32 s70, s69, 2
    s_or_b32 s26, s26, s70
    s_and_b32 s70, s70, 3
    s_sub_u32 s64, s27, s70
    s_and_b32 s64, s64, 7
    s_mov_b32 s66, 0x3f803f80
    s_cmp_lt_u32 s3, 4
    s_cbranch_scc1 L_main
    s_branch L_loader
L_loader:
    s_sub_u32 s70, s3, 4
    v_lshrrev_b32 v3, 3, v1
    v_lshrrev_b32 v4, 4, v1
    v_and_b32 v5, 7, v1
    v_xor_b32 v6, v5, v4
    v_lshlrev_b32 v6, 4, v6
    v_lshl_add_u32 v6, v3, 10, v6
    s_lshl_b32 s68, s70, 14
    v_add_u32 v10, s68, v6
    v_xor_b32 v11, 64, v10
    v_add_u32 v11, 7168, v11
    s_lshl_b32 s69, s26, 16
    s_add_u32 s75, s64, 0
    s_and_b32 s75, s75, 7
    s_mul_i32 s36, s75, 196608
    s_lshl_b32 s75, s75, 7
    s_add_u32 s52, s75, s69
    v_bfe_u32 v6, v1, 2, 2
    v_xor_b32 v6, v6, v4
    v_lshrrev_b32 v7, 1, v6
    v_add_u32 v7, 1, v7
    v_lshlrev_b32 v7, 10, v7
    v_and_b32 v6, 1, v6
    v_lshl_add_u32 v7, v6, 6, v7
    v_and_b32 v6, 3, v1
    v_lshl_add_u32 v7, v6, 4, v7
    v_mul_u32_u24 v8, 3072, v4
    s_add_u32 s68, s27, 0
    s_and_b32 s68, s68, 7
    s_lshl_b32 s68, s68, 7
    s_mul_i32 s78, s70, 24576
    s_add_u32 s78, s78, s68
    v_add3_u32 v12, v7, v8, s78
    v_add_u32 v13, 11264, v12
    v_add_u32 v14, 98304, v12
    v_add_u32 v15, 98304, v13
    s_lshl_b32 s71, s70, 11
    s_add_u32 s72, s71, 65536
    s_waitcnt lgkmcnt(0)
    s_mov_b32 s28, s4
    s_and_b32 s29, s5, 0xffff
    s_mov_b32 s30, 2097152
    s_mov_b32 s31, 0x00020000
    s_mov_b32 s32, s6
    s_and_b32 s33, s7, 0xffff
    s_mov_b32 s34, 1572864
    s_mov_b32 s35, 0x00020000
    s_cmp_ge_u32 s70, 2
    s_cbranch_scc1 L_loader2
    s_add_u32 m0, s71, 0
    s_nop 0
    buffer_load_dwordx4 v10, s[28:31], s52 offen offset:0 lds
    buffer_load_dwordx4 v11, s[28:31], s52 offen offset:1024 lds
    s_add_u32 m0, s72, 0
    s_nop 0
    buffer_load_dwordx4 v12, s[32:35], s36 offen offset:0 lds
    buffer_load_dwordx4 v13, s[32:35], s36 offen offset:1024 lds
    s_add_u32 m0, s72, 8192
    s_nop 0
    buffer_load_dwordx4 v14, s[32:35], s36 offen offset:0 lds
    buffer_load_dwordx4 v15, s[32:35], s36 offen offset:1024 lds
    v_bfe_u32 v7, v1, 2, 1
    v_and_b32 v8, 1, v4
    v_xor_b32 v7, v7, v8
    v_lshlrev_b32 v7, 6, v7
    v_lshl_add_u32 v7, v6, 4, v7
    v_add_u32 v7, s68, v7
    v_mul_u32_u24 v8, 3072, v3
    s_mul_i32 s78, s70, 98304
    v_add3_u32 v16, v7, v8, s78
    v_add_u32 v17, 23552, v16
    v_add_u32 v18, 47104, v16
    v_add_u32 v19, 70656, v16
    v_lshl_add_u32 v20, v3, 10, v7
    s_lshl_b32 s73, s70, 12
    s_add_u32 s73, s73, 65536
    s_add_u32 s75, s64, 1
    s_and_b32 s75, s75, 7
    s_mul_i32 s37, s75, 196608
    s_lshl_b32 s75, s75, 7
    s_add_u32 s53, s75, s69
    s_add_u32 m0, s71, 8192
    s_nop 0
    buffer_load_dwordx4 v10, s[28:31], s53 offen offset:0 lds
    buffer_load_dwordx4 v11, s[28:31], s53 offen offset:1024 lds
    s_add_u32 m0, s72, 16384
    s_nop 0
    buffer_load_dwordx4 v12, s[32:35], s37 offen offset:0 lds
    buffer_load_dwordx4 v13, s[32:35], s37 offen offset:1024 lds
    s_add_u32 m0, s72, 24576
    s_nop 0
    buffer_load_dwordx4 v14, s[32:35], s37 offen offset:0 lds
    buffer_load_dwordx4 v15, s[32:35], s37 offen offset:1024 lds
    s_mov_b32 s40, s24
    s_and_b32 s41, s25, 0xffff
    s_mov_b32 s42, 25165824
    s_mov_b32 s43, 0x00020000
    s_lshl_b32 s79, s70, 2
    v_add_u32 v23, s79, v2
    v_bfe_u32 v31, v1, 2, 2
    v_lshl_add_u32 v21, v4, 3, v31
    v_xor_b32 v22, s70, v31
    v_lshlrev_b32 v22, 6, v22
    v_lshl_add_u32 v22, v6, 3, v22
    v_lshl_add_u32 v22, v21, 8, v22
    v_add_u32 v24, 65536, v22
    v_add_u32 v25, 131072, v22
    s_lshl_b32 s78, s70, 8
    v_lshl_add_u32 v30, v1, 3, v2
    v_add_u32 v30, s78, v30
    v_mov_b32 v48, s66
    v_mov_b32 v49, s66
    v_mov_b32 v50, s66
    v_mov_b32 v51, s66
    s_waitcnt vmcnt(8)
    s_barrier
    s_add_u32 s75, s64, 2
    s_and_b32 s75, s75, 7
    s_mul_i32 s38, s75, 196608
    s_lshl_b32 s75, s75, 7
    s_add_u32 s54, s75, s69
    s_add_u32 m0, s71, 16384
    s_nop 0
    buffer_load_dwordx4 v10, s[28:31], s54 offen offset:0 lds
    buffer_load_dwordx4 v11, s[28:31], s54 offen offset:1024 lds
    s_add_u32 m0, s72, 32768
    s_nop 0
    buffer_load_dwordx4 v12, s[32:35], s38 offen offset:0 lds
    buffer_load_dwordx4 v13, s[32:35], s38 offen offset:1024 lds
    ds_read_b64_tr_b16 v[52:53], v24 offset:0
    ds_read_b64_tr_b16 v[54:55], v24 offset:1024
    ds_read_b64_tr_b16 v[56:57], v24 offset:32
    ds_read_b64_tr_b16 v[58:59], v24 offset:1056
    s_waitcnt vmcnt(10)
    s_barrier
    s_add_u32 m0, s72, 40960
    s_nop 0
    buffer_load_dwordx4 v14, s[32:35], s38 offen offset:0 lds
    buffer_load_dwordx4 v15, s[32:35], s38 offen offset:1024 lds
    s_waitcnt lgkmcnt(0)
    v_mfma_f32_16x16x32_bf16 v[32:35], v[48:51], v[52:55], 0
    v_mfma_f32_16x16x32_bf16 v[36:39], v[48:51], v[56:59], 0
    ds_read_b64_tr_b16 v[60:61], v24 offset:8192
    ds_read_b64_tr_b16 v[62:63], v24 offset:9216
    ds_read_b64_tr_b16 v[64:65], v24 offset:8224
    ds_read_b64_tr_b16 v[66:67], v24 offset:9248
    s_waitcnt vmcnt(8)
    s_barrier
    s_add_u32 s75, s64, 3
    s_and_b32 s75, s75, 7
    s_mul_i32 s39, s75, 196608
    s_lshl_b32 s75, s75, 7
    s_add_u32 s55, s75, s69
    s_add_u32 m0, s71, 24576
    s_nop 0
    buffer_load_dwordx4 v10, s[28:31], s55 offen offset:0 lds
    buffer_load_dwordx4 v11, s[28:31], s55 offen offset:1024 lds
    s_add_u32 m0, s72, 49152
    s_nop 0
    buffer_load_dwordx4 v12, s[32:35], s39 offen offset:0 lds
    buffer_load_dwordx4 v13, s[32:35], s39 offen offset:1024 lds
    s_waitcnt lgkmcnt(0)
    v_mfma_f32_16x16x32_bf16 v[32:35], v[48:51], v[60:63], v[32:35]
    v_mfma_f32_16x16x32_bf16 v[36:39], v[48:51], v[64:67], v[36:39]
    ds_read_b64_tr_b16 v[52:53], v24 offset:16384
    ds_read_b64_tr_b16 v[54:55], v24 offset:17408
    ds_read_b64_tr_b16 v[56:57], v24 offset:16416
    ds_read_b64_tr_b16 v[58:59], v24 offset:17440
    s_waitcnt vmcnt(10)
    s_barrier
    s_add_u32 m0, s72, 57344
    s_nop 0
    buffer_load_dwordx4 v14, s[32:35], s39 offen offset:0 lds
    buffer_load_dwordx4 v15, s[32:35], s39 offen offset:1024 lds
    s_waitcnt lgkmcnt(0)
    v_mfma_f32_16x16x32_bf16 v[32:35], v[48:51], v[52:55], v[32:35]
    v_mfma_f32_16x16x32_bf16 v[36:39], v[48:51], v[56:59], v[36:39]
    ds_read_b64_tr_b16 v[60:61], v24 offset:24576
    ds_read_b64_tr_b16 v[62:63], v24 offset:25600
    ds_read_b64_tr_b16 v[64:65], v24 offset:24608
    ds_read_b64_tr_b16 v[66:67], v24 offset:25632
    s_waitcnt vmcnt(8)
    s_barrier
    s_add_u32 s75, s64, 4
    s_and_b32 s75, s75, 7
    s_mul_i32 s44, s75, 196608
    s_lshl_b32 s75, s75, 7
    s_add_u32 s56, s75, s69
    s_add_u32 m0, s71, 32768
    s_nop 0
    buffer_load_dwordx4 v10, s[28:31], s56 offen offset:0 lds
    buffer_load_dwordx4 v11, s[28:31], s56 offen offset:1024 lds
    s_add_u32 m0, s72, 65536
    s_nop 0
    buffer_load_dwordx4 v12, s[32:35], s44 offen offset:0 lds
    buffer_load_dwordx4 v13, s[32:35], s44 offen offset:1024 lds
    s_waitcnt lgkmcnt(0)
    v_mfma_f32_16x16x32_bf16 v[32:35], v[48:51], v[60:63], v[32:35]
    v_mfma_f32_16x16x32_bf16 v[36:39], v[48:51], v[64:67], v[36:39]
    ds_read_b64_tr_b16 v[52:53], v24 offset:32768
    ds_read_b64_tr_b16 v[54:55], v24 offset:33792
    ds_read_b64_tr_b16 v[56:57], v24 offset:32800
    ds_read_b64_tr_b16 v[58:59], v24 offset:33824
    s_waitcnt vmcnt(10)
    s_barrier
    s_add_u32 m0, s72, 73728
    s_nop 0
    buffer_load_dwordx4 v14, s[32:35], s44 offen offset:0 lds
    buffer_load_dwordx4 v15, s[32:35], s44 offen offset:1024 lds
    s_waitcnt lgkmcnt(0)
    v_mfma_f32_16x16x32_bf16 v[32:35], v[48:51], v[52:55], v[32:35]
    v_mfma_f32_16x16x32_bf16 v[36:39], v[48:51], v[56:59], v[36:39]
    ds_read_b64_tr_b16 v[60:61], v24 offset:40960
    ds_read_b64_tr_b16 v[62:63], v24 offset:41984
    ds_read_b64_tr_b16 v[64:65], v24 offset:40992
    ds_read_b64_tr_b16 v[66:67], v24 offset:42016
    s_waitcnt vmcnt(8)
    s_barrier
    s_add_u32 s75, s64, 5
    s_and_b32 s75, s75, 7
    s_mul_i32 s45, s75, 196608
    s_lshl_b32 s75, s75, 7
    s_add_u32 s57, s75, s69
    s_add_u32 m0, s71, 40960
    s_nop 0
    buffer_load_dwordx4 v10, s[28:31], s57 offen offset:0 lds
    buffer_load_dwordx4 v11, s[28:31], s57 offen offset:1024 lds
    s_add_u32 m0, s72, 0
    s_nop 0
    buffer_load_dwordx4 v12, s[32:35], s45 offen offset:0 lds
    buffer_load_dwordx4 v13, s[32:35], s45 offen offset:1024 lds
    s_waitcnt lgkmcnt(0)
    v_mfma_f32_16x16x32_bf16 v[32:35], v[48:51], v[60:63], v[32:35]
    v_mfma_f32_16x16x32_bf16 v[36:39], v[48:51], v[64:67], v[36:39]
    ds_read_b64_tr_b16 v[52:53], v24 offset:49152
    ds_read_b64_tr_b16 v[54:55], v24 offset:50176
    ds_read_b64_tr_b16 v[56:57], v24 offset:49184
    ds_read_b64_tr_b16 v[58:59], v24 offset:50208
    s_waitcnt vmcnt(10)
    s_barrier
    s_add_u32 m0, s72, 8192
    s_nop 0
    buffer_load_dwordx4 v14, s[32:35], s45 offen offset:0 lds
    buffer_load_dwordx4 v15, s[32:35], s45 offen offset:1024 lds
    s_waitcnt lgkmcnt(0)
    v_mfma_f32_16x16x32_bf16 v[32:35], v[48:51], v[52:55], v[32:35]
    v_mfma_f32_16x16x32_bf16 v[36:39], v[48:51], v[56:59], v[36:39]
    ds_read_b64_tr_b16 v[60:61], v24 offset:57344
    ds_read_b64_tr_b16 v[62:63], v24 offset:58368
    ds_read_b64_tr_b16 v[64:65], v24 offset:57376
    ds_read_b64_tr_b16 v[66:67], v24 offset:58400
    s_waitcnt vmcnt(8)
    s_barrier
    s_add_u32 s75, s64, 6
    s_and_b32 s75, s75, 7
    s_mul_i32 s46, s75, 196608
    s_lshl_b32 s75, s75, 7
    s_add_u32 s58, s75, s69
    s_add_u32 m0, s71, 49152
    s_nop 0
    buffer_load_dwordx4 v10, s[28:31], s58 offen offset:0 lds
    buffer_load_dwordx4 v11, s[28:31], s58 offen offset:1024 lds
    s_add_u32 m0, s72, 16384
    s_nop 0
    buffer_load_dwordx4 v12, s[32:35], s46 offen offset:0 lds
    buffer_load_dwordx4 v13, s[32:35], s46 offen offset:1024 lds
    s_waitcnt lgkmcnt(0)
    v_mfma_f32_16x16x32_bf16 v[32:35], v[48:51], v[60:63], v[32:35]
    v_mfma_f32_16x16x32_bf16 v[36:39], v[48:51], v[64:67], v[36:39]
    ds_read_b64_tr_b16 v[52:53], v25 offset:0
    ds_read_b64_tr_b16 v[54:55], v25 offset:1024
    ds_read_b64_tr_b16 v[56:57], v25 offset:32
    ds_read_b64_tr_b16 v[58:59], v25 offset:1056
    s_waitcnt vmcnt(10)
    s_barrier
    s_add_u32 m0, s72, 24576
    s_nop 0
    buffer_load_dwordx4 v14, s[32:35], s46 offen offset:0 lds
    buffer_load_dwordx4 v15, s[32:35], s46 offen offset:1024 lds
    s_add_u32 s75, s64, 7
    s_and_b32 s75, s75, 7
    s_mul_i32 s47, s75, 196608
    s_lshl_b32 s75, s75, 7
    s_add_u32 s59, s75, s69
    s_add_u32 m0, s71, 57344
    s_nop 0
    buffer_load_dwordx4 v10, s[28:31], s59 offen offset:0 lds
    buffer_load_dwordx4 v11, s[28:31], s59 offen offset:1024 lds
    s_add_u32 m0, s72, 32768
    s_nop 0
    buffer_load_dwordx4 v12, s[32:35], s47 offen offset:0 lds
    buffer_load_dwordx4 v13, s[32:35], s47 offen offset:1024 lds
    s_waitcnt lgkmcnt(0)
    v_mfma_f32_16x16x32_bf16 v[32:35], v[48:51], v[52:55], v[32:35]
    v_mfma_f32_16x16x32_bf16 v[36:39], v[48:51], v[56:59], v[36:39]
    ds_read_b64_tr_b16 v[60:61], v25 offset:8192
    ds_read_b64_tr_b16 v[62:63], v25 offset:9216
    ds_read_b64_tr_b16 v[64:65], v25 offset:8224
    ds_read_b64_tr_b16 v[66:67], v25 offset:9248
    s_waitcnt vmcnt(12)
    s_barrier
    s_add_u32 m0, s72, 40960
    s_nop 0
    buffer_load_dwordx4 v14, s[32:35], s47 offen offset:0 lds
    buffer_load_dwordx4 v15, s[32:35], s47 offen offset:1024 lds
    s_add_u32 m0, s73, 49152
    s_nop 0
    buffer_load_dwordx4 v16, s[32:35], s36 offen offset:0 lds
    buffer_load_dwordx4 v17, s[32:35], s36 offen offset:1024 lds
    buffer_load_dwordx4 v18, s[32:35], s36 offen offset:2048 lds
    buffer_load_dwordx4 v19, s[32:35], s36 offen offset:3072 lds
    s_waitcnt lgkmcnt(0)
    v_mfma_f32_16x16x32_bf16 v[32:35], v[48:51], v[60:63], v[32:35]
    v_mfma_f32_16x16x32_bf16 v[36:39], v[48:51], v[64:67], v[36:39]
    ds_read_b64_tr_b16 v[52:53], v24 offset:0
    ds_read_b64_tr_b16 v[54:55], v24 offset:1024
    ds_read_b64_tr_b16 v[56:57], v24 offset:32
    ds_read_b64_tr_b16 v[58:59], v24 offset:1056
    s_waitcnt vmcnt(16)
    s_barrier
    s_add_u32 m0, s73, 57344
    s_nop 0
    buffer_load_dwordx4 v16, s[32:35], s37 offen offset:0 lds
    buffer_load_dwordx4 v17, s[32:35], s37 offen offset:1024 lds
    buffer_load_dwordx4 v18, s[32:35], s37 offen offset:2048 lds
    buffer_load_dwordx4 v19, s[32:35], s37 offen offset:3072 lds
    s_waitcnt lgkmcnt(0)
    v_mfma_f32_16x16x32_bf16 v[32:35], v[48:51], v[52:55], v[32:35]
    v_mfma_f32_16x16x32_bf16 v[36:39], v[48:51], v[56:59], v[36:39]
    ds_read_b64_tr_b16 v[60:61], v24 offset:8192
    ds_read_b64_tr_b16 v[62:63], v24 offset:9216
    ds_read_b64_tr_b16 v[64:65], v24 offset:8224
    ds_read_b64_tr_b16 v[66:67], v24 offset:9248
    s_waitcnt vmcnt(16)
    s_barrier
    s_add_u32 m0, s73, 65536
    s_nop 0
    buffer_load_dwordx4 v16, s[32:35], s38 offen offset:0 lds
    buffer_load_dwordx4 v17, s[32:35], s38 offen offset:1024 lds
    buffer_load_dwordx4 v18, s[32:35], s38 offen offset:2048 lds
    buffer_load_dwordx4 v19, s[32:35], s38 offen offset:3072 lds
    s_waitcnt lgkmcnt(0)
    v_mfma_f32_16x16x32_bf16 v[32:35], v[48:51], v[60:63], v[32:35]
    v_mfma_f32_16x16x32_bf16 v[36:39], v[48:51], v[64:67], v[36:39]
    ds_read_b64_tr_b16 v[52:53], v24 offset:16384
    ds_read_b64_tr_b16 v[54:55], v24 offset:17408
    ds_read_b64_tr_b16 v[56:57], v24 offset:16416
    ds_read_b64_tr_b16 v[58:59], v24 offset:17440
    s_waitcnt vmcnt(18)
    s_barrier
    s_add_u32 m0, s73, 73728
    s_nop 0
    buffer_load_dwordx4 v16, s[32:35], s39 offen offset:0 lds
    buffer_load_dwordx4 v17, s[32:35], s39 offen offset:1024 lds
    buffer_load_dwordx4 v18, s[32:35], s39 offen offset:2048 lds
    buffer_load_dwordx4 v19, s[32:35], s39 offen offset:3072 lds
    s_waitcnt lgkmcnt(0)
    v_mfma_f32_16x16x32_bf16 v[32:35], v[48:51], v[52:55], v[32:35]
    v_mfma_f32_16x16x32_bf16 v[36:39], v[48:51], v[56:59], v[36:39]
    ds_read_b64_tr_b16 v[60:61], v24 offset:24576
    ds_read_b64_tr_b16 v[62:63], v24 offset:25600
    ds_read_b64_tr_b16 v[64:65], v24 offset:24608
    ds_read_b64_tr_b16 v[66:67], v24 offset:25632
    s_waitcnt vmcnt(16)
    s_barrier
    ds_read_b64_tr_b16 v[52:53], v24 offset:32768
    ds_read_b64_tr_b16 v[54:55], v24 offset:33792
    ds_read_b64_tr_b16 v[56:57], v24 offset:32800
    ds_read_b64_tr_b16 v[58:59], v24 offset:33824
    s_waitcnt lgkmcnt(4)
    v_mfma_f32_16x16x32_bf16 v[32:35], v[48:51], v[60:63], v[32:35]
    v_mfma_f32_16x16x32_bf16 v[36:39], v[48:51], v[64:67], v[36:39]
    ds_read_b64_tr_b16 v[60:61], v24 offset:40960
    ds_read_b64_tr_b16 v[62:63], v24 offset:41984
    ds_read_b64_tr_b16 v[64:65], v24 offset:40992
    ds_read_b64_tr_b16 v[66:67], v24 offset:42016
    s_mov_b32 s78, 0xffff0000
    s_mov_b32 s79, 0
    v_mov_b32 v8, 1
    v_mov_b32 v41, 0
    s_waitcnt lgkmcnt(4)
    v_mfma_f32_16x16x32_bf16 v[32:35], v[48:51], v[52:55], v[32:35]
    v_mfma_f32_16x16x32_bf16 v[36:39], v[48:51], v[56:59], v[36:39]
    s_waitcnt lgkmcnt(0)
    v_mfma_f32_16x16x32_bf16 v[32:35], v[48:51], v[60:63], v[32:35]
    v_mfma_f32_16x16x32_bf16 v[36:39], v[48:51], v[64:67], v[36:39]
    s_waitcnt vmcnt(8)
    s_barrier
    s_mov_b32 exec_hi, 0
    s_nop 6
    v_cndmask_b32_e64 v40, v32, v36, s[78:79]
    v_cvt_pk_bf16_f32 v42, v40, v40
    v_lshlrev_b32 v42, 16, v42
    v_sub_f32 v42, v40, v42
    v_cvt_pk_bf16_f32 v40, v40, v42
    ds_write_b64 v30, v[40:41] offset:12288
    ds_write_b32 v23, v8 offset:16
    s_mov_b32 exec_hi, -1
    s_add_u32 m0, s73, 0
    s_nop 0
    buffer_load_dwordx4 v16, s[32:35], s44 offen offset:0 lds
    buffer_load_dwordx4 v17, s[32:35], s44 offen offset:1024 lds
    buffer_load_dwordx4 v18, s[32:35], s44 offen offset:2048 lds
    buffer_load_dwordx4 v19, s[32:35], s44 offen offset:3072 lds
    s_add_u32 m0, s73, 8192
    s_nop 0
    buffer_load_dwordx4 v16, s[32:35], s45 offen offset:0 lds
    buffer_load_dwordx4 v17, s[32:35], s45 offen offset:1024 lds
    buffer_load_dwordx4 v18, s[32:35], s45 offen offset:2048 lds
    buffer_load_dwordx4 v19, s[32:35], s45 offen offset:3072 lds
    s_add_u32 m0, s73, 16384
    s_nop 0
    buffer_load_dwordx4 v16, s[32:35], s46 offen offset:0 lds
    buffer_load_dwordx4 v17, s[32:35], s46 offen offset:1024 lds
    buffer_load_dwordx4 v18, s[32:35], s46 offen offset:2048 lds
    buffer_load_dwordx4 v19, s[32:35], s46 offen offset:3072 lds
    s_add_u32 m0, s73, 24576
    s_nop 0
    buffer_load_dwordx4 v16, s[32:35], s47 offen offset:0 lds
    buffer_load_dwordx4 v17, s[32:35], s47 offen offset:1024 lds
    buffer_load_dwordx4 v18, s[32:35], s47 offen offset:2048 lds
    buffer_load_dwordx4 v19, s[32:35], s47 offen offset:3072 lds
    v_lshrrev_b32 v22, 1, v31
    v_lshlrev_b32 v22, 6, v22
    v_lshl_add_u32 v22, v6, 3, v22
    v_lshl_add_u32 v22, v21, 7, v22
    v_add_u32 v26, s73, v22
    v_add_u32 v27, 0x10000, v26
    v_xor_b32 v28, 64, v26
    v_xor_b32 v29, 64, v27
    v_lshl_add_u32 v30, v1, 3, v23
    ds_read_b64_tr_b16 v[52:53], v26 offset:49152
    ds_read_b64_tr_b16 v[54:55], v26 offset:49664
    ds_read_b64_tr_b16 v[56:57], v26 offset:49184
    ds_read_b64_tr_b16 v[58:59], v26 offset:49696
    ds_read_b64_tr_b16 v[60:61], v28 offset:49152
    ds_read_b64_tr_b16 v[62:63], v28 offset:49664
    ds_read_b64_tr_b16 v[64:65], v28 offset:49184
    ds_read_b64_tr_b16 v[66:67], v28 offset:49696
    ds_read_b64_tr_b16 v[68:69], v26 offset:57344
    ds_read_b64_tr_b16 v[70:71], v26 offset:57856
    ds_read_b64_tr_b16 v[72:73], v26 offset:57376
    ds_read_b64_tr_b16 v[74:75], v26 offset:57888
    ds_read_b64_tr_b16 v[76:77], v28 offset:57344
    ds_read_b64_tr_b16 v[78:79], v28 offset:57856
    ds_read_b64_tr_b16 v[80:81], v28 offset:57376
    ds_read_b64_tr_b16 v[82:83], v28 offset:57888
    s_waitcnt lgkmcnt(8)
    v_mfma_f32_16x16x32_bf16 v[32:35], v[48:51], v[52:55], 0
    v_mfma_f32_16x16x32_bf16 v[36:39], v[48:51], v[56:59], 0
    v_mfma_f32_16x16x32_bf16 v[40:43], v[48:51], v[60:63], 0
    v_mfma_f32_16x16x32_bf16 v[44:47], v[48:51], v[64:67], 0
    s_waitcnt lgkmcnt(0)
    v_mfma_f32_16x16x32_bf16 v[32:35], v[48:51], v[68:71], v[32:35]
    v_mfma_f32_16x16x32_bf16 v[36:39], v[48:51], v[72:75], v[36:39]
    v_mfma_f32_16x16x32_bf16 v[40:43], v[48:51], v[76:79], v[40:43]
    v_mfma_f32_16x16x32_bf16 v[44:47], v[48:51], v[80:83], v[44:47]
    s_waitcnt vmcnt(16)
    v_mov_b32 v8, 4
    ds_write_b32 v23, v8 offset:0
    ds_read_b64_tr_b16 v[52:53], v27 offset:0
    ds_read_b64_tr_b16 v[54:55], v27 offset:512
    ds_read_b64_tr_b16 v[56:57], v27 offset:32
    ds_read_b64_tr_b16 v[58:59], v27 offset:544
    ds_read_b64_tr_b16 v[60:61], v29 offset:0
    ds_read_b64_tr_b16 v[62:63], v29 offset:512
    ds_read_b64_tr_b16 v[64:65], v29 offset:32
    ds_read_b64_tr_b16 v[66:67], v29 offset:544
    ds_read_b64_tr_b16 v[68:69], v27 offset:8192
    ds_read_b64_tr_b16 v[70:71], v27 offset:8704
    ds_read_b64_tr_b16 v[72:73], v27 offset:8224
    ds_read_b64_tr_b16 v[74:75], v27 offset:8736
    ds_read_b64_tr_b16 v[76:77], v29 offset:8192
    ds_read_b64_tr_b16 v[78:79], v29 offset:8704
    ds_read_b64_tr_b16 v[80:81], v29 offset:8224
    ds_read_b64_tr_b16 v[82:83], v29 offset:8736
    s_waitcnt lgkmcnt(8)
    v_mfma_f32_16x16x32_bf16 v[32:35], v[48:51], v[52:55], v[32:35]
    v_mfma_f32_16x16x32_bf16 v[36:39], v[48:51], v[56:59], v[36:39]
    v_mfma_f32_16x16x32_bf16 v[40:43], v[48:51], v[60:63], v[40:43]
    v_mfma_f32_16x16x32_bf16 v[44:47], v[48:51], v[64:67], v[44:47]
    s_waitcnt lgkmcnt(0)
    v_mfma_f32_16x16x32_bf16 v[32:35], v[48:51], v[68:71], v[32:35]
    v_mfma_f32_16x16x32_bf16 v[36:39], v[48:51], v[72:75], v[36:39]
    v_mfma_f32_16x16x32_bf16 v[40:43], v[48:51], v[76:79], v[40:43]
    v_mfma_f32_16x16x32_bf16 v[44:47], v[48:51], v[80:83], v[44:47]
    s_waitcnt vmcnt(8)
    v_mov_b32 v8, 6
    ds_write_b32 v23, v8 offset:0
    ds_read_b64_tr_b16 v[52:53], v26 offset:0
    ds_read_b64_tr_b16 v[54:55], v26 offset:512
    ds_read_b64_tr_b16 v[56:57], v26 offset:32
    ds_read_b64_tr_b16 v[58:59], v26 offset:544
    ds_read_b64_tr_b16 v[60:61], v28 offset:0
    ds_read_b64_tr_b16 v[62:63], v28 offset:512
    ds_read_b64_tr_b16 v[64:65], v28 offset:32
    ds_read_b64_tr_b16 v[66:67], v28 offset:544
    ds_read_b64_tr_b16 v[68:69], v26 offset:8192
    ds_read_b64_tr_b16 v[70:71], v26 offset:8704
    ds_read_b64_tr_b16 v[72:73], v26 offset:8224
    ds_read_b64_tr_b16 v[74:75], v26 offset:8736
    ds_read_b64_tr_b16 v[76:77], v28 offset:8192
    ds_read_b64_tr_b16 v[78:79], v28 offset:8704
    ds_read_b64_tr_b16 v[80:81], v28 offset:8224
    ds_read_b64_tr_b16 v[82:83], v28 offset:8736
    s_waitcnt lgkmcnt(8)
    v_mfma_f32_16x16x32_bf16 v[32:35], v[48:51], v[52:55], v[32:35]
    v_mfma_f32_16x16x32_bf16 v[36:39], v[48:51], v[56:59], v[36:39]
    v_mfma_f32_16x16x32_bf16 v[40:43], v[48:51], v[60:63], v[40:43]
    v_mfma_f32_16x16x32_bf16 v[44:47], v[48:51], v[64:67], v[44:47]
    s_waitcnt lgkmcnt(0)
    v_mfma_f32_16x16x32_bf16 v[32:35], v[48:51], v[68:71], v[32:35]
    v_mfma_f32_16x16x32_bf16 v[36:39], v[48:51], v[72:75], v[36:39]
    v_mfma_f32_16x16x32_bf16 v[40:43], v[48:51], v[76:79], v[40:43]
    v_mfma_f32_16x16x32_bf16 v[44:47], v[48:51], v[80:83], v[44:47]
    s_waitcnt vmcnt(0)
    v_mov_b32 v8, 8
    ds_write_b32 v23, v8 offset:0
    ds_read_b64_tr_b16 v[52:53], v26 offset:16384
    ds_read_b64_tr_b16 v[54:55], v26 offset:16896
    ds_read_b64_tr_b16 v[56:57], v26 offset:16416
    ds_read_b64_tr_b16 v[58:59], v26 offset:16928
    ds_read_b64_tr_b16 v[60:61], v28 offset:16384
    ds_read_b64_tr_b16 v[62:63], v28 offset:16896
    ds_read_b64_tr_b16 v[64:65], v28 offset:16416
    ds_read_b64_tr_b16 v[66:67], v28 offset:16928
    ds_read_b64_tr_b16 v[68:69], v26 offset:24576
    ds_read_b64_tr_b16 v[70:71], v26 offset:25088
    ds_read_b64_tr_b16 v[72:73], v26 offset:24608
    ds_read_b64_tr_b16 v[74:75], v26 offset:25120
    ds_read_b64_tr_b16 v[76:77], v28 offset:24576
    ds_read_b64_tr_b16 v[78:79], v28 offset:25088
    ds_read_b64_tr_b16 v[80:81], v28 offset:24608
    ds_read_b64_tr_b16 v[82:83], v28 offset:25120
    s_waitcnt lgkmcnt(8)
    v_mfma_f32_16x16x32_bf16 v[32:35], v[48:51], v[52:55], v[32:35]
    v_mfma_f32_16x16x32_bf16 v[36:39], v[48:51], v[56:59], v[36:39]
    v_mfma_f32_16x16x32_bf16 v[40:43], v[48:51], v[60:63], v[40:43]
    v_mfma_f32_16x16x32_bf16 v[44:47], v[48:51], v[64:67], v[44:47]
    s_waitcnt lgkmcnt(0)
    v_mfma_f32_16x16x32_bf16 v[32:35], v[48:51], v[68:71], v[32:35]
    v_mfma_f32_16x16x32_bf16 v[36:39], v[48:51], v[72:75], v[36:39]
    v_mfma_f32_16x16x32_bf16 v[40:43], v[48:51], v[76:79], v[40:43]
    v_mfma_f32_16x16x32_bf16 v[44:47], v[48:51], v[80:83], v[44:47]
    v_mov_b32 v8, 1
    s_mov_b32 s78, 0xffff0000
    s_mov_b32 s79, 0xffff0000
    s_mov_b32 vcc_lo, 0
    s_mov_b32 vcc_hi, -1
    s_nop 4
    v_cndmask_b32_e64 v32, v32, v36, s[78:79]
    v_cndmask_b32_e64 v40, v40, v44, s[78:79]
    v_cndmask_b32 v32, v32, v40, vcc
    v_cvt_pk_bf16_f32 v33, v32, v32
    v_lshlrev_b32 v33, 16, v33
    v_sub_f32 v33, v32, v33
    v_cvt_pk_bf16_f32 v32, v32, v33
    ds_write_b32 v30, v32 offset:14336
    ds_write_b32 v23, v8 offset:8
    s_mov_b32 s36, s8
    s_and_b32 s37, s9, 0xffff
    s_mov_b32 s38, 524288
    s_mov_b32 s39, 0x00020000
    v_and_b32 v204, 31, v1
    v_bfe_u32 v200, v1, 1, 3
    v_lshlrev_b32 v200, 4, v200
    v_lshl_add_u32 v200, v204, 7, v200
    v_lshrrev_b32 v205, 5, v1
    v_lshl_add_u32 v200, v205, 3, v200
    s_and_b32 s61, s26, 3
    s_lshl_b32 s61, s61, 13
    s_lshl_b32 s62, s70, 5
    v_xor_b32 v200, s62, v200
    v_add_u32 v200, s61, v200
    v_lshl_add_u32 v204, v204, 2, v2
    s_lshl_b32 s62, s70, 10
    v_lshl_add_u32 v205, v1, 4, v2
    v_add_u32 v205, s62, v205
    s_mov_b32 s60, 0xbfb8aa3b
    ds_read_b32 v208, v204 offset:1920
    ds_read_b32 v210, v204 offset:1664
    ds_read_b32 v212, v204 offset:1792
    ds_read_b32 v214, v204 offset:1536
    ds_read_b64 v[216:217], v200 offset:4096
    v_xor_b32 v201, 16, v200
    ds_read_b64 v[218:219], v201 offset:4096
    v_xor_b32 v201, 64, v200
    ds_read_b64 v[220:221], v201 offset:4096
    v_xor_b32 v201, 80, v200
    ds_read_b64 v[222:223], v201 offset:4096
    ds_read_b64 v[224:225], v200 offset:0
    v_xor_b32 v201, 16, v200
    ds_read_b64 v[226:227], v201 offset:0
    s_waitcnt lgkmcnt(6)
    v_mul_f32_e64 v210, -v210, v208
    v_mul_f32_e64 v214, -v214, v212
    s_waitcnt lgkmcnt(4)
    v_lshlrev_b32 v232, 16, v216
    v_and_b32 v233, 0xffff0000, v216
    v_lshlrev_b32 v234, 16, v217
    v_and_b32 v235, 0xffff0000, v217
    v_lshlrev_b32 v236, 16, v218
    v_and_b32 v237, 0xffff0000, v218
    v_lshlrev_b32 v238, 16, v219
    v_and_b32 v239, 0xffff0000, v219
    v_pk_fma_f32 v[232:233], v[232:233], v[208:209], v[210:211] op_sel_hi:[1,0,0]
    v_pk_fma_f32 v[234:235], v[234:235], v[208:209], v[210:211] op_sel_hi:[1,0,0]
    v_pk_fma_f32 v[236:237], v[236:237], v[208:209], v[210:211] op_sel_hi:[1,0,0]
    v_pk_fma_f32 v[238:239], v[238:239], v[208:209], v[210:211] op_sel_hi:[1,0,0]
    v_pk_mul_f32 v[240:241], v[232:233], s[60:61] op_sel_hi:[1,0]
    v_pk_mul_f32 v[242:243], v[234:235], s[60:61] op_sel_hi:[1,0]
    v_pk_mul_f32 v[244:245], v[236:237], s[60:61] op_sel_hi:[1,0]
    v_pk_mul_f32 v[246:247], v[238:239], s[60:61] op_sel_hi:[1,0]
    v_exp_f32 v240, v240
    v_exp_f32 v241, v241
    v_exp_f32 v242, v242
    v_exp_f32 v243, v243
    v_exp_f32 v244, v244
    v_exp_f32 v245, v245
    v_exp_f32 v246, v246
    v_exp_f32 v247, v247
    v_pk_add_f32 v[240:241], v[240:241], 1.0 op_sel_hi:[1,0]
    v_pk_add_f32 v[242:243], v[242:243], 1.0 op_sel_hi:[1,0]
    v_pk_add_f32 v[244:245], v[244:245], 1.0 op_sel_hi:[1,0]
    v_pk_add_f32 v[246:247], v[246:247], 1.0 op_sel_hi:[1,0]
    v_rcp_f32 v240, v240
    v_rcp_f32 v241, v241
    v_rcp_f32 v242, v242
    v_rcp_f32 v243, v243
    v_rcp_f32 v244, v244
    v_rcp_f32 v245, v245
    v_rcp_f32 v246, v246
    v_rcp_f32 v247, v247
    v_pk_mul_f32 v[240:241], v[240:241], v[232:233]
    v_pk_mul_f32 v[242:243], v[242:243], v[234:235]
    v_pk_mul_f32 v[244:245], v[244:245], v[236:237]
    v_pk_mul_f32 v[246:247], v[246:247], v[238:239]
    v_cvt_pk_bf16_f32 v216, v240, v241
    v_cvt_pk_bf16_f32 v217, v242, v243
    v_cvt_pk_bf16_f32 v218, v244, v245
    v_cvt_pk_bf16_f32 v219, v246, v247
    ds_write_b128 v205, v[216:219] offset:4096
    s_waitcnt lgkmcnt(3)
    v_lshlrev_b32 v232, 16, v220
    v_and_b32 v233, 0xffff0000, v220
    v_lshlrev_b32 v234, 16, v221
    v_and_b32 v235, 0xffff0000, v221
    v_lshlrev_b32 v236, 16, v222
    v_and_b32 v237, 0xffff0000, v222
    v_lshlrev_b32 v238, 16, v223
    v_and_b32 v239, 0xffff0000, v223
    v_pk_fma_f32 v[232:233], v[232:233], v[208:209], v[210:211] op_sel_hi:[1,0,0]
    v_pk_fma_f32 v[234:235], v[234:235], v[208:209], v[210:211] op_sel_hi:[1,0,0]
    v_pk_fma_f32 v[236:237], v[236:237], v[208:209], v[210:211] op_sel_hi:[1,0,0]
    v_pk_fma_f32 v[238:239], v[238:239], v[208:209], v[210:211] op_sel_hi:[1,0,0]
    v_pk_mul_f32 v[240:241], v[232:233], s[60:61] op_sel_hi:[1,0]
    v_pk_mul_f32 v[242:243], v[234:235], s[60:61] op_sel_hi:[1,0]
    v_pk_mul_f32 v[244:245], v[236:237], s[60:61] op_sel_hi:[1,0]
    v_pk_mul_f32 v[246:247], v[238:239], s[60:61] op_sel_hi:[1,0]
    v_exp_f32 v240, v240
    v_exp_f32 v241, v241
    v_exp_f32 v242, v242
    v_exp_f32 v243, v243
    v_exp_f32 v244, v244
    v_exp_f32 v245, v245
    v_exp_f32 v246, v246
    v_exp_f32 v247, v247
    v_pk_add_f32 v[240:241], v[240:241], 1.0 op_sel_hi:[1,0]
    v_pk_add_f32 v[242:243], v[242:243], 1.0 op_sel_hi:[1,0]
    v_pk_add_f32 v[244:245], v[244:245], 1.0 op_sel_hi:[1,0]
    v_pk_add_f32 v[246:247], v[246:247], 1.0 op_sel_hi:[1,0]
    v_rcp_f32 v240, v240
    v_rcp_f32 v241, v241
    v_rcp_f32 v242, v242
    v_rcp_f32 v243, v243
    v_rcp_f32 v244, v244
    v_rcp_f32 v245, v245
    v_rcp_f32 v246, v246
    v_rcp_f32 v247, v247
    v_pk_mul_f32 v[240:241], v[240:241], v[232:233]
    v_pk_mul_f32 v[242:243], v[242:243], v[234:235]
    v_pk_mul_f32 v[244:245], v[244:245], v[236:237]
    v_pk_mul_f32 v[246:247], v[246:247], v[238:239]
    v_cvt_pk_bf16_f32 v220, v240, v241
    v_cvt_pk_bf16_f32 v221, v242, v243
    v_cvt_pk_bf16_f32 v222, v244, v245
    v_cvt_pk_bf16_f32 v223, v246, v247
    ds_write_b128 v205, v[220:223] offset:6144
    s_waitcnt lgkmcnt(2)
    v_lshlrev_b32 v232, 16, v224
    v_and_b32 v233, 0xffff0000, v224
    v_lshlrev_b32 v234, 16, v225
    v_and_b32 v235, 0xffff0000, v225
    v_lshlrev_b32 v236, 16, v226
    v_and_b32 v237, 0xffff0000, v226
    v_lshlrev_b32 v238, 16, v227
    v_and_b32 v239, 0xffff0000, v227
    v_pk_fma_f32 v[232:233], v[232:233], v[212:213], v[214:215] op_sel_hi:[1,0,0]
    v_pk_fma_f32 v[234:235], v[234:235], v[212:213], v[214:215] op_sel_hi:[1,0,0]
    v_pk_fma_f32 v[236:237], v[236:237], v[212:213], v[214:215] op_sel_hi:[1,0,0]
    v_pk_fma_f32 v[238:239], v[238:239], v[212:213], v[214:215] op_sel_hi:[1,0,0]
    v_pk_mul_f32 v[240:241], v[232:233], s[60:61] op_sel_hi:[1,0]
    v_pk_mul_f32 v[242:243], v[234:235], s[60:61] op_sel_hi:[1,0]
    v_pk_mul_f32 v[244:245], v[236:237], s[60:61] op_sel_hi:[1,0]
    v_pk_mul_f32 v[246:247], v[238:239], s[60:61] op_sel_hi:[1,0]
    v_exp_f32 v240, v240
    v_exp_f32 v241, v241
    v_exp_f32 v242, v242
    v_exp_f32 v243, v243
    v_exp_f32 v244, v244
    v_exp_f32 v245, v245
    v_exp_f32 v246, v246
    v_exp_f32 v247, v247
    v_pk_add_f32 v[240:241], v[240:241], 1.0 op_sel_hi:[1,0]
    v_pk_add_f32 v[242:243], v[242:243], 1.0 op_sel_hi:[1,0]
    v_pk_add_f32 v[244:245], v[244:245], 1.0 op_sel_hi:[1,0]
    v_pk_add_f32 v[246:247], v[246:247], 1.0 op_sel_hi:[1,0]
    v_rcp_f32 v240, v240
    v_rcp_f32 v241, v241
    v_rcp_f32 v242, v242
    v_rcp_f32 v243, v243
    v_rcp_f32 v244, v244
    v_rcp_f32 v245, v245
    v_rcp_f32 v246, v246
    v_rcp_f32 v247, v247
    v_pk_mul_f32 v[240:241], v[240:241], v[232:233]
    v_pk_mul_f32 v[242:243], v[242:243], v[234:235]
    v_pk_mul_f32 v[244:245], v[244:245], v[236:237]
    v_pk_mul_f32 v[246:247], v[246:247], v[238:239]
    v_cvt_pk_bf16_f32 v224, v240, v241
    v_cvt_pk_bf16_f32 v225, v242, v243
    v_cvt_pk_bf16_f32 v226, v244, v245
    v_cvt_pk_bf16_f32 v227, v246, v247
    ds_write_b128 v205, v[224:227] offset:8192
    s_mov_b64 exec, 1
    v_mov_b32 v200, 3
    ds_add_u32 v2, v200 offset:68
    s_mov_b64 exec, -1
    s_mov_b32 s67, 0
W_1:
    ds_read_b32 v4, v2 offset:56
    s_waitcnt lgkmcnt(0)
    v_readfirstlane_b32 s68, v4
    s_cmp_ge_u32 s68, 4
    s_cbranch_scc1 D_2
    s_add_u32 s67, s67, 1
    s_cmp_lt_u32 s67, 4194304
    s_cbranch_scc1 W_1
D_2:
    s_and_b32 s74, s26, 7
    s_lshl_b32 s74, s74, 3
    s_add_u32 s74, s74, s70
    s_mov_b32 s75, 0
L_ld_wo2:
    s_lshl_b32 s76, s74, 13
    s_lshl_b32 s77, s74, 10
    s_add_u32 s77, s77, 65536
    s_add_u32 m0, s77, 0
    s_add_u32 s78, s76, 0
    buffer_load_dwordx4 v20, s[36:39], s78 offen lds
    s_add_u32 m0, s77, 2048
    s_add_u32 s78, s76, 16384
    buffer_load_dwordx4 v20, s[36:39], s78 offen lds
    s_add_u32 m0, s77, 4096
    s_add_u32 s78, s76, 32768
    buffer_load_dwordx4 v20, s[36:39], s78 offen lds
    s_add_u32 m0, s77, 6144
    s_add_u32 s78, s76, 49152
    buffer_load_dwordx4 v20, s[36:39], s78 offen lds
    s_waitcnt vmcnt(12)
    s_add_u32 s74, s74, 8
    s_and_b32 s74, s74, 63
    s_add_u32 s75, s75, 1
    s_cmp_lt_u32 s75, 8
    s_cbranch_scc1 L_ld_wo2
    s_waitcnt vmcnt(0)
    v_mov_b32 v8, 11
    ds_write_b32 v23, v8 offset:0
    s_waitcnt lgkmcnt(0)
    s_endpgm
L_loader2:
    s_cmp_eq_u32 s3, 7
    s_cbranch_scc1 L_loader7
    s_add_u32 m0, s71, 0
    s_nop 0
    buffer_load_dwordx4 v10, s[28:31], s52 offen offset:0 lds
    buffer_load_dwordx4 v11, s[28:31], s52 offen offset:1024 lds
    s_add_u32 m0, s72, 0
    s_nop 0
    buffer_load_dwordx4 v12, s[32:35], s36 offen offset:0 lds
    buffer_load_dwordx4 v13, s[32:35], s36 offen offset:1024 lds
    s_add_u32 m0, s72, 8192
    s_nop 0
    buffer_load_dwordx4 v14, s[32:35], s36 offen offset:0 lds
    buffer_load_dwordx4 v15, s[32:35], s36 offen offset:1024 lds
    s_add_u32 s75, s64, 1
    s_and_b32 s75, s75, 7
    s_mul_i32 s37, s75, 196608
    s_lshl_b32 s75, s75, 7
    s_add_u32 s53, s75, s69
    s_add_u32 m0, s71, 8192
    s_nop 0
    buffer_load_dwordx4 v10, s[28:31], s53 offen offset:0 lds
    buffer_load_dwordx4 v11, s[28:31], s53 offen offset:1024 lds
    s_add_u32 m0, s72, 16384
    s_nop 0
    buffer_load_dwordx4 v12, s[32:35], s37 offen offset:0 lds
    buffer_load_dwordx4 v13, s[32:35], s37 offen offset:1024 lds
    s_add_u32 m0, s72, 24576
    s_nop 0
    buffer_load_dwordx4 v14, s[32:35], s37 offen offset:0 lds
    buffer_load_dwordx4 v15, s[32:35], s37 offen offset:1024 lds
    s_mov_b32 s40, s24
    s_and_b32 s41, s25, 0xffff
    s_mov_b32 s42, 25165824
    s_mov_b32 s43, 0x00020000
    s_lshl_b32 s79, s70, 2
    v_add_u32 v23, s79, v2
    v_bfe_u32 v31, v1, 2, 2
    v_lshl_add_u32 v21, v4, 3, v31
    v_xor_b32 v22, s70, v31
    v_lshlrev_b32 v22, 6, v22
    v_lshl_add_u32 v22, v6, 3, v22
    v_lshl_add_u32 v22, v21, 8, v22
    v_add_u32 v24, 65536, v22
    v_add_u32 v25, 131072, v22
    s_lshl_b32 s78, s70, 8
    v_lshl_add_u32 v30, v1, 3, v2
    v_add_u32 v30, s78, v30
    v_mov_b32 v48, s66
    v_mov_b32 v49, s66
    v_mov_b32 v50, s66
    v_mov_b32 v51, s66
    s_waitcnt vmcnt(8)
    s_barrier
    s_add_u32 s75, s64, 2
    s_and_b32 s75, s75, 7
    s_mul_i32 s38, s75, 196608
    s_lshl_b32 s75, s75, 7
    s_add_u32 s54, s75, s69
    s_add_u32 m0, s71, 16384
    s_nop 0
    buffer_load_dwordx4 v10, s[28:31], s54 offen offset:0 lds
    buffer_load_dwordx4 v11, s[28:31], s54 offen offset:1024 lds
    s_add_u32 m0, s72, 32768
    s_nop 0
    buffer_load_dwordx4 v12, s[32:35], s38 offen offset:0 lds
    buffer_load_dwordx4 v13, s[32:35], s38 offen offset:1024 lds
    ds_read_b64_tr_b16 v[52:53], v24 offset:0
    ds_read_b64_tr_b16 v[54:55], v24 offset:1024
    ds_read_b64_tr_b16 v[56:57], v24 offset:32
    ds_read_b64_tr_b16 v[58:59], v24 offset:1056
    s_waitcnt vmcnt(10)
    s_barrier
    s_add_u32 m0, s72, 40960
    s_nop 0
    buffer_load_dwordx4 v14, s[32:35], s38 offen offset:0 lds
    buffer_load_dwordx4 v15, s[32:35], s38 offen offset:1024 lds
    s_waitcnt lgkmcnt(0)
    v_mfma_f32_16x16x32_bf16 v[32:35], v[48:51], v[52:55], 0
    v_mfma_f32_16x16x32_bf16 v[36:39], v[48:51], v[56:59], 0
    ds_read_b64_tr_b16 v[60:61], v24 offset:8192
    ds_read_b64_tr_b16 v[62:63], v24 offset:9216
    ds_read_b64_tr_b16 v[64:65], v24 offset:8224
    ds_read_b64_tr_b16 v[66:67], v24 offset:9248
    s_waitcnt vmcnt(8)
    s_barrier
    s_add_u32 s75, s64, 3
    s_and_b32 s75, s75, 7
    s_mul_i32 s39, s75, 196608
    s_lshl_b32 s75, s75, 7
    s_add_u32 s55, s75, s69
    s_add_u32 m0, s71, 24576
    s_nop 0
    buffer_load_dwordx4 v10, s[28:31], s55 offen offset:0 lds
    buffer_load_dwordx4 v11, s[28:31], s55 offen offset:1024 lds
    s_add_u32 m0, s72, 49152
    s_nop 0
    buffer_load_dwordx4 v12, s[32:35], s39 offen offset:0 lds
    buffer_load_dwordx4 v13, s[32:35], s39 offen offset:1024 lds
    s_waitcnt lgkmcnt(0)
    v_mfma_f32_16x16x32_bf16 v[32:35], v[48:51], v[60:63], v[32:35]
    v_mfma_f32_16x16x32_bf16 v[36:39], v[48:51], v[64:67], v[36:39]
    ds_read_b64_tr_b16 v[52:53], v24 offset:16384
    ds_read_b64_tr_b16 v[54:55], v24 offset:17408
    ds_read_b64_tr_b16 v[56:57], v24 offset:16416
    ds_read_b64_tr_b16 v[58:59], v24 offset:17440
    ds_read_b32 v82, v2 offset:48
    v_lshlrev_b32 v68, 4, v1
    v_lshlrev_b32 v80, 5, v1
    v_mov_b32 v81, 0
    v_lshrrev_b32 v73, 2, v1
    v_and_b32 v74, 3, v1
    v_lshrrev_b32 v75, 5, v1
    v_lshlrev_b32 v75, 1, v75
    v_xor_b32 v74, v74, v75
    v_mul_u32_u24 v73, 3584, v73
    s_cmp_eq_u32 s27, 3
    s_cselect_b32 s68, 0x40000000, 0
    v_lshl_add_u32 v69, v74, 4, v73
    v_add_u32 v69, s68, v69
    v_add_u32 v70, 56320, v69
    v_lshrrev_b32 v73, 4, v1
    v_and_b32 v74, 15, v1
    v_lshlrev_b32 v75, 1, v73
    v_xor_b32 v74, v74, v75
    v_lshlrev_b32 v74, 4, v74
    v_lshl_add_u32 v71, v73, 10, v74
    v_add_u32 v71, s68, v71
    v_xor_b32 v72, 128, v71
    v_add_u32 v72, 3072, v72
    s_waitcnt vmcnt(10)
    s_barrier
    s_add_u32 m0, s72, 57344
    s_nop 0
    buffer_load_dwordx4 v14, s[32:35], s39 offen offset:0 lds
    buffer_load_dwordx4 v15, s[32:35], s39 offen offset:1024 lds
    s_waitcnt lgkmcnt(0)
    v_mfma_f32_16x16x32_bf16 v[32:35], v[48:51], v[52:55], v[32:35]
    v_mfma_f32_16x16x32_bf16 v[36:39], v[48:51], v[56:59], v[36:39]
    ds_read_b64_tr_b16 v[60:61], v24 offset:24576
    ds_read_b64_tr_b16 v[62:63], v24 offset:25600
    ds_read_b64_tr_b16 v[64:65], v24 offset:24608
    ds_read_b64_tr_b16 v[66:67], v24 offset:25632
    v_readfirstlane_b32 s65, v82
    s_mov_b32 s77, 0xffff0000
    s_mov_b32 s62, 0x01010101
    s_mov_b32 s63, 0x01010101
    v_mov_b32 v128, s66
    v_mov_b32 v129, s66
    v_mov_b32 v130, s66
    v_mov_b32 v131, s66
    v_mov_b32 v132, s66
    v_mov_b32 v133, s66
    v_mov_b32 v134, s66
    v_mov_b32 v135, s66
    v_mov_b32 v136, s66
    v_mov_b32 v137, s66
    v_mov_b32 v138, s66
    v_mov_b32 v139, s66
    v_mov_b32 v140, s66
    v_mov_b32 v141, s66
    v_mov_b32 v142, s66
    v_mov_b32 v143, s66
    v_mov_b32 v144, s66
    v_mov_b32 v145, s66
    v_mov_b32 v146, s66
    v_mov_b32 v147, s66
    v_mov_b32 v148, s66
    v_mov_b32 v149, s66
    v_mov_b32 v150, s66
    v_mov_b32 v151, s66
    v_mov_b32 v152, s66
    v_mov_b32 v153, s66
    v_mov_b32 v154, s66
    v_mov_b32 v155, s66
    v_mov_b32 v156, s66
    v_mov_b32 v157, s66
    v_mov_b32 v158, s66
    v_mov_b32 v159, s66
    s_waitcnt vmcnt(8)
    s_barrier
    s_add_u32 s75, s64, 4
    s_and_b32 s75, s75, 7
    s_mul_i32 s44, s75, 196608
    s_lshl_b32 s75, s75, 7
    s_add_u32 s56, s75, s69
    s_add_u32 m0, s71, 32768
    s_nop 0
    buffer_load_dwordx4 v10, s[28:31], s56 offen offset:0 lds
    buffer_load_dwordx4 v11, s[28:31], s56 offen offset:1024 lds
    s_add_u32 m0, s72, 65536
    s_nop 0
    buffer_load_dwordx4 v12, s[32:35], s44 offen offset:0 lds
    buffer_load_dwordx4 v13, s[32:35], s44 offen offset:1024 lds
    s_waitcnt lgkmcnt(0)
    v_mfma_f32_16x16x32_bf16 v[32:35], v[48:51], v[60:63], v[32:35]
    v_mfma_f32_16x16x32_bf16 v[36:39], v[48:51], v[64:67], v[36:39]
    ds_read_b64_tr_b16 v[52:53], v24 offset:32768
    ds_read_b64_tr_b16 v[54:55], v24 offset:33792
    ds_read_b64_tr_b16 v[56:57], v24 offset:32800
    ds_read_b64_tr_b16 v[58:59], v24 offset:33824
    s_waitcnt vmcnt(10)
    s_barrier
    s_add_u32 m0, s72, 73728
    s_nop 0
    buffer_load_dwordx4 v14, s[32:35], s44 offen offset:0 lds
    buffer_load_dwordx4 v15, s[32:35], s44 offen offset:1024 lds
    s_waitcnt lgkmcnt(0)
    v_mfma_f32_16x16x32_bf16 v[32:35], v[48:51], v[52:55], v[32:35]
    v_mfma_f32_16x16x32_bf16 v[36:39], v[48:51], v[56:59], v[36:39]
    ds_read_b64_tr_b16 v[60:61], v24 offset:40960
    ds_read_b64_tr_b16 v[62:63], v24 offset:41984
    ds_read_b64_tr_b16 v[64:65], v24 offset:40992
    ds_read_b64_tr_b16 v[66:67], v24 offset:42016
    s_waitcnt vmcnt(8)
    s_barrier
    s_add_u32 s75, s64, 5
    s_and_b32 s75, s75, 7
    s_mul_i32 s45, s75, 196608
    s_lshl_b32 s75, s75, 7
    s_add_u32 s57, s75, s69
    s_add_u32 m0, s71, 40960
    s_nop 0
    buffer_load_dwordx4 v10, s[28:31], s57 offen offset:0 lds
    buffer_load_dwordx4 v11, s[28:31], s57 offen offset:1024 lds
    s_add_u32 m0, s72, 0
    s_nop 0
    buffer_load_dwordx4 v12, s[32:35], s45 offen offset:0 lds
    buffer_load_dwordx4 v13, s[32:35], s45 offen offset:1024 lds
    s_waitcnt lgkmcnt(0)
    v_mfma_f32_16x16x32_bf16 v[32:35], v[48:51], v[60:63], v[32:35]
    v_mfma_f32_16x16x32_bf16 v[36:39], v[48:51], v[64:67], v[36:39]
    ds_read_b64_tr_b16 v[52:53], v24 offset:49152
    ds_read_b64_tr_b16 v[54:55], v24 offset:50176
    ds_read_b64_tr_b16 v[56:57], v24 offset:49184
    ds_read_b64_tr_b16 v[58:59], v24 offset:50208
    s_waitcnt vmcnt(10)
    s_barrier
    s_add_u32 m0, s72, 8192
    s_nop 0
    buffer_load_dwordx4 v14, s[32:35], s45 offen offset:0 lds
    buffer_load_dwordx4 v15, s[32:35], s45 offen offset:1024 lds
    s_waitcnt lgkmcnt(0)
    v_mfma_f32_16x16x32_bf16 v[32:35], v[48:51], v[52:55], v[32:35]
    v_mfma_f32_16x16x32_bf16 v[36:39], v[48:51], v[56:59], v[36:39]
    ds_read_b64_tr_b16 v[60:61], v24 offset:57344
    ds_read_b64_tr_b16 v[62:63], v24 offset:58368
    ds_read_b64_tr_b16 v[64:65], v24 offset:57376
    ds_read_b64_tr_b16 v[66:67], v24 offset:58400
    s_waitcnt vmcnt(8)
    s_barrier
    s_add_u32 s75, s64, 6
    s_and_b32 s75, s75, 7
    s_mul_i32 s46, s75, 196608
    s_lshl_b32 s75, s75, 7
    s_add_u32 s58, s75, s69
    s_add_u32 m0, s71, 49152
    s_nop 0
    buffer_load_dwordx4 v10, s[28:31], s58 offen offset:0 lds
    buffer_load_dwordx4 v11, s[28:31], s58 offen offset:1024 lds
    s_add_u32 m0, s72, 16384
    s_nop 0
    buffer_load_dwordx4 v12, s[32:35], s46 offen offset:0 lds
    buffer_load_dwordx4 v13, s[32:35], s46 offen offset:1024 lds
    s_waitcnt lgkmcnt(0)
    v_mfma_f32_16x16x32_bf16 v[32:35], v[48:51], v[60:63], v[32:35]
    v_mfma_f32_16x16x32_bf16 v[36:39], v[48:51], v[64:67], v[36:39]
    ds_read_b64_tr_b16 v[52:53], v25 offset:0
    ds_read_b64_tr_b16 v[54:55], v25 offset:1024
    ds_read_b64_tr_b16 v[56:57], v25 offset:32
    ds_read_b64_tr_b16 v[58:59], v25 offset:1056
    s_mov_b32 s74, 4096
    s_mov_b32 s76, 8192
    buffer_load_dwordx4 v[96:99], v68, s[40:43], s74 offen offset:0 sc1
    buffer_load_dwordx4 v[100:103], v68, s[40:43], s74 offen offset:1024 sc1
    buffer_load_dwordx4 v[104:107], v68, s[40:43], s74 offen offset:2048 sc1
    buffer_load_dwordx4 v[108:111], v68, s[40:43], s74 offen offset:3072 sc1
    buffer_load_dwordx4 v[112:115], v68, s[40:43], s76 offen offset:0 sc1
    buffer_load_dwordx4 v[116:119], v68, s[40:43], s76 offen offset:1024 sc1
    buffer_load_dwordx4 v[120:123], v68, s[40:43], s76 offen offset:2048 sc1
    buffer_load_dwordx4 v[124:127], v68, s[40:43], s76 offen offset:3072 sc1
    s_waitcnt vmcnt(18)
    s_barrier
    s_add_u32 m0, s72, 24576
    s_nop 0
    buffer_load_dwordx4 v14, s[32:35], s46 offen offset:0 lds
    buffer_load_dwordx4 v15, s[32:35], s46 offen offset:1024 lds
    s_add_u32 s75, s64, 7
    s_and_b32 s75, s75, 7
    s_mul_i32 s47, s75, 196608
    s_lshl_b32 s75, s75, 7
    s_add_u32 s59, s75, s69
    s_add_u32 m0, s71, 57344
    s_nop 0
    buffer_load_dwordx4 v10, s[28:31], s59 offen offset:0 lds
    buffer_load_dwordx4 v11, s[28:31], s59 offen offset:1024 lds
    s_add_u32 m0, s72, 32768
    s_nop 0
    buffer_load_dwordx4 v12, s[32:35], s47 offen offset:0 lds
    buffer_load_dwordx4 v13, s[32:35], s47 offen offset:1024 lds
    s_waitcnt lgkmcnt(0)
    v_mfma_f32_16x16x32_bf16 v[32:35], v[48:51], v[52:55], v[32:35]
    v_mfma_f32_16x16x32_bf16 v[36:39], v[48:51], v[56:59], v[36:39]
    ds_read_b64_tr_b16 v[60:61], v25 offset:8192
    ds_read_b64_tr_b16 v[62:63], v25 offset:9216
    ds_read_b64_tr_b16 v[64:65], v25 offset:8224
    ds_read_b64_tr_b16 v[66:67], v25 offset:9248
    s_waitcnt vmcnt(20)
    s_barrier
    s_add_u32 m0, s72, 40960
    s_nop 0
    buffer_load_dwordx4 v14, s[32:35], s47 offen offset:0 lds
    buffer_load_dwordx4 v15, s[32:35], s47 offen offset:1024 lds
    s_waitcnt lgkmcnt(0)
    v_mfma_f32_16x16x32_bf16 v[32:35], v[48:51], v[60:63], v[32:35]
    v_mfma_f32_16x16x32_bf16 v[36:39], v[48:51], v[64:67], v[36:39]
    ds_read_b64_tr_b16 v[52:53], v24 offset:0
    ds_read_b64_tr_b16 v[54:55], v24 offset:1024
    ds_read_b64_tr_b16 v[56:57], v24 offset:32
    ds_read_b64_tr_b16 v[58:59], v24 offset:1056
    s_mov_b32 s48, s14
    s_and_b32 s49, s15, 0xffff
    s_mov_b32 s50, 1835008
    s_mov_b32 s51, 0x00020000
    s_mov_b32 s52, s16
    s_and_b32 s53, s17, 0xffff
    s_mov_b32 s54, 1835008
    s_mov_b32 s55, 0x00020000
    s_mov_b32 s56, s18
    s_and_b32 s57, s19, 0xffff
    s_mov_b32 s58, 1835008
    s_mov_b32 s59, 0x00020000
    s_cmp_gt_u32 s27, 3
    s_subb_u32 s70, s27, 0
    s_min_u32 s70, s70, 6
    s_lshl_b32 s70, s70, 3
    s_lshr_b32 s71, s26, 2
    s_add_u32 s70, s70, s71
    s_and_b32 s71, s26, 3
    s_mul_i32 s39, s71, 458752
    s_lshl_b32 s68, s70, 6
    s_add_u32 s39, s39, s68
    s_lshl_b32 s44, s70, 15
    s_lshl_b32 s68, s71, 8
    s_add_u32 s44, s44, s68
    s_lshl_b32 s68, s26, 13
    s_add_u32 s36, s68, 8192
    s_add_u32 s37, s68, 16384
    s_add_u32 s38, s68, 24576
    s_and_b32 s36, s36, 0x6000
    s_and_b32 s37, s37, 0x6000
    s_and_b32 s38, s38, 0x6000
    s_add_u32 m0, s36, 0
    s_nop 0
    buffer_load_dwordx4 v69, s[48:51], s39 offen nt lds
    buffer_load_dwordx4 v70, s[48:51], s39 offen offset:1024 nt lds
    s_add_u32 m0, s37, 0
    s_nop 0
    buffer_load_dwordx4 v69, s[52:55], s39 offen nt lds
    buffer_load_dwordx4 v70, s[52:55], s39 offen offset:1024 nt lds
    s_add_u32 s39, s39, 114688
    s_add_u32 m0, s36, 2048
    s_nop 0
    buffer_load_dwordx4 v69, s[48:51], s39 offen nt lds
    buffer_load_dwordx4 v70, s[48:51], s39 offen offset:1024 nt lds
    s_add_u32 m0, s37, 2048
    s_nop 0
    buffer_load_dwordx4 v69, s[52:55], s39 offen nt lds
    buffer_load_dwordx4 v70, s[52:55], s39 offen offset:1024 nt lds
    s_add_u32 s39, s39, 114688
    s_add_u32 m0, s36, 4096
    s_nop 0
    buffer_load_dwordx4 v69, s[48:51], s39 offen nt lds
    buffer_load_dwordx4 v70, s[48:51], s39 offen offset:1024 nt lds
    s_add_u32 m0, s37, 4096
    s_nop 0
    buffer_load_dwordx4 v69, s[52:55], s39 offen nt lds
    buffer_load_dwordx4 v70, s[52:55], s39 offen offset:1024 nt lds
    s_add_u32 s39, s39, 114688
    s_add_u32 m0, s36, 6144
    s_nop 0
    buffer_load_dwordx4 v69, s[48:51], s39 offen nt lds
    buffer_load_dwordx4 v70, s[48:51], s39 offen offset:1024 nt lds
    s_add_u32 m0, s37, 6144
    s_nop 0
    buffer_load_dwordx4 v69, s[52:55], s39 offen nt lds
    buffer_load_dwordx4 v70, s[52:55], s39 offen offset:1024 nt lds
    s_waitcnt vmcnt(36)
    s_barrier
    s_waitcnt lgkmcnt(0)
    v_mfma_f32_16x16x32_bf16 v[32:35], v[48:51], v[52:55], v[32:35]
    v_mfma_f32_16x16x32_bf16 v[36:39], v[48:51], v[56:59], v[36:39]
    ds_read_b64_tr_b16 v[60:61], v24 offset:8192
    ds_read_b64_tr_b16 v[62:63], v24 offset:9216
    ds_read_b64_tr_b16 v[64:65], v24 offset:8224
    ds_read_b64_tr_b16 v[66:67], v24 offset:9248
    s_waitcnt vmcnt(32)
    s_barrier
    s_waitcnt lgkmcnt(0)
    v_mfma_f32_16x16x32_bf16 v[32:35], v[48:51], v[60:63], v[32:35]
    v_mfma_f32_16x16x32_bf16 v[36:39], v[48:51], v[64:67], v[36:39]
    ds_read_b64_tr_b16 v[52:53], v24 offset:16384
    ds_read_b64_tr_b16 v[54:55], v24 offset:17408
    ds_read_b64_tr_b16 v[56:57], v24 offset:16416
    ds_read_b64_tr_b16 v[58:59], v24 offset:17440
    s_waitcnt vmcnt(22)
    s_barrier
    s_waitcnt lgkmcnt(0)
    v_mfma_f32_16x16x32_bf16 v[32:35], v[48:51], v[52:55], v[32:35]
    v_mfma_f32_16x16x32_bf16 v[36:39], v[48:51], v[56:59], v[36:39]
    ds_read_b64_tr_b16 v[60:61], v24 offset:24576
    ds_read_b64_tr_b16 v[62:63], v24 offset:25600
    ds_read_b64_tr_b16 v[64:65], v24 offset:24608
    ds_read_b64_tr_b16 v[66:67], v24 offset:25632
    v_cmpx_eq_u32 vcc, s65, v97
    v_cmpx_eq_u32 vcc, s65, v99
    v_cmpx_eq_u32 vcc, s65, v101
    v_cmpx_eq_u32 vcc, s65, v103
    v_cmpx_eq_u32 vcc, s65, v105
    v_cmpx_eq_u32 vcc, s65, v107
    v_cmpx_eq_u32 vcc, s65, v109
    v_cmpx_eq_u32 vcc, s65, v111
    v_cmpx_eq_u32 vcc, s65, v113
    v_cmpx_eq_u32 vcc, s65, v115
    v_cmpx_eq_u32 vcc, s65, v117
    v_cmpx_eq_u32 vcc, s65, v119
    v_cmpx_eq_u32 vcc, s65, v121
    v_cmpx_eq_u32 vcc, s65, v123
    v_cmpx_eq_u32 vcc, s65, v125
    v_cmpx_eq_u32 vcc, s65, v127
    s_not_b64 vcc, exec
    s_mov_b64 exec, -1
    s_cselect_b32 s73, 1, 0
    v_lshl_or_b32 v160, v96, 16, 0
    v_and_or_b32 v161, v96, s77, 1
    v_lshl_or_b32 v162, v98, 16, 2
    v_max3_u32 v76, v160, v161, v162
    v_med3_u32 v77, v160, v161, v162
    v_min3_u32 v78, v160, v161, v162
    v_and_or_b32 v163, v98, s77, 3
    v_med3_u32 v78, v77, v78, v163
    v_med3_u32 v77, v76, v77, v163
    v_max_u32 v76, v76, v163
    v_lshl_or_b32 v164, v100, 16, 4
    v_med3_u32 v78, v77, v78, v164
    v_med3_u32 v77, v76, v77, v164
    v_max_u32 v76, v76, v164
    v_and_or_b32 v165, v100, s77, 5
    v_med3_u32 v78, v77, v78, v165
    v_med3_u32 v77, v76, v77, v165
    v_max_u32 v76, v76, v165
    s_waitcnt vmcnt(16)
    s_barrier
    ds_read_b64_tr_b16 v[52:53], v24 offset:32768
    ds_read_b64_tr_b16 v[54:55], v24 offset:33792
    ds_read_b64_tr_b16 v[56:57], v24 offset:32800
    ds_read_b64_tr_b16 v[58:59], v24 offset:33824
    s_waitcnt lgkmcnt(4)
    v_mfma_f32_16x16x32_bf16 v[32:35], v[48:51], v[60:63], v[32:35]
    v_mfma_f32_16x16x32_bf16 v[36:39], v[48:51], v[64:67], v[36:39]
    ds_read_b64_tr_b16 v[60:61], v24 offset:40960
    ds_read_b64_tr_b16 v[62:63], v24 offset:41984
    ds_read_b64_tr_b16 v[64:65], v24 offset:40992
    ds_read_b64_tr_b16 v[66:67], v24 offset:42016
    s_mov_b32 s78, 0xffff0000
    s_mov_b32 s79, 0
    v_mov_b32 v8, 1
    v_mov_b32 v41, 0
    s_waitcnt lgkmcnt(4)
    v_mfma_f32_16x16x32_bf16 v[32:35], v[48:51], v[52:55], v[32:35]
    v_mfma_f32_16x16x32_bf16 v[36:39], v[48:51], v[56:59], v[36:39]
    s_waitcnt lgkmcnt(0)
    v_mfma_f32_16x16x32_bf16 v[32:35], v[48:51], v[60:63], v[32:35]
    v_mfma_f32_16x16x32_bf16 v[36:39], v[48:51], v[64:67], v[36:39]
    s_barrier
    s_mov_b32 exec_hi, 0
    s_nop 6
    v_cndmask_b32_e64 v40, v32, v36, s[78:79]
    v_cvt_pk_bf16_f32 v42, v40, v40
    v_lshlrev_b32 v42, 16, v42
    v_sub_f32 v42, v40, v42
    v_cvt_pk_bf16_f32 v40, v40, v42
    ds_write_b64 v30, v[40:41] offset:12288
    ds_write_b32 v23, v8 offset:16
    s_mov_b32 exec_hi, -1
    s_branch L_moe
L_loader7:
    s_add_u32 m0, s71, 0
    s_nop 0
    buffer_load_dwordx4 v10, s[28:31], s52 offen offset:0 lds
    buffer_load_dwordx4 v11, s[28:31], s52 offen offset:1024 lds
    s_add_u32 m0, s72, 0
    s_nop 0
    buffer_load_dwordx4 v12, s[32:35], s36 offen offset:0 lds
    buffer_load_dwordx4 v13, s[32:35], s36 offen offset:1024 lds
    s_add_u32 m0, s72, 8192
    s_nop 0
    buffer_load_dwordx4 v14, s[32:35], s36 offen offset:0 lds
    buffer_load_dwordx4 v15, s[32:35], s36 offen offset:1024 lds
    s_add_u32 s75, s64, 1
    s_and_b32 s75, s75, 7
    s_mul_i32 s37, s75, 196608
    s_lshl_b32 s75, s75, 7
    s_add_u32 s53, s75, s69
    s_add_u32 m0, s71, 8192
    s_nop 0
    buffer_load_dwordx4 v10, s[28:31], s53 offen offset:0 lds
    buffer_load_dwordx4 v11, s[28:31], s53 offen offset:1024 lds
    s_add_u32 m0, s72, 16384
    s_nop 0
    buffer_load_dwordx4 v12, s[32:35], s37 offen offset:0 lds
    buffer_load_dwordx4 v13, s[32:35], s37 offen offset:1024 lds
    s_add_u32 m0, s72, 24576
    s_nop 0
    buffer_load_dwordx4 v14, s[32:35], s37 offen offset:0 lds
    buffer_load_dwordx4 v15, s[32:35], s37 offen offset:1024 lds
    s_mov_b32 s40, s24
    s_and_b32 s41, s25, 0xffff
    s_mov_b32 s42, 25165824
    s_mov_b32 s43, 0x00020000
    s_lshl_b32 s79, s70, 2
    v_add_u32 v23, s79, v2
    v_bfe_u32 v31, v1, 2, 2
    v_lshl_add_u32 v21, v4, 3, v31
    v_xor_b32 v22, s70, v31
    v_lshlrev_b32 v22, 6, v22
    v_lshl_add_u32 v22, v6, 3, v22
    v_lshl_add_u32 v22, v21, 8, v22
    v_add_u32 v24, 65536, v22
    v_add_u32 v25, 131072, v22
    s_lshl_b32 s78, s70, 8
    v_lshl_add_u32 v30, v1, 3, v2
    v_add_u32 v30, s78, v30
    v_mov_b32 v48, s66
    v_mov_b32 v49, s66
    v_mov_b32 v50, s66
    v_mov_b32 v51, s66
    s_waitcnt vmcnt(8)
    s_barrier
    s_add_u32 s75, s64, 2
    s_and_b32 s75, s75, 7
    s_mul_i32 s38, s75, 196608
    s_lshl_b32 s75, s75, 7
    s_add_u32 s54, s75, s69
    s_add_u32 m0, s71, 16384
    s_nop 0
    buffer_load_dwordx4 v10, s[28:31], s54 offen offset:0 lds
    buffer_load_dwordx4 v11, s[28:31], s54 offen offset:1024 lds
    s_add_u32 m0, s72, 32768
    s_nop 0
    buffer_load_dwordx4 v12, s[32:35], s38 offen offset:0 lds
    buffer_load_dwordx4 v13, s[32:35], s38 offen offset:1024 lds
    ds_read_b64_tr_b16 v[52:53], v24 offset:0
    ds_read_b64_tr_b16 v[54:55], v24 offset:1024
    ds_read_b64_tr_b16 v[56:57], v24 offset:32
    ds_read_b64_tr_b16 v[58:59], v24 offset:1056
    s_waitcnt vmcnt(10)
    s_barrier
    s_add_u32 m0, s72, 40960
    s_nop 0
    buffer_load_dwordx4 v14, s[32:35], s38 offen offset:0 lds
    buffer_load_dwordx4 v15, s[32:35], s38 offen offset:1024 lds
    s_waitcnt lgkmcnt(0)
    v_mfma_f32_16x16x32_bf16 v[32:35], v[48:51], v[52:55], 0
    v_mfma_f32_16x16x32_bf16 v[36:39], v[48:51], v[56:59], 0
    ds_read_b64_tr_b16 v[60:61], v24 offset:8192
    ds_read_b64_tr_b16 v[62:63], v24 offset:9216
    ds_read_b64_tr_b16 v[64:65], v24 offset:8224
    ds_read_b64_tr_b16 v[66:67], v24 offset:9248
    s_waitcnt vmcnt(8)
    s_barrier
    s_add_u32 s75, s64, 3
    s_and_b32 s75, s75, 7
    s_mul_i32 s39, s75, 196608
    s_lshl_b32 s75, s75, 7
    s_add_u32 s55, s75, s69
    s_add_u32 m0, s71, 24576
    s_nop 0
    buffer_load_dwordx4 v10, s[28:31], s55 offen offset:0 lds
    buffer_load_dwordx4 v11, s[28:31], s55 offen offset:1024 lds
    s_add_u32 m0, s72, 49152
    s_nop 0
    buffer_load_dwordx4 v12, s[32:35], s39 offen offset:0 lds
    buffer_load_dwordx4 v13, s[32:35], s39 offen offset:1024 lds
    s_waitcnt lgkmcnt(0)
    v_mfma_f32_16x16x32_bf16 v[32:35], v[48:51], v[60:63], v[32:35]
    v_mfma_f32_16x16x32_bf16 v[36:39], v[48:51], v[64:67], v[36:39]
    ds_read_b64_tr_b16 v[52:53], v24 offset:16384
    ds_read_b64_tr_b16 v[54:55], v24 offset:17408
    ds_read_b64_tr_b16 v[56:57], v24 offset:16416
    ds_read_b64_tr_b16 v[58:59], v24 offset:17440
    s_waitcnt vmcnt(10)
    s_barrier
    s_add_u32 m0, s72, 57344
    s_nop 0
    buffer_load_dwordx4 v14, s[32:35], s39 offen offset:0 lds
    buffer_load_dwordx4 v15, s[32:35], s39 offen offset:1024 lds
    s_waitcnt lgkmcnt(0)
    v_mfma_f32_16x16x32_bf16 v[32:35], v[48:51], v[52:55], v[32:35]
    v_mfma_f32_16x16x32_bf16 v[36:39], v[48:51], v[56:59], v[36:39]
    ds_read_b64_tr_b16 v[60:61], v24 offset:24576
    ds_read_b64_tr_b16 v[62:63], v24 offset:25600
    ds_read_b64_tr_b16 v[64:65], v24 offset:24608
    ds_read_b64_tr_b16 v[66:67], v24 offset:25632
    s_waitcnt vmcnt(8)
    s_barrier
    s_add_u32 s75, s64, 4
    s_and_b32 s75, s75, 7
    s_mul_i32 s44, s75, 196608
    s_lshl_b32 s75, s75, 7
    s_add_u32 s56, s75, s69
    s_add_u32 m0, s71, 32768
    s_nop 0
    buffer_load_dwordx4 v10, s[28:31], s56 offen offset:0 lds
    buffer_load_dwordx4 v11, s[28:31], s56 offen offset:1024 lds
    s_add_u32 m0, s72, 65536
    s_nop 0
    buffer_load_dwordx4 v12, s[32:35], s44 offen offset:0 lds
    buffer_load_dwordx4 v13, s[32:35], s44 offen offset:1024 lds
    s_waitcnt lgkmcnt(0)
    v_mfma_f32_16x16x32_bf16 v[32:35], v[48:51], v[60:63], v[32:35]
    v_mfma_f32_16x16x32_bf16 v[36:39], v[48:51], v[64:67], v[36:39]
    ds_read_b64_tr_b16 v[52:53], v24 offset:32768
    ds_read_b64_tr_b16 v[54:55], v24 offset:33792
    ds_read_b64_tr_b16 v[56:57], v24 offset:32800
    ds_read_b64_tr_b16 v[58:59], v24 offset:33824
    s_waitcnt vmcnt(10)
    s_barrier
    s_add_u32 m0, s72, 73728
    s_nop 0
    buffer_load_dwordx4 v14, s[32:35], s44 offen offset:0 lds
    buffer_load_dwordx4 v15, s[32:35], s44 offen offset:1024 lds
    s_waitcnt lgkmcnt(0)
    v_mfma_f32_16x16x32_bf16 v[32:35], v[48:51], v[52:55], v[32:35]
    v_mfma_f32_16x16x32_bf16 v[36:39], v[48:51], v[56:59], v[36:39]
    ds_read_b64_tr_b16 v[60:61], v24 offset:40960
    ds_read_b64_tr_b16 v[62:63], v24 offset:41984
    ds_read_b64_tr_b16 v[64:65], v24 offset:40992
    ds_read_b64_tr_b16 v[66:67], v24 offset:42016
    s_waitcnt vmcnt(8)
    s_barrier
    s_add_u32 s75, s64, 5
    s_and_b32 s75, s75, 7
    s_mul_i32 s45, s75, 196608
    s_lshl_b32 s75, s75, 7
    s_add_u32 s57, s75, s69
    s_add_u32 m0, s71, 40960
    s_nop 0
    buffer_load_dwordx4 v10, s[28:31], s57 offen offset:0 lds
    buffer_load_dwordx4 v11, s[28:31], s57 offen offset:1024 lds
    s_add_u32 m0, s72, 0
    s_nop 0
    buffer_load_dwordx4 v12, s[32:35], s45 offen offset:0 lds
    buffer_load_dwordx4 v13, s[32:35], s45 offen offset:1024 lds
    s_waitcnt lgkmcnt(0)
    v_mfma_f32_16x16x32_bf16 v[32:35], v[48:51], v[60:63], v[32:35]
    v_mfma_f32_16x16x32_bf16 v[36:39], v[48:51], v[64:67], v[36:39]
    ds_read_b64_tr_b16 v[52:53], v24 offset:49152
    ds_read_b64_tr_b16 v[54:55], v24 offset:50176
    ds_read_b64_tr_b16 v[56:57], v24 offset:49184
    ds_read_b64_tr_b16 v[58:59], v24 offset:50208
    s_waitcnt vmcnt(10)
    s_barrier
    s_add_u32 m0, s72, 8192
    s_nop 0
    buffer_load_dwordx4 v14, s[32:35], s45 offen offset:0 lds
    buffer_load_dwordx4 v15, s[32:35], s45 offen offset:1024 lds
    s_waitcnt lgkmcnt(0)
    v_mfma_f32_16x16x32_bf16 v[32:35], v[48:51], v[52:55], v[32:35]
    v_mfma_f32_16x16x32_bf16 v[36:39], v[48:51], v[56:59], v[36:39]
    ds_read_b64_tr_b16 v[60:61], v24 offset:57344
    ds_read_b64_tr_b16 v[62:63], v24 offset:58368
    ds_read_b64_tr_b16 v[64:65], v24 offset:57376
    ds_read_b64_tr_b16 v[66:67], v24 offset:58400
    s_waitcnt vmcnt(8)
    s_barrier
    s_add_u32 s75, s64, 6
    s_and_b32 s75, s75, 7
    s_mul_i32 s46, s75, 196608
    s_lshl_b32 s75, s75, 7
    s_add_u32 s58, s75, s69
    s_add_u32 m0, s71, 49152
    s_nop 0
    buffer_load_dwordx4 v10, s[28:31], s58 offen offset:0 lds
    buffer_load_dwordx4 v11, s[28:31], s58 offen offset:1024 lds
    s_add_u32 m0, s72, 16384
    s_nop 0
    buffer_load_dwordx4 v12, s[32:35], s46 offen offset:0 lds
    buffer_load_dwordx4 v13, s[32:35], s46 offen offset:1024 lds
    s_waitcnt lgkmcnt(0)
    v_mfma_f32_16x16x32_bf16 v[32:35], v[48:51], v[60:63], v[32:35]
    v_mfma_f32_16x16x32_bf16 v[36:39], v[48:51], v[64:67], v[36:39]
    ds_read_b64_tr_b16 v[52:53], v25 offset:0
    ds_read_b64_tr_b16 v[54:55], v25 offset:1024
    ds_read_b64_tr_b16 v[56:57], v25 offset:32
    ds_read_b64_tr_b16 v[58:59], v25 offset:1056
    s_waitcnt vmcnt(10)
    s_barrier
    s_add_u32 m0, s72, 24576
    s_nop 0
    buffer_load_dwordx4 v14, s[32:35], s46 offen offset:0 lds
    buffer_load_dwordx4 v15, s[32:35], s46 offen offset:1024 lds
    s_add_u32 s75, s64, 7
    s_and_b32 s75, s75, 7
    s_mul_i32 s47, s75, 196608
    s_lshl_b32 s75, s75, 7
    s_add_u32 s59, s75, s69
    s_add_u32 m0, s71, 57344
    s_nop 0
    buffer_load_dwordx4 v10, s[28:31], s59 offen offset:0 lds
    buffer_load_dwordx4 v11, s[28:31], s59 offen offset:1024 lds
    s_add_u32 m0, s72, 32768
    s_nop 0
    buffer_load_dwordx4 v12, s[32:35], s47 offen offset:0 lds
    buffer_load_dwordx4 v13, s[32:35], s47 offen offset:1024 lds
    s_waitcnt lgkmcnt(0)
    v_mfma_f32_16x16x32_bf16 v[32:35], v[48:51], v[52:55], v[32:35]
    v_mfma_f32_16x16x32_bf16 v[36:39], v[48:51], v[56:59], v[36:39]
    ds_read_b64_tr_b16 v[60:61], v25 offset:8192
    ds_read_b64_tr_b16 v[62:63], v25 offset:9216
    ds_read_b64_tr_b16 v[64:65], v25 offset:8224
    ds_read_b64_tr_b16 v[66:67], v25 offset:9248
    s_waitcnt vmcnt(12)
    s_barrier
    s_add_u32 m0, s72, 40960
    s_nop 0
    buffer_load_dwordx4 v14, s[32:35], s47 offen offset:0 lds
    buffer_load_dwordx4 v15, s[32:35], s47 offen offset:1024 lds
    s_waitcnt lgkmcnt(0)
    v_mfma_f32_16x16x32_bf16 v[32:35], v[48:51], v[60:63], v[32:35]
    v_mfma_f32_16x16x32_bf16 v[36:39], v[48:51], v[64:67], v[36:39]
    ds_read_b64_tr_b16 v[52:53], v24 offset:0
    ds_read_b64_tr_b16 v[54:55], v24 offset:1024
    ds_read_b64_tr_b16 v[56:57], v24 offset:32
    ds_read_b64_tr_b16 v[58:59], v24 offset:1056
    s_waitcnt vmcnt(12)
    s_barrier
    s_waitcnt lgkmcnt(0)
    v_mfma_f32_16x16x32_bf16 v[32:35], v[48:51], v[52:55], v[32:35]
    v_mfma_f32_16x16x32_bf16 v[36:39], v[48:51], v[56:59], v[36:39]
    ds_read_b64_tr_b16 v[60:61], v24 offset:8192
    ds_read_b64_tr_b16 v[62:63], v24 offset:9216
    ds_read_b64_tr_b16 v[64:65], v24 offset:8224
    ds_read_b64_tr_b16 v[66:67], v24 offset:9248
    s_waitcnt vmcnt(8)
    s_barrier
    s_waitcnt lgkmcnt(0)
    v_mfma_f32_16x16x32_bf16 v[32:35], v[48:51], v[60:63], v[32:35]
    v_mfma_f32_16x16x32_bf16 v[36:39], v[48:51], v[64:67], v[36:39]
    ds_read_b64_tr_b16 v[52:53], v24 offset:16384
    ds_read_b64_tr_b16 v[54:55], v24 offset:17408
    ds_read_b64_tr_b16 v[56:57], v24 offset:16416
    ds_read_b64_tr_b16 v[58:59], v24 offset:17440
    s_waitcnt vmcnt(6)
    s_barrier
    s_waitcnt lgkmcnt(0)
    v_mfma_f32_16x16x32_bf16 v[32:35], v[48:51], v[52:55], v[32:35]
    v_mfma_f32_16x16x32_bf16 v[36:39], v[48:51], v[56:59], v[36:39]
    ds_read_b64_tr_b16 v[60:61], v24 offset:24576
    ds_read_b64_tr_b16 v[62:63], v24 offset:25600
    ds_read_b64_tr_b16 v[64:65], v24 offset:24608
    ds_read_b64_tr_b16 v[66:67], v24 offset:25632
    s_waitcnt vmcnt(0)
    s_barrier
    ds_read_b64_tr_b16 v[52:53], v24 offset:32768
    ds_read_b64_tr_b16 v[54:55], v24 offset:33792
    ds_read_b64_tr_b16 v[56:57], v24 offset:32800
    ds_read_b64_tr_b16 v[58:59], v24 offset:33824
    s_waitcnt lgkmcnt(4)
    v_mfma_f32_16x16x32_bf16 v[32:35], v[48:51], v[60:63], v[32:35]
    v_mfma_f32_16x16x32_bf16 v[36:39], v[48:51], v[64:67], v[36:39]
    ds_read_b64_tr_b16 v[60:61], v24 offset:40960
    ds_read_b64_tr_b16 v[62:63], v24 offset:41984
    ds_read_b64_tr_b16 v[64:65], v24 offset:40992
    ds_read_b64_tr_b16 v[66:67], v24 offset:42016
    s_mov_b32 s78, 0xffff0000
    s_mov_b32 s79, 0
    v_mov_b32 v8, 1
    v_mov_b32 v41, 0
    s_waitcnt lgkmcnt(4)
    v_mfma_f32_16x16x32_bf16 v[32:35], v[48:51], v[52:55], v[32:35]
    v_mfma_f32_16x16x32_bf16 v[36:39], v[48:51], v[56:59], v[36:39]
    s_waitcnt lgkmcnt(0)
    v_mfma_f32_16x16x32_bf16 v[32:35], v[48:51], v[60:63], v[32:35]
    v_mfma_f32_16x16x32_bf16 v[36:39], v[48:51], v[64:67], v[36:39]
    s_barrier
    s_mov_b32 exec_hi, 0
    s_nop 6
    v_cndmask_b32_e64 v40, v32, v36, s[78:79]
    v_cvt_pk_bf16_f32 v42, v40, v40
    v_lshlrev_b32 v42, 16, v42
    v_sub_f32 v42, v40, v42
    v_cvt_pk_bf16_f32 v40, v40, v42
    ds_write_b64 v30, v[40:41] offset:12288
    ds_write_b32 v23, v8 offset:16
    s_mov_b32 exec_hi, -1
    s_mov_b32 s67, 0
TG_3:
    ds_read_b64 v[6:7], v2 offset:48
    s_waitcnt lgkmcnt(0)
    v_readfirstlane_b32 s68, v7
    v_readfirstlane_b32 s65, v6
    s_cmp_lg_u32 s68, 0
    s_cbranch_scc1 TD_4
    s_add_u32 s67, s67, 1
    s_cmp_lt_u32 s67, 4194304
    s_cbranch_scc1 TG_3
TD_4:
    s_branch L_aux7
L_main:
    s_and_b32 s70, s3, 1
    s_lshr_b32 s71, s3, 1
    v_and_b32 v8, 31, v1
    v_lshrrev_b32 v9, 5, v1
    v_lshlrev_b32 v28, 4, v8
    v_lshl_add_u32 v29, v9, 10, v28
    v_mov_b32 v30, 0
    s_lshl_b32 s58, s26, 6
    s_lshl_b32 s59, s27, 3
    s_add_u32 s58, s58, s59
    s_lshl_b32 s59, s3, 1
    s_add_u32 s58, s58, s59
    s_lshl_b32 s59, s58, 10
    s_waitcnt lgkmcnt(0)
    s_mov_b32 s28, s4
    s_and_b32 s29, s5, 0xffff
    s_mov_b32 s30, 2097152
    s_mov_b32 s31, 0x00020000
    buffer_load_dwordx4 v[32:35], v29, s[28:31], s59 offen
    buffer_load_dwordx4 v[36:39], v29, s[28:31], s59 offen offset:512
    s_mov_b32 s48, s12
    s_and_b32 s49, s13, 0xffff
    s_mov_b32 s50, 1024
    s_mov_b32 s51, 0x00020000
    buffer_load_dwordx4 v[40:43], v28, s[48:51], 0 offen
    buffer_load_dwordx4 v[44:47], v28, s[48:51], 0 offen offset:512
    s_mov_b32 s40, s24
    s_and_b32 s41, s25, 0xffff
    s_mov_b32 s42, 25165824
    s_mov_b32 s43, 0x00020000
    buffer_load_dword v26, v30, s[40:43], 0 offen offset:0 sc1
    s_lshl_b32 s73, s70, 5
    v_add_u32 v60, s73, v8
    v_lshlrev_b32 v60, 7, v60
    v_bfe_u32 v61, v8, 1, 3
    v_xor_b32 v61, v61, v9
    s_lshl_b32 s73, s70, 1
    v_xor_b32 v61, s73, v61
    v_xor_b32 v62, 0, v61
    v_lshl_add_u32 v10, v62, 4, v60
    v_xor_b32 v62, 2, v61
    v_lshl_add_u32 v11, v62, 4, v60
    v_xor_b32 v62, 4, v61
    v_lshl_add_u32 v12, v62, 4, v60
    v_xor_b32 v62, 6, v61
    v_lshl_add_u32 v13, v62, 4, v60
    v_bfe_u32 v60, v1, 2, 2
    v_and_b32 v61, 3, v1
    v_bfe_u32 v62, v1, 4, 1
    v_lshlrev_b32 v61, 3, v61
    v_lshl_add_u32 v61, v62, 5, v61
    v_lshl_add_u32 v62, v9, 3, v60
    v_xor_b32 v63, s71, v60
    v_lshl_add_u32 v63, v63, 6, v61
    v_lshl_add_u32 v63, v62, 8, v63
    s_lshl_b32 s73, s70, 12
    s_add_u32 s73, s73, 65536
    v_add_u32 v14, s73, v63
    v_xor_b32 v16, 0x1000, v14
    v_add_u32 v15, 0x10000, v14
    v_add_u32 v17, 0x10000, v16
    v_xor_b32 v18, 128, v14
    v_xor_b32 v19, 128, v15
    v_xor_b32 v20, 128, v16
    v_xor_b32 v21, 128, v17
    v_lshrrev_b32 v63, 1, v60
    v_xor_b32 v63, s71, v63
    v_lshl_add_u32 v63, v63, 6, v61
    v_lshl_add_u32 v63, v62, 7, v63
    s_lshl_b32 s73, s70, 11
    s_add_u32 s73, s73, 65536
    v_add_u32 v22, s73, v63
    v_xor_b32 v24, 0x800, v22
    v_add_u32 v23, 0x10000, v22
    v_add_u32 v25, 0x10000, v24
    s_lshl_b32 s73, s71, 8
    v_lshl_add_u32 v27, v8, 3, v2
    v_lshl_add_u32 v27, v9, 2, v27
    v_add_u32 v27, s73, v27
    s_lshl_b32 s74, s26, 9
    s_lshl_b32 s73, s70, 8
    s_add_u32 s74, s74, s73
    s_add_u32 s74, s74, 49152
    v_lshlrev_b32 v3, 3, v8
    s_lshl_b32 s62, s26, 16
    s_lshl_b32 s73, s27, 7
    s_add_u32 s62, s62, s73
    s_lshl_b32 s73, s3, 5
    s_add_u32 s62, s62, s73
    s_add_u32 s101, s62, 32768
    s_lshl_b32 s72, s71, 12
    s_lshl_b32 s73, s70, 10
    s_add_u32 s72, s72, s73
    v_lshlrev_b32 v112, 4, v1
    v_add_u32 v116, s72, v112
    v_bfe_u32 v114, v1, 4, 1
    v_and_b32 v113, 15, v1
    v_lshlrev_b32 v113, 4, v113
    v_lshl_add_u32 v117, v9, 8, v113
    v_lshl_add_u32 v115, v114, 11, v117
    v_add_u32 v115, s72, v115
    v_lshl_add_u32 v114, v114, 16, v113
    v_lshl_add_u32 v114, v9, 9, v114
    v_and_b32 v113, 60, v1
    s_lshl_b32 s72, s27, 18
    s_lshl_b32 s75, s71, 17
    s_add_u32 s72, s72, s75
    s_lshl_b32 s75, s26, 11
    s_add_u32 s72, s72, s75
    s_add_u32 s72, s72, s73
    s_add_u32 s54, s72, 4194304
    s_add_u32 s55, s72, 4259840
    s_lshr_b32 s75, s72, 4
    s_add_u32 s56, s72, 8388608
    s_add_u32 s57, s75, 1572864
    s_add_u32 s61, s75, 1576960
    s_lshl_b32 s100, s27, 2
    s_add_u32 s100, s100, s3
    s_lshl_b32 s36, s100, 12
    s_lshl_b32 s68, s26, 7
    s_add_u32 s36, s36, s68
    s_add_u32 s36, s36, 1572352
    s_lshl_b32 s100, s100, 16
    s_add_u32 s100, s100, 4194304
    s_add_i32 s68, s26, -4
    s_max_i32 s68, s68, 0
    s_lshl_b32 s69, s68, 11
    s_add_u32 s32, s69, s100
    s_add_i32 s68, s26, -3
    s_max_i32 s68, s68, 0
    s_lshl_b32 s69, s68, 11
    s_add_u32 s33, s69, s100
    s_add_i32 s68, s26, -2
    s_max_i32 s68, s68, 0
    s_lshl_b32 s69, s68, 11
    s_add_u32 s34, s69, s100
    s_add_i32 s68, s26, -1
    s_max_i32 s68, s68, 0
    s_lshl_b32 s69, s68, 11
    s_add_u32 s35, s69, s100
    v_mov_b32 v121, 0
    v_mov_b32 v122, 0
    v_mov_b32 v123, 0
    v_mov_b32 v125, 0
    v_mov_b32 v126, 0
    v_mov_b32 v127, 0
    v_mov_b32 v48, 0
    v_mov_b32 v49, 0
    v_mov_b32 v50, 0
    v_mov_b32 v51, 0
    s_waitcnt vmcnt(1)
    v_dot2c_f32_bf16 v48, s66, v32
    v_dot2c_f32_bf16 v49, v32, v32
    v_dot2c_f32_bf16 v50, v32, v40
    v_dot2c_f32_bf16 v51, s66, v40
    v_dot2c_f32_bf16 v48, s66, v33
    v_dot2c_f32_bf16 v49, v33, v33
    v_dot2c_f32_bf16 v50, v33, v41
    v_dot2c_f32_bf16 v51, s66, v41
    v_dot2c_f32_bf16 v48, s66, v34
    v_dot2c_f32_bf16 v49, v34, v34
    v_dot2c_f32_bf16 v50, v34, v42
    v_dot2c_f32_bf16 v51, s66, v42
    v_dot2c_f32_bf16 v48, s66, v35
    v_dot2c_f32_bf16 v49, v35, v35
    v_dot2c_f32_bf16 v50, v35, v43
    v_dot2c_f32_bf16 v51, s66, v43
    v_dot2c_f32_bf16 v48, s66, v36
    v_dot2c_f32_bf16 v49, v36, v36
    v_dot2c_f32_bf16 v50, v36, v44
    v_dot2c_f32_bf16 v51, s66, v44
    v_dot2c_f32_bf16 v48, s66, v37
    v_dot2c_f32_bf16 v49, v37, v37
    v_dot2c_f32_bf16 v50, v37, v45
    v_dot2c_f32_bf16 v51, s66, v45
    v_dot2c_f32_bf16 v48, s66, v38
    v_dot2c_f32_bf16 v49, v38, v38
    v_dot2c_f32_bf16 v50, v38, v46
    v_dot2c_f32_bf16 v51, s66, v46
    v_dot2c_f32_bf16 v48, s66, v39
    v_dot2c_f32_bf16 v49, v39, v39
    v_dot2c_f32_bf16 v50, v39, v47
    v_dot2c_f32_bf16 v51, s66, v47
    s_nop 1
    v_add_f32_dpp v48, v48, v48 quad_perm:[1,0,3,2] row_mask:0xf bank_mask:0xf
    v_add_f32_dpp v49, v49, v49 quad_perm:[1,0,3,2] row_mask:0xf bank_mask:0xf
    v_add_f32_dpp v50, v50, v50 quad_perm:[1,0,3,2] row_mask:0xf bank_mask:0xf
    v_add_f32_dpp v51, v51, v51 quad_perm:[1,0,3,2] row_mask:0xf bank_mask:0xf
    v_add_f32_dpp v48, v48, v48 quad_perm:[2,3,0,1] row_mask:0xf bank_mask:0xf
    v_add_f32_dpp v49, v49, v49 quad_perm:[2,3,0,1] row_mask:0xf bank_mask:0xf
    v_add_f32_dpp v50, v50, v50 quad_perm:[2,3,0,1] row_mask:0xf bank_mask:0xf
    v_add_f32_dpp v51, v51, v51 quad_perm:[2,3,0,1] row_mask:0xf bank_mask:0xf
    v_add_f32_dpp v48, v48, v48 row_half_mirror row_mask:0xf bank_mask:0xf
    v_add_f32_dpp v49, v49, v49 row_half_mirror row_mask:0xf bank_mask:0xf
    v_add_f32_dpp v50, v50, v50 row_half_mirror row_mask:0xf bank_mask:0xf
    v_add_f32_dpp v51, v51, v51 row_half_mirror row_mask:0xf bank_mask:0xf
    v_add_f32_dpp v48, v48, v48 row_mirror row_mask:0xf bank_mask:0xf
    v_add_f32_dpp v49, v49, v49 row_mirror row_mask:0xf bank_mask:0xf
    v_add_f32_dpp v50, v50, v50 row_mirror row_mask:0xf bank_mask:0xf
    v_add_f32_dpp v51, v51, v51 row_mirror row_mask:0xf bank_mask:0xf
    v_mov_b32 v52, v48
    v_mov_b32 v53, v49
    v_mov_b32 v54, v50
    v_mov_b32 v55, v51
    s_nop 0
    v_permlane16_swap_b32 v48, v52
    v_permlane16_swap_b32 v49, v53
    v_permlane16_swap_b32 v50, v54
    v_permlane16_swap_b32 v51, v55
    v_add_f32 v48, v48, v52
    v_add_f32 v49, v49, v53
    v_add_f32 v50, v50, v54
    v_add_f32 v51, v51, v55
    v_mul_f32 v52, 0x3b000000, v48
    v_mul_f32 v53, 0x3b000000, v49
    v_fma_f32 v53, -v52, v52, v53
    v_max_f32 v53, 0, v53
    v_cvt_pk_bf16_f32 v54, v52, v52
    v_lshlrev_b32 v52, 16, v54
    v_cvt_pk_bf16_f32 v54, v53, v53
    v_lshlrev_b32 v53, 16, v54
    v_add_f32 v53, 0x3727c5ac, v53
    v_cvt_pk_bf16_f32 v54, v53, v53
    v_lshlrev_b32 v53, 16, v54
    v_sqrt_f32 v53, v53
    s_nop 0
    v_cvt_pk_bf16_f32 v54, v53, v53
    v_lshlrev_b32 v53, 16, v54
    v_mov_b32 v58, v53
    v_rcp_f32 v53, v53
    s_nop 0
    v_fma_f32 v50, -v52, v51, v50
    v_mul_f32 v50, v50, v53
    v_cvt_pk_bf16_f32 v54, v50, v50
    v_lshlrev_b32 v54, 16, v54
    v_ashrrev_i32 v55, 31, v54
    v_or_b32 v55, 0x80000000, v55
    v_xor_b32 v54, v54, v55
    v_lshrrev_b32 v52, 16, v52
    v_or_b32 v58, v58, v52
    v_lshlrev_b32 v60, 3, v9
    s_waitcnt vmcnt(0)
    v_readlane_b32 s59, v54, 0
    v_readlane_b32 s60, v54, 32
    v_readfirstlane_b32 s65, v26
    s_lshr_b32 s59, s59, 16
    s_and_b32 s60, s60, 0xffff0000
    s_or_b32 s59, s59, s60
    s_add_u32 s65, s65, 2654435769
    s_lshl_b32 s60, s58, 3
    s_add_u32 s60, s60, 49152
    s_lshl_b32 s58, s58, 2
    s_add_u32 s58, s58, 4096
    v_mov_b32 v54, s59
    v_mov_b32 v55, s65
    v_mov_b32 v56, s65
    v_mov_b32 v57, 1
    v_mov_b32 v59, s65
    s_mov_b32 exec_lo, 1
    s_mov_b32 exec_hi, 1
    buffer_store_dwordx2 v[58:59], v60, s[40:43], s60 offen sc1
    s_mov_b64 exec, 1
    buffer_store_dwordx2 v[54:55], v30, s[40:43], s58 offen sc1
    s_cmp_lg_u32 s3, 0
    s_cbranch_scc1 L_nt
    ds_write_b64 v2, v[56:57] offset:48
L_nt:
    s_mov_b64 exec, -1
    s_lshl_b32 s68, s27, 5
    s_add_u32 s68, s68, s26
    s_lshl_b32 s68, s68, 8
    s_add_u32 s68, s68, 1048576
    s_lshl_b32 s69, s26, 3
    s_add_u32 s69, s69, s27
    s_lshl_b32 s69, s69, 10
    s_add_u32 s69, s69, 1310720
    v_lshlrev_b32 v60, 7, v1
    s_cmp_eq_u32 s3, 0
    s_cselect_b32 s68, s68, s69
    s_cselect_b32 s69, 3, 0xff
    s_cmp_lt_u32 s3, 2
    s_cbranch_scc0 L_fw
    s_mov_b32 exec_hi, 0
    s_mov_b32 exec_lo, s69
    buffer_atomic_or v30, v60, s[40:43], s68 offen sc1
    s_mov_b64 exec, -1
L_fw:
    v_mov_b32 v29, 0
    v_mov_b32 v30, 0
    v_mov_b32 v31, 0
    s_barrier
    ds_read_b64_tr_b16 v[80:81], v14 offset:0
    ds_read_b64_tr_b16 v[82:83], v14 offset:1024
    ds_read_b128 v[128:131], v10 offset:0
    ds_read_b64_tr_b16 v[84:85], v18 offset:0
    ds_read_b64_tr_b16 v[86:87], v18 offset:1024
    ds_read_b64_tr_b16 v[88:89], v16 offset:0
    ds_read_b64_tr_b16 v[90:91], v16 offset:1024
    ds_read_b128 v[132:135], v11 offset:0
    ds_read_b64_tr_b16 v[92:93], v20 offset:0
    ds_read_b64_tr_b16 v[94:95], v20 offset:1024
    s_waitcnt lgkmcnt(0)
    s_barrier
    v_mfma_f32_32x32x16_bf16 v[32:47], v[80:83], v[128:131], 0
    ds_read_b64_tr_b16 v[96:97], v14 offset:8192
    ds_read_b64_tr_b16 v[98:99], v14 offset:9216
    ds_read_b128 v[136:139], v12 offset:0
    ds_read_b64_tr_b16 v[100:101], v18 offset:8192
    v_mfma_f32_32x32x16_bf16 v[48:63], v[128:131], v[84:87], 0
    ds_read_b64_tr_b16 v[102:103], v18 offset:9216
    ds_read_b64_tr_b16 v[104:105], v16 offset:8192
    ds_read_b64_tr_b16 v[106:107], v16 offset:9216
    ds_read_b128 v[140:143], v13 offset:0
    v_mfma_f32_32x32x16_bf16 v[32:47], v[88:91], v[132:135], v[32:47]
    ds_read_b64_tr_b16 v[108:109], v20 offset:8192
    ds_read_b64_tr_b16 v[110:111], v20 offset:9216
    v_mfma_f32_32x32x16_bf16 v[48:63], v[132:135], v[92:95], v[48:63]
    s_waitcnt lgkmcnt(0)
    s_barrier
    v_mfma_f32_32x32x16_bf16 v[32:47], v[96:99], v[136:139], v[32:47]
    ds_read_b64_tr_b16 v[80:81], v14 offset:16384
    ds_read_b64_tr_b16 v[82:83], v14 offset:17408
    ds_read_b128 v[144:147], v10 offset:8192
    ds_read_b64_tr_b16 v[84:85], v18 offset:16384
    ds_read_b64_tr_b16 v[86:87], v18 offset:17408
    ds_read_b64_tr_b16 v[88:89], v16 offset:16384
    v_mfma_f32_32x32x16_bf16 v[48:63], v[136:139], v[100:103], v[48:63]
    ds_read_b64_tr_b16 v[90:91], v16 offset:17408
    ds_read_b128 v[148:151], v11 offset:8192
    ds_read_b64_tr_b16 v[92:93], v20 offset:16384
    ds_read_b64_tr_b16 v[94:95], v20 offset:17408
    s_lshl_b32 s98, s27, 5
    s_add_u32 s98, s98, s26
    v_mfma_f32_32x32x16_bf16 v[32:47], v[104:107], v[140:143], v[32:47]
    s_lshl_b32 s98, s98, 1
    s_add_u32 s98, s98, s71
    s_lshl_b32 s98, s98, 5
    s_add_u32 s98, s98, s70
    s_lshl_b32 s98, s98, 2
    s_add_u32 s98, s98, 1048832
    v_mfma_f32_32x32x16_bf16 v[48:63], v[140:143], v[108:111], v[48:63]
    s_sub_u32 s63, 31, s26
    s_min_u32 s63, s63, 4
    s_bfm_b32 s63, s63, 0
    s_waitcnt lgkmcnt(0)
    s_barrier
    v_mfma_f32_32x32x16_bf16 v[32:47], v[80:83], v[144:147], v[32:47]
    ds_read_b64_tr_b16 v[96:97], v14 offset:24576
    ds_read_b64_tr_b16 v[98:99], v14 offset:25600
    ds_read_b128 v[152:155], v12 offset:8192
    ds_read_b64_tr_b16 v[100:101], v18 offset:24576
    v_mfma_f32_32x32x16_bf16 v[48:63], v[144:147], v[84:87], v[48:63]
    ds_read_b64_tr_b16 v[102:103], v18 offset:25600
    ds_read_b64_tr_b16 v[104:105], v16 offset:24576
    ds_read_b64_tr_b16 v[106:107], v16 offset:25600
    ds_read_b128 v[156:159], v13 offset:8192
    v_mfma_f32_32x32x16_bf16 v[32:47], v[88:91], v[148:151], v[32:47]
    ds_read_b64_tr_b16 v[108:109], v20 offset:24576
    ds_read_b64_tr_b16 v[110:111], v20 offset:25600
    v_mfma_f32_32x32x16_bf16 v[48:63], v[148:151], v[92:95], v[48:63]
    s_waitcnt lgkmcnt(0)
    s_barrier
    v_mfma_f32_32x32x16_bf16 v[32:47], v[96:99], v[152:155], v[32:47]
    ds_read_b64_tr_b16 v[80:81], v14 offset:32768
    ds_read_b64_tr_b16 v[82:83], v14 offset:33792
    ds_read_b128 v[160:163], v10 offset:16384
    ds_read_b64_tr_b16 v[84:85], v18 offset:32768
    v_mfma_f32_32x32x16_bf16 v[48:63], v[152:155], v[100:103], v[48:63]
    ds_read_b64_tr_b16 v[86:87], v18 offset:33792
    ds_read_b64_tr_b16 v[88:89], v16 offset:32768
    ds_read_b64_tr_b16 v[90:91], v16 offset:33792
    ds_read_b128 v[164:167], v11 offset:16384
    v_mfma_f32_32x32x16_bf16 v[32:47], v[104:107], v[156:159], v[32:47]
    ds_read_b64_tr_b16 v[92:93], v20 offset:32768
    ds_read_b64_tr_b16 v[94:95], v20 offset:33792
    v_mfma_f32_32x32x16_bf16 v[48:63], v[156:159], v[108:111], v[48:63]
    s_waitcnt lgkmcnt(0)
    s_barrier
    v_mfma_f32_32x32x16_bf16 v[32:47], v[80:83], v[160:163], v[32:47]
    ds_read_b64_tr_b16 v[96:97], v14 offset:40960
    ds_read_b64_tr_b16 v[98:99], v14 offset:41984
    ds_read_b128 v[168:171], v12 offset:16384
    ds_read_b64_tr_b16 v[100:101], v18 offset:40960
    v_mfma_f32_32x32x16_bf16 v[48:63], v[160:163], v[84:87], v[48:63]
    ds_read_b64_tr_b16 v[102:103], v18 offset:41984
    ds_read_b64_tr_b16 v[104:105], v16 offset:40960
    ds_read_b64_tr_b16 v[106:107], v16 offset:41984
    ds_read_b128 v[172:175], v13 offset:16384
    v_mfma_f32_32x32x16_bf16 v[32:47], v[88:91], v[164:167], v[32:47]
    ds_read_b64_tr_b16 v[108:109], v20 offset:40960
    ds_read_b64_tr_b16 v[110:111], v20 offset:41984
    v_mfma_f32_32x32x16_bf16 v[48:63], v[164:167], v[92:95], v[48:63]
    s_waitcnt lgkmcnt(0)
    s_barrier
    v_mfma_f32_32x32x16_bf16 v[32:47], v[96:99], v[168:171], v[32:47]
    ds_read_b64_tr_b16 v[80:81], v14 offset:49152
    ds_read_b64_tr_b16 v[82:83], v14 offset:50176
    ds_read_b128 v[176:179], v10 offset:24576
    ds_read_b64_tr_b16 v[84:85], v18 offset:49152
    v_mfma_f32_32x32x16_bf16 v[48:63], v[168:171], v[100:103], v[48:63]
    ds_read_b64_tr_b16 v[86:87], v18 offset:50176
    ds_read_b64_tr_b16 v[88:89], v16 offset:49152
    ds_read_b64_tr_b16 v[90:91], v16 offset:50176
    ds_read_b128 v[180:183], v11 offset:24576
    v_mfma_f32_32x32x16_bf16 v[32:47], v[104:107], v[172:175], v[32:47]
    ds_read_b64_tr_b16 v[92:93], v20 offset:49152
    ds_read_b64_tr_b16 v[94:95], v20 offset:50176
    v_mfma_f32_32x32x16_bf16 v[48:63], v[172:175], v[108:111], v[48:63]
    s_waitcnt lgkmcnt(0)
    s_barrier
    v_mfma_f32_32x32x16_bf16 v[32:47], v[80:83], v[176:179], v[32:47]
    ds_read_b64_tr_b16 v[96:97], v14 offset:57344
    ds_read_b64_tr_b16 v[98:99], v14 offset:58368
    ds_read_b128 v[184:187], v12 offset:24576
    ds_read_b64_tr_b16 v[100:101], v18 offset:57344
    v_mfma_f32_32x32x16_bf16 v[48:63], v[176:179], v[84:87], v[48:63]
    ds_read_b64_tr_b16 v[102:103], v18 offset:58368
    ds_read_b64_tr_b16 v[104:105], v16 offset:57344
    ds_read_b64_tr_b16 v[106:107], v16 offset:58368
    ds_read_b128 v[188:191], v13 offset:24576
    v_mfma_f32_32x32x16_bf16 v[32:47], v[88:91], v[180:183], v[32:47]
    ds_read_b64_tr_b16 v[108:109], v20 offset:57344
    ds_read_b64_tr_b16 v[110:111], v20 offset:58368
    v_mfma_f32_32x32x16_bf16 v[48:63], v[180:183], v[92:95], v[48:63]
    s_waitcnt lgkmcnt(0)
    s_barrier
    v_mfma_f32_32x32x16_bf16 v[32:47], v[96:99], v[184:187], v[32:47]
    ds_read_b64_tr_b16 v[80:81], v15 offset:0
    ds_read_b64_tr_b16 v[82:83], v15 offset:1024
    ds_read_b128 v[192:195], v10 offset:32768
    ds_read_b64_tr_b16 v[84:85], v19 offset:0
    v_mfma_f32_32x32x16_bf16 v[48:63], v[184:187], v[100:103], v[48:63]
    ds_read_b64_tr_b16 v[86:87], v19 offset:1024
    ds_read_b64_tr_b16 v[88:89], v17 offset:0
    ds_read_b64_tr_b16 v[90:91], v17 offset:1024
    ds_read_b128 v[196:199], v11 offset:32768
    v_mfma_f32_32x32x16_bf16 v[32:47], v[104:107], v[188:191], v[32:47]
    ds_read_b64_tr_b16 v[92:93], v21 offset:0
    ds_read_b64_tr_b16 v[94:95], v21 offset:1024
    buffer_load_dwordx2 v[4:5], v3, s[40:43], s74 offen sc1
    v_mfma_f32_32x32x16_bf16 v[48:63], v[188:191], v[108:111], v[48:63]
    s_waitcnt lgkmcnt(0)
    s_barrier
    v_mfma_f32_32x32x16_bf16 v[32:47], v[80:83], v[192:195], v[32:47]
    ds_read_b64_tr_b16 v[96:97], v15 offset:8192
    ds_read_b64_tr_b16 v[98:99], v15 offset:9216
    ds_read_b128 v[200:203], v12 offset:32768
    ds_read_b64_tr_b16 v[100:101], v19 offset:8192
    v_mfma_f32_32x32x16_bf16 v[48:63], v[192:195], v[84:87], v[48:63]
    ds_read_b64_tr_b16 v[102:103], v19 offset:9216
    ds_read_b64_tr_b16 v[104:105], v17 offset:8192
    ds_read_b64_tr_b16 v[106:107], v17 offset:9216
    ds_read_b128 v[204:207], v13 offset:32768
    v_mfma_f32_32x32x16_bf16 v[32:47], v[88:91], v[196:199], v[32:47]
    ds_read_b64_tr_b16 v[108:109], v21 offset:8192
    ds_read_b64_tr_b16 v[110:111], v21 offset:9216
    v_mfma_f32_32x32x16_bf16 v[48:63], v[196:199], v[92:95], v[48:63]
    s_waitcnt lgkmcnt(0)
    s_barrier
    v_mfma_f32_32x32x16_bf16 v[32:47], v[96:99], v[200:203], v[32:47]
    ds_read_b64_tr_b16 v[80:81], v14 offset:0
    ds_read_b64_tr_b16 v[82:83], v14 offset:1024
    ds_read_b128 v[208:211], v10 offset:40960
    ds_read_b64_tr_b16 v[84:85], v18 offset:0
    v_mfma_f32_32x32x16_bf16 v[48:63], v[200:203], v[100:103], v[48:63]
    ds_read_b64_tr_b16 v[86:87], v18 offset:1024
    ds_read_b64_tr_b16 v[88:89], v16 offset:0
    ds_read_b64_tr_b16 v[90:91], v16 offset:1024
    ds_read_b128 v[212:215], v11 offset:40960
    v_mfma_f32_32x32x16_bf16 v[32:47], v[104:107], v[204:207], v[32:47]
    ds_read_b64_tr_b16 v[92:93], v20 offset:0
    ds_read_b64_tr_b16 v[94:95], v20 offset:1024
    v_mfma_f32_32x32x16_bf16 v[48:63], v[204:207], v[108:111], v[48:63]
    s_waitcnt lgkmcnt(0)
    s_barrier
    v_mfma_f32_32x32x16_bf16 v[32:47], v[80:83], v[208:211], v[32:47]
    ds_read_b64_tr_b16 v[96:97], v14 offset:8192
    ds_read_b64_tr_b16 v[98:99], v14 offset:9216
    ds_read_b128 v[216:219], v12 offset:40960
    ds_read_b64_tr_b16 v[100:101], v18 offset:8192
    v_mfma_f32_32x32x16_bf16 v[48:63], v[208:211], v[84:87], v[48:63]
    ds_read_b64_tr_b16 v[102:103], v18 offset:9216
    ds_read_b64_tr_b16 v[104:105], v16 offset:8192
    ds_read_b64_tr_b16 v[106:107], v16 offset:9216
    ds_read_b128 v[220:223], v13 offset:40960
    v_mfma_f32_32x32x16_bf16 v[32:47], v[88:91], v[212:215], v[32:47]
    ds_read_b64_tr_b16 v[108:109], v20 offset:8192
    ds_read_b64_tr_b16 v[110:111], v20 offset:9216
    v_mfma_f32_32x32x16_bf16 v[48:63], v[212:215], v[92:95], v[48:63]
    s_waitcnt lgkmcnt(0)
    s_barrier
    v_mfma_f32_32x32x16_bf16 v[32:47], v[96:99], v[216:219], v[32:47]
    ds_read_b64_tr_b16 v[80:81], v14 offset:16384
    ds_read_b64_tr_b16 v[82:83], v14 offset:17408
    ds_read_b128 v[224:227], v10 offset:49152
    ds_read_b64_tr_b16 v[84:85], v18 offset:16384
    v_mfma_f32_32x32x16_bf16 v[48:63], v[216:219], v[100:103], v[48:63]
    ds_read_b64_tr_b16 v[86:87], v18 offset:17408
    ds_read_b64_tr_b16 v[88:89], v16 offset:16384
    ds_read_b64_tr_b16 v[90:91], v16 offset:17408
    ds_read_b128 v[228:231], v11 offset:49152
    v_mfma_f32_32x32x16_bf16 v[32:47], v[104:107], v[220:223], v[32:47]
    ds_read_b64_tr_b16 v[92:93], v20 offset:16384
    ds_read_b64_tr_b16 v[94:95], v20 offset:17408
    v_mfma_f32_32x32x16_bf16 v[48:63], v[220:223], v[108:111], v[48:63]
    s_waitcnt lgkmcnt(0)
    s_barrier
    v_mfma_f32_32x32x16_bf16 v[32:47], v[80:83], v[224:227], v[32:47]
    ds_read_b64_tr_b16 v[96:97], v14 offset:24576
    ds_read_b64_tr_b16 v[98:99], v14 offset:25600
    ds_read_b128 v[232:235], v12 offset:49152
    ds_read_b64_tr_b16 v[100:101], v18 offset:24576
    v_mfma_f32_32x32x16_bf16 v[48:63], v[224:227], v[84:87], v[48:63]
    ds_read_b64_tr_b16 v[102:103], v18 offset:25600
    ds_read_b64_tr_b16 v[104:105], v16 offset:24576
    ds_read_b64_tr_b16 v[106:107], v16 offset:25600
    ds_read_b128 v[236:239], v13 offset:49152
    v_mfma_f32_32x32x16_bf16 v[32:47], v[88:91], v[228:231], v[32:47]
    ds_read_b64_tr_b16 v[108:109], v20 offset:24576
    ds_read_b64_tr_b16 v[110:111], v20 offset:25600
    v_mfma_f32_32x32x16_bf16 v[48:63], v[228:231], v[92:95], v[48:63]
    s_waitcnt lgkmcnt(0)
    s_barrier
    v_mfma_f32_32x32x16_bf16 v[32:47], v[96:99], v[232:235], v[32:47]
    ds_read_b64_tr_b16 v[80:81], v14 offset:32768
    ds_read_b64_tr_b16 v[82:83], v14 offset:33792
    ds_read_b128 v[240:243], v10 offset:57344
    ds_read_b64_tr_b16 v[84:85], v18 offset:32768
    ds_read_b64_tr_b16 v[86:87], v18 offset:33792
    v_mfma_f32_32x32x16_bf16 v[48:63], v[232:235], v[100:103], v[48:63]
    ds_read_b64_tr_b16 v[88:89], v16 offset:32768
    ds_read_b64_tr_b16 v[90:91], v16 offset:33792
    ds_read_b128 v[244:247], v11 offset:57344
    ds_read_b64_tr_b16 v[92:93], v20 offset:32768
    ds_read_b64_tr_b16 v[94:95], v20 offset:33792
    v_mfma_f32_32x32x16_bf16 v[32:47], v[104:107], v[236:239], v[32:47]
    s_waitcnt vmcnt(0)
    v_cmp_ne_u32 vcc, s65, v5
    s_cbranch_vccnz SP_5
SD_6:
    v_and_b32 v26, 0xffff0000, v4
    v_rcp_f32 v26, v26
    v_lshlrev_b32 v5, 16, v4
    v_and_b32 v4, 0xffff, v4
    v_mfma_f32_32x32x16_bf16 v[48:63], v[236:239], v[108:111], v[48:63]
    s_lshl_b32 s73, s70, 7
    v_lshl_add_u32 v7, v8, 2, v2
    v_add_u32 v6, s73, v7
    ds_write_b32 v6, v5 offset:1536
    ds_write_b32 v6, v26 offset:1792
    s_waitcnt lgkmcnt(0)
    s_barrier
    v_mfma_f32_32x32x16_bf16 v[32:47], v[80:83], v[240:243], v[32:47]
    ds_read_b64_tr_b16 v[96:97], v14 offset:40960
    ds_read_b64_tr_b16 v[98:99], v14 offset:41984
    ds_read_b128 v[248:251], v12 offset:57344
    ds_read_b64_tr_b16 v[100:101], v18 offset:40960
    ds_read_b64_tr_b16 v[102:103], v18 offset:41984
    v_mfma_f32_32x32x16_bf16 v[48:63], v[240:243], v[84:87], v[48:63]
    ds_read_b64_tr_b16 v[104:105], v16 offset:40960
    ds_read_b64_tr_b16 v[106:107], v16 offset:41984
    ds_read_b128 v[252:255], v13 offset:57344
    ds_read_b64_tr_b16 v[108:109], v20 offset:40960
    ds_read_b64_tr_b16 v[110:111], v20 offset:41984
    v_mfma_f32_32x32x16_bf16 v[32:47], v[88:91], v[244:247], v[32:47]
    v_lshl_add_u32 v6, v9, 4, v2
    v_add_u32 v6, s73, v6
    ds_read_b128 v[64:67], v6 offset:1792
    ds_read_b128 v[68:71], v6 offset:1824
    ds_read_b128 v[72:75], v6 offset:1856
    v_mfma_f32_32x32x16_bf16 v[48:63], v[244:247], v[92:95], v[48:63]
    ds_read_b128 v[76:79], v6 offset:1888
    v_or_b32 v4, v4, v5
    v_xor_b32 v28, 0x80008000, v4
    s_waitcnt lgkmcnt(0)
    ds_read_b128 v[4:7], v2 offset:16
    ds_read_b32 v120, v27 offset:12288
    ds_read_b32 v124, v27 offset:12800
    v_mfma_f32_32x32x16_bf16 v[32:47], v[96:99], v[248:251], v[32:47]
    ds_read_b64_tr_b16 v[80:81], v22 offset:49152
    ds_read_b64_tr_b16 v[82:83], v22 offset:49664
    ds_read_b64_tr_b16 v[84:85], v24 offset:49152
    v_mfma_f32_32x32x16_bf16 v[32:47], v[104:107], v[252:255], v[32:47]
    ds_read_b64_tr_b16 v[86:87], v24 offset:49664
    ds_read_b64_tr_b16 v[88:89], v22 offset:53248
    ds_read_b64_tr_b16 v[90:91], v22 offset:53760
    v_mfma_f32_32x32x16_bf16 v[48:63], v[248:251], v[100:103], v[48:63]
    ds_read_b64_tr_b16 v[92:93], v24 offset:53248
    ds_read_b64_tr_b16 v[94:95], v24 offset:53760
    s_waitcnt lgkmcnt(8)
    v_min_u32 v4, v4, v5
    v_min3_u32 v4, v4, v6, v7
    s_nop 0
    v_readfirstlane_b32 s68, v4
    s_cmp_lg_u32 s68, 0
    s_cbranch_scc0 CL_7
CD_8:
    v_mfma_f32_32x32x16_bf16 v[32:47], v[120:123], v[28:31], v[32:47]
    v_mfma_f32_32x32x16_bf16 v[48:63], v[252:255], v[108:111], v[48:63]
    v_mfma_f32_32x32x16_bf16 v[48:63], v[28:31], v[124:127], v[48:63]
    s_mov_b64 exec, 15
    v_mov_b32 v4, s65
    v_mul_u32_u24 v5, 264, v1
    s_mov_b32 exec_lo, s63
    buffer_atomic_swap v4, v5, s[40:43], s98 offen sc1
    s_mov_b64 exec, -1
    ds_read_b64_tr_b16 v[96:97], v22 offset:57344
    ds_read_b64_tr_b16 v[98:99], v22 offset:57856
    ds_read_b64_tr_b16 v[100:101], v24 offset:57344
    ds_read_b64_tr_b16 v[102:103], v24 offset:57856
    ds_read_b64_tr_b16 v[104:105], v22 offset:61440
    ds_read_b64_tr_b16 v[106:107], v22 offset:61952
    ds_read_b64_tr_b16 v[108:109], v24 offset:61440
    ds_read_b64_tr_b16 v[110:111], v24 offset:61952
    s_nop 1
    v_pk_mul_f32 v[32:33], v[26:27], v[32:33] op_sel_hi:[0,1]
    v_pk_mul_f32 v[34:35], v[26:27], v[34:35] op_sel_hi:[0,1]
    v_pk_mul_f32 v[36:37], v[26:27], v[36:37] op_sel_hi:[0,1]
    v_pk_mul_f32 v[38:39], v[26:27], v[38:39] op_sel_hi:[0,1]
    v_cvt_pk_bf16_f32 v32, v32, v33
    v_cvt_pk_bf16_f32 v33, v34, v35
    v_cvt_pk_bf16_f32 v34, v36, v37
    v_cvt_pk_bf16_f32 v35, v38, v39
    buffer_store_dwordx4 v[32:35], v112, s[40:43], s54 offen sc1
    v_pk_mul_f32 v[40:41], v[26:27], v[40:41] op_sel_hi:[0,1]
    v_pk_mul_f32 v[42:43], v[26:27], v[42:43] op_sel_hi:[0,1]
    v_pk_mul_f32 v[44:45], v[26:27], v[44:45] op_sel_hi:[0,1]
    v_pk_mul_f32 v[46:47], v[26:27], v[46:47] op_sel_hi:[0,1]
    v_cvt_pk_bf16_f32 v36, v40, v41
    v_cvt_pk_bf16_f32 v37, v42, v43
    v_cvt_pk_bf16_f32 v38, v44, v45
    v_cvt_pk_bf16_f32 v39, v46, v47
    buffer_store_dwordx4 v[36:39], v112, s[40:43], s55 offen sc1
    v_pk_mul_f32 v[48:49], v[64:65], v[48:49]
    v_pk_mul_f32 v[50:51], v[66:67], v[50:51]
    v_pk_mul_f32 v[52:53], v[68:69], v[52:53]
    v_pk_mul_f32 v[54:55], v[70:71], v[54:55]
    v_pk_mul_f32 v[56:57], v[72:73], v[56:57]
    v_pk_mul_f32 v[58:59], v[74:75], v[58:59]
    v_pk_mul_f32 v[60:61], v[76:77], v[60:61]
    v_pk_mul_f32 v[62:63], v[78:79], v[62:63]
    s_waitcnt lgkmcnt(8)
    v_mfma_f32_32x32x16_bf16 v[64:79], v[80:83], v[128:131], 0
    v_cvt_pk_bf16_f32 v48, v48, v49
    v_cvt_pk_bf16_f32 v49, v50, v51
    v_cvt_pk_bf16_f32 v50, v52, v53
    v_cvt_pk_bf16_f32 v51, v54, v55
    buffer_store_dwordx4 v[48:51], v114, s[40:43], s56 offen offset:0 sc1
    v_cvt_pk_bf16_f32 v52, v56, v57
    v_cvt_pk_bf16_f32 v53, v58, v59
    v_cvt_pk_bf16_f32 v54, v60, v61
    v_cvt_pk_bf16_f32 v55, v62, v63
    buffer_store_dwordx4 v[52:55], v114, s[40:43], s56 offen offset:256 sc1
    v_mfma_f32_32x32x16_bf16 v[64:79], v[84:87], v[132:135], v[64:79]
    v_add3_u32 v58, v48, v49, v50
    v_add3_u32 v59, v52, v53, v54
    v_add3_u32 v56, v32, v33, s65
    v_add_u32 v58, v58, v51
    v_add_u32 v59, v59, v55
    v_add3_u32 v57, v36, v37, s65
    v_add3_u32 v56, v56, v34, v35
    v_permlane16_swap_b32 v58, v59
    v_add3_u32 v57, v57, v38, v39
    v_mfma_f32_32x32x16_bf16 v[64:79], v[88:91], v[136:139], v[64:79]
    v_add_u32 v56, v56, v58
    v_add_u32 v57, v57, v59
    s_nop 0
    v_add_u32_dpp v56, v56, v56 quad_perm:[1,0,3,2] row_mask:0xf bank_mask:0xf
    v_add_u32_dpp v57, v57, v57 quad_perm:[1,0,3,2] row_mask:0xf bank_mask:0xf
    s_nop 0
    v_add_u32_dpp v56, v56, v56 quad_perm:[2,3,0,1] row_mask:0xf bank_mask:0xf
    v_add_u32_dpp v57, v57, v57 quad_perm:[2,3,0,1] row_mask:0xf bank_mask:0xf
    buffer_store_dword v56, v113, s[40:43], s57 offen sc1
    buffer_store_dword v57, v113, s[40:43], s61 offen sc1
    v_mfma_f32_32x32x16_bf16 v[64:79], v[92:95], v[140:143], v[64:79]
    ds_read_b64 v[6:7], v2 offset:0
    s_mov_b32 s52, 0xf149f2ca
    s_mov_b32 s53, 0x6c800000
    v_lshl_add_u32 v14, v9, 2, 31
    v_sub_u32 v14, v14, v8
    v_and_b32 v15, 3, v14
    v_and_b32 v14, 60, v14
    v_lshl_add_u32 v15, v15, 9, v2
    s_waitcnt lgkmcnt(0)
    v_mfma_f32_32x32x16_bf16 v[64:79], v[96:99], v[144:147], v[64:79]
    v_min_u32 v6, v6, v7
    s_nop 0
    v_readfirstlane_b32 s68, v6
    s_cmp_ge_u32 s68, 4
    s_cbranch_scc0 CL_9
CD_10:
    ds_read_b64_tr_b16 v[80:81], v23 offset:0
    ds_read_b64_tr_b16 v[82:83], v23 offset:512
    ds_read_b64_tr_b16 v[84:85], v25 offset:0
    ds_read_b64_tr_b16 v[86:87], v25 offset:512
    ds_read_b64_tr_b16 v[88:89], v23 offset:4096
    ds_read_b64_tr_b16 v[90:91], v23 offset:4608
    v_mfma_f32_32x32x16_bf16 v[64:79], v[100:103], v[148:151], v[64:79]
    ds_read_b64_tr_b16 v[92:93], v25 offset:4096
    ds_read_b64_tr_b16 v[94:95], v25 offset:4608
    ds_write_b128 v116, v[32:35] offset:32768
    ds_write_b128 v116, v[36:39] offset:34816
    ds_write_b128 v115, v[48:51] offset:40960
    ds_write_b128 v115, v[52:55] offset:41472
    v_lshl_add_u32 v15, v14, 2, v15
    v_mfma_f32_32x32x16_bf16 v[64:79], v[104:107], v[152:155], v[64:79]
    s_lshl_b32 s37, s65, 1
    v_lshlrev_b32 v10, 4, v1
    v_add_u32 v11, 4194304, v10
    v_and_b32 v12, 3, v1
    v_and_b32 v19, 60, v1
    v_lshl_add_u32 v12, v12, 6, v19
    s_mov_b32 s78, 0x0000ffff
    v_mfma_f32_32x32x16_bf16 v[64:79], v[108:111], v[156:159], v[64:79]
    s_mov_b32 s79, 0x0000ffff
    s_lshl_b32 s72, s3, 11
    v_add_u32 v16, s72, v10
    v_add_u32 v17, s72, v117
    v_mov_b32 v18, 109568
    v_cndmask_b32_e64 v17, v18, v17, s[78:79]
    ds_write_b32 v2, v2 offset:72
    s_waitcnt lgkmcnt(0)
    v_mfma_f32_32x32x16_bf16 v[64:79], v[80:83], v[160:163], v[64:79]
    ds_read_b64_tr_b16 v[96:97], v23 offset:8192
    ds_read_b64_tr_b16 v[98:99], v23 offset:8704
    ds_read_b64_tr_b16 v[100:101], v25 offset:8192
    ds_read_b64_tr_b16 v[102:103], v25 offset:8704
    ds_read_b64_tr_b16 v[104:105], v23 offset:12288
    ds_read_b64_tr_b16 v[106:107], v23 offset:12800
    ds_read_b64_tr_b16 v[108:109], v25 offset:12288
    ds_read_b64_tr_b16 v[110:111], v25 offset:12800
    ds_read_b64 v[6:7], v2 offset:0
    v_mfma_f32_32x32x16_bf16 v[64:79], v[84:87], v[164:167], v[64:79]
    v_mov_b32 v156, s66
    v_mov_b32 v157, s66
    v_mov_b32 v158, s66
    v_mov_b32 v159, s66
    v_mov_b32 v144, s66
    v_mov_b32 v145, s66
    v_mov_b32 v146, s66
    v_mov_b32 v147, s66
    v_bfe_u32 v4, v1, 2, 2
    v_mfma_f32_32x32x16_bf16 v[64:79], v[88:91], v[168:171], v[64:79]
    v_lshl_add_u32 v5, v9, 2, v4
    v_lshlrev_b32 v5, 7, v5
    v_lshrrev_b32 v4, 1, v4
    s_xor_b32 s72, s71, 1
    v_xor_b32 v4, s72, v4
    v_lshl_add_u32 v5, v4, 6, v5
    v_bfe_u32 v4, v1, 4, 1
    s_xor_b32 s72, s70, 1
    v_xor_b32 v4, s72, v4
    v_mfma_f32_32x32x16_bf16 v[64:79], v[92:95], v[172:175], v[64:79]
    v_lshl_add_u32 v5, v4, 5, v5
    v_and_b32 v4, 3, v1
    v_lshl_add_u32 v5, v4, 3, v5
    s_lshl_b32 s73, s3, 14
    s_add_u32 s73, s73, 65536
    v_add_u32 v130, s73, v5
    v_xor_b32 v131, 64, v130
    v_add_u32 v132, s73, v10
    s_waitcnt lgkmcnt(0)
    v_mfma_f32_32x32x16_bf16 v[64:79], v[96:99], v[176:179], v[64:79]
    v_min_u32 v6, v6, v7
    s_nop 0
    v_readfirstlane_b32 s68, v6
    s_cmp_ge_u32 s68, 6
    s_cbranch_scc0 CL_11
CD_12:
    ds_read_b64_tr_b16 v[80:81], v22 offset:0
    ds_read_b64_tr_b16 v[82:83], v22 offset:512
    ds_read_b64_tr_b16 v[84:85], v24 offset:0
    ds_read_b64_tr_b16 v[86:87], v24 offset:512
    ds_read_b64_tr_b16 v[88:89], v22 offset:4096
    ds_read_b64_tr_b16 v[90:91], v22 offset:4608
    ds_read_b64_tr_b16 v[92:93], v24 offset:4096
    v_mfma_f32_32x32x16_bf16 v[64:79], v[100:103], v[180:183], v[64:79]
    ds_read_b64_tr_b16 v[94:95], v24 offset:4608
    v_mov_b32 v168, s66
    v_mov_b32 v169, s66
    v_mov_b32 v170, s66
    v_mov_b32 v171, s66
    ds_read_b128 v[32:35], v15 offset:2064
    ds_read_b128 v[36:39], v15 offset:2096
    ds_read_b128 v[40:43], v15 offset:2128
    v_mfma_f32_32x32x16_bf16 v[64:79], v[104:107], v[184:187], v[64:79]
    ds_read_b128 v[44:47], v15 offset:2160
    v_bfe_u32 v4, v8, 1, 3
    s_lshl_b32 s72, s3, 1
    v_xor_b32 v4, s72, v4
    v_lshlrev_b32 v4, 4, v4
    v_lshl_add_u32 v4, v8, 7, v4
    v_lshl_add_u32 v4, v9, 3, v4
    s_and_b32 s72, s26, 3
    v_mfma_f32_32x32x16_bf16 v[64:79], v[108:111], v[188:191], v[64:79]
    s_lshl_b32 s72, s72, 13
    v_add_u32 v133, s72, v4
    v_lshl_add_u32 v134, v8, 2, v2
    v_lshlrev_b32 v135, 10, v8
    v_lshl_add_u32 v135, v9, 4, v135
    s_waitcnt lgkmcnt(0)
    v_mfma_f32_32x32x16_bf16 v[64:79], v[80:83], v[192:195], v[64:79]
    ds_read_b64_tr_b16 v[96:97], v22 offset:8192
    ds_read_b64_tr_b16 v[98:99], v22 offset:8704
    ds_read_b64_tr_b16 v[100:101], v24 offset:8192
    ds_read_b64_tr_b16 v[102:103], v24 offset:8704
    ds_read_b64_tr_b16 v[104:105], v22 offset:12288
    ds_read_b64_tr_b16 v[106:107], v22 offset:12800
    v_mfma_f32_32x32x16_bf16 v[64:79], v[84:87], v[196:199], v[64:79]
    ds_read_b64_tr_b16 v[108:109], v24 offset:12288
    ds_read_b64_tr_b16 v[110:111], v24 offset:12800
    ds_read_b64 v[6:7], v2 offset:0
    v_mov_b32 v180, s66
    v_mov_b32 v181, s66
    v_mov_b32 v182, s66
    v_mfma_f32_32x32x16_bf16 v[64:79], v[88:91], v[200:203], v[64:79]
    v_mov_b32 v183, s66
    s_lshl_b32 s72, s26, 3
    s_add_u32 s72, s72, s3
    s_lshl_b32 s74, s72, 9
    s_add_u32 s74, s74, 1835008
    s_lshl_b32 s72, s72, 13
    v_mfma_f32_32x32x16_bf16 v[64:79], v[92:95], v[204:207], v[64:79]
    s_add_u32 s38, s72, 12582912
    s_add_u32 s39, s72, 12587008
    s_add_u32 s61, s72, 12615680
    s_add_u32 s63, s72, 12619776
    s_lshl_b32 s75, s3, 3
    s_lshl_b32 s64, s65, 3
    s_waitcnt lgkmcnt(0)
    v_mfma_f32_32x32x16_bf16 v[64:79], v[96:99], v[208:211], v[64:79]
    v_min_u32 v6, v6, v7
    s_nop 0
    v_readfirstlane_b32 s68, v6
    s_cmp_ge_u32 s68, 8
    s_cbranch_scc0 CL_13
CD_14:
    ds_read_b64_tr_b16 v[80:81], v22 offset:16384
    ds_read_b64_tr_b16 v[82:83], v22 offset:16896
    ds_read_b64_tr_b16 v[84:85], v24 offset:16384
    ds_read_b64_tr_b16 v[86:87], v24 offset:16896
    v_mfma_f32_32x32x16_bf16 v[64:79], v[100:103], v[212:215], v[64:79]
    ds_read_b64_tr_b16 v[88:89], v22 offset:20480
    ds_read_b64_tr_b16 v[90:91], v22 offset:20992
    ds_read_b64_tr_b16 v[92:93], v24 offset:20480
    ds_read_b64_tr_b16 v[94:95], v24 offset:20992
    v_mov_b32 v204, s66
    v_mfma_f32_32x32x16_bf16 v[64:79], v[104:107], v[216:219], v[64:79]
    v_mov_b32 v205, s66
    v_mov_b32 v206, s66
    v_mov_b32 v207, s66
    v_mov_b32 v192, s66
    v_mov_b32 v193, s66
    v_mfma_f32_32x32x16_bf16 v[64:79], v[108:111], v[220:223], v[64:79]
    v_mov_b32 v194, s66
    v_mov_b32 v195, s66
    s_mov_b32 s44, s20
    s_and_b32 s45, s21, 0xffff
    s_mov_b32 s46, 2097152
    s_mov_b32 s47, 0x00020000
    s_waitcnt lgkmcnt(0)
    v_mfma_f32_32x32x16_bf16 v[64:79], v[80:83], v[224:227], v[64:79]
    ds_read_b64_tr_b16 v[96:97], v22 offset:24576
    ds_read_b64_tr_b16 v[98:99], v22 offset:25088
    ds_read_b64_tr_b16 v[100:101], v24 offset:24576
    ds_read_b64_tr_b16 v[102:103], v24 offset:25088
    v_mfma_f32_32x32x16_bf16 v[64:79], v[84:87], v[228:231], v[64:79]
    ds_read_b64_tr_b16 v[104:105], v22 offset:28672
    ds_read_b64_tr_b16 v[106:107], v22 offset:29184
    ds_read_b64_tr_b16 v[108:109], v24 offset:28672
    ds_read_b64_tr_b16 v[110:111], v24 offset:29184
    v_mfma_f32_32x32x16_bf16 v[64:79], v[88:91], v[232:235], v[64:79]
    v_mov_b32 v216, s66
    v_mov_b32 v217, s66
    v_mov_b32 v218, s66
    v_mov_b32 v219, s66
    v_mfma_f32_32x32x16_bf16 v[64:79], v[92:95], v[236:239], v[64:79]
    ds_read_b32 v13, v2 offset:40
    s_waitcnt lgkmcnt(0)
    v_mfma_f32_32x32x16_bf16 v[64:79], v[96:99], v[240:243], v[64:79]
    ds_read_b64 v[4:5], v2 offset:8
    ds_read_b32 v120, v27 offset:14336
    v_mul_f32 v26, 0x3eb8aa3b, v26
    v_mov_b32 v228, s66
    v_mfma_f32_32x32x16_bf16 v[64:79], v[100:103], v[244:247], v[64:79]
    v_mov_b32 v229, s66
    v_mov_b32 v230, s66
    v_mov_b32 v231, s66
    s_lshl_b32 s100, s71, 3
    s_mov_b32 s67, 0
KL_16:
    v_readfirstlane_b32 s68, v13
    s_lshr_b32 s68, s68, s100
    s_and_b32 s68, s68, 0xff
    s_cmp_eq_u32 s68, 0xff
    s_cbranch_scc1 KR_15
    ds_read_b32 v13, v2 offset:40
    s_add_u32 s67, s67, 1
    s_cmp_lt_u32 s67, 4194304
    s_waitcnt lgkmcnt(0)
    s_cbranch_scc1 KL_16
KR_15:
    v_mfma_f32_32x32x16_bf16 v[64:79], v[104:107], v[248:251], v[64:79]
    buffer_load_dwordx4 v[136:139], v10, s[40:43], s35 offen offset:1024 sc1
    buffer_load_dwordx4 v[140:143], v11, s[40:43], s35 offen offset:1024 sc1
    buffer_load_dword v129, v12, s[40:43], s36 offen offset:256 sc1
    s_waitcnt lgkmcnt(0)
    v_min_u32 v4, v4, v5
    s_nop 0
    v_readfirstlane_b32 s68, v4
    s_cmp_lg_u32 s68, 0
    s_cbranch_scc0 CL_17
CD_18:
    v_mfma_f32_32x32x16_bf16 v[64:79], v[108:111], v[252:255], v[64:79]
    s_nop 0
    v_mfma_f32_32x32x16_bf16 v[64:79], v[120:123], v[28:31], v[64:79]
    buffer_load_dwordx4 v[148:151], v10, s[40:43], s35 offen offset:0 sc1
    buffer_load_dwordx4 v[152:155], v11, s[40:43], s35 offen offset:0 sc1
    buffer_load_dwordx4 v[160:163], v10, s[40:43], s34 offen offset:1024 sc1
    buffer_load_dwordx4 v[164:167], v11, s[40:43], s34 offen offset:1024 sc1
    s_nop 7
    v_pk_mul_f32 v[64:65], v[26:27], v[64:65] op_sel_hi:[0,1]
    v_pk_mul_f32 v[66:67], v[26:27], v[66:67] op_sel_hi:[0,1]
    v_pk_mul_f32 v[68:69], v[26:27], v[68:69] op_sel_hi:[0,1]
    v_pk_mul_f32 v[70:71], v[26:27], v[70:71] op_sel_hi:[0,1]
    v_cvt_pk_bf16_f32 v80, v64, v65
    v_cvt_pk_bf16_f32 v81, v66, v67
    v_cvt_pk_bf16_f32 v82, v68, v69
    v_cvt_pk_bf16_f32 v83, v70, v71
    ds_write_b128 v116, v[80:83] offset:49152
    v_pk_mul_f32 v[72:73], v[26:27], v[72:73] op_sel_hi:[0,1]
    v_pk_mul_f32 v[74:75], v[26:27], v[74:75] op_sel_hi:[0,1]
    v_pk_mul_f32 v[76:77], v[26:27], v[76:77] op_sel_hi:[0,1]
    v_pk_mul_f32 v[78:79], v[26:27], v[78:79] op_sel_hi:[0,1]
    v_cvt_pk_bf16_f32 v84, v72, v73
    v_cvt_pk_bf16_f32 v85, v74, v75
    v_cvt_pk_bf16_f32 v86, v76, v77
    v_cvt_pk_bf16_f32 v87, v78, v79
    ds_write_b128 v116, v[84:87] offset:51200
    s_mov_b64 exec, 1
    v_mov_b32 v4, 1
    ds_add_u32 v2, v4 offset:44
    s_mov_b64 exec, -1
    s_lshl_b32 s72, s26, 6
    s_lshl_b32 s73, s27, 2
    s_add_u32 s73, s73, s3
    s_add_u32 s72, s72, s73
    s_lshl_b32 s58, s72, 10
    s_add_u32 s58, s58, 12582912
    s_lshl_b32 s59, s72, 6
    s_add_u32 s59, s59, 1835008
    s_lshl_b32 s98, s26, 13
    s_lshr_b32 s72, s73, 3
    s_lshl_b32 s72, s72, 7
    s_add_u32 s98, s98, s72
    s_and_b32 s72, s73, 7
    s_mul_i32 s72, s72, 4
    s_add_u32 s98, s98, s72
    s_add_u32 s98, s98, 1310720
    s_mov_b32 s60, 0
    v_lshlrev_b32 v13, 10, v1
    v_mov_b32 v14, s65
    s_mov_b32 s67, 0
W_19:
    ds_read_b32 v4, v2 offset:44
    s_waitcnt lgkmcnt(0)
    v_readfirstlane_b32 s68, v4
    s_cmp_ge_u32 s68, 4
    s_cbranch_scc1 D_20
    s_add_u32 s67, s67, 1
    s_cmp_lt_u32 s67, 4194304
    s_cbranch_scc1 W_19
D_20:
    ds_read_b128 v[236:239], v16 offset:33792
    ds_read_b128 v[24:27], v16 offset:50176
    ds_read_b128 v[232:235], v16 offset:32768
    ds_read_b128 v[248:251], v17 offset:41984
    ds_read_b128 v[252:255], v17 offset:42496
    ds_read_b128 v[20:23], v16 offset:49152
    ds_read_b128 v[240:243], v17 offset:40960
    ds_read_b128 v[244:247], v17 offset:41472
    s_waitcnt lgkmcnt(6)
    v_mfma_f32_32x32x16_bf16 v[48:63], v[236:239], v[24:27], v[32:47]
    buffer_load_dwordx4 v[172:175], v10, s[40:43], s34 offen offset:0 sc1
    buffer_load_dwordx4 v[176:179], v11, s[40:43], s34 offen offset:0 sc1
    buffer_load_dwordx4 v[184:187], v10, s[40:43], s33 offen offset:1024 sc1
    buffer_load_dwordx4 v[188:191], v11, s[40:43], s33 offen offset:1024 sc1
    s_waitcnt lgkmcnt(0)
    s_nop 7
    s_nop 0
    v_exp_f32 v48, v48
    v_exp_f32 v49, v49
    v_exp_f32 v50, v50
    v_cvt_pk_bf16_f32 v80, v48, v49
    v_exp_f32 v51, v51
    v_exp_f32 v52, v52
    v_cvt_pk_bf16_f32 v81, v50, v51
    v_exp_f32 v53, v53
    v_exp_f32 v54, v54
    v_cvt_pk_bf16_f32 v82, v52, v53
    v_mfma_f32_32x32x16_bf16 v[64:79], v[232:235], v[24:27], 0
    v_exp_f32 v55, v55
    buffer_load_dword v128, v12, s[40:43], s36 offen offset:0 sc1
    v_exp_f32 v56, v56
    v_cvt_pk_bf16_f32 v83, v54, v55
    v_exp_f32 v57, v57
    v_exp_f32 v58, v58
    v_mfma_f32_32x32x16_bf16 v[112:127], v[248:251], v[80:83], 0
    v_cvt_pk_bf16_f32 v84, v56, v57
    v_exp_f32 v59, v59
    buffer_load_dwordx4 v[196:199], v10, s[40:43], s33 offen offset:0 sc1
    v_exp_f32 v60, v60
    v_cvt_pk_bf16_f32 v85, v58, v59
    v_exp_f32 v61, v61
    buffer_load_dwordx4 v[200:203], v11, s[40:43], s33 offen offset:0 sc1
    v_exp_f32 v62, v62
    v_cvt_pk_bf16_f32 v86, v60, v61
    v_exp_f32 v63, v63
    ds_write_b32 v2, v2 offset:112
    v_exp_f32 v64, v64
    v_cvt_pk_bf16_f32 v87, v62, v63
    v_exp_f32 v65, v65
    v_exp_f32 v66, v66
    v_mfma_f32_32x32x16_bf16 v[112:127], v[252:255], v[84:87], v[112:127]
    v_cvt_pk_bf16_f32 v88, v64, v65
    v_exp_f32 v67, v67
    v_exp_f32 v68, v68
    v_cvt_pk_bf16_f32 v89, v66, v67
    v_exp_f32 v69, v69
    v_exp_f32 v70, v70
    v_cvt_pk_bf16_f32 v90, v68, v69
    v_mfma_f32_32x32x16_bf16 v[48:63], v[232:235], v[20:23], v[32:47]
    v_exp_f32 v71, v71
    buffer_load_dwordx4 v[208:211], v10, s[40:43], s32 offen offset:1024 sc1
    v_exp_f32 v72, v72
    v_cvt_pk_bf16_f32 v91, v70, v71
    v_exp_f32 v73, v73
    v_exp_f32 v74, v74
    v_mfma_f32_32x32x16_bf16 v[112:127], v[240:243], v[88:91], v[112:127]
    v_cvt_pk_bf16_f32 v92, v72, v73
    v_exp_f32 v75, v75
    buffer_load_dwordx4 v[212:215], v11, s[40:43], s32 offen offset:1024 sc1
    v_exp_f32 v76, v76
    v_cvt_pk_bf16_f32 v93, v74, v75
    v_exp_f32 v77, v77
    buffer_load_dwordx4 v[220:223], v10, s[40:43], s32 offen offset:0 sc1
    v_exp_f32 v78, v78
    v_cvt_pk_bf16_f32 v94, v76, v77
    v_exp_f32 v79, v79
    s_waitcnt vmcnt(12)
    v_exp_f32 v48, v48
    v_add3_u32 v4, v136, v137, v138
    v_add3_u32 v5, v148, v149, v150
    v_cvt_pk_bf16_f32 v95, v78, v79
    v_exp_f32 v49, v49
    v_add3_u32 v4, v4, v139, v140
    v_add3_u32 v5, v5, v151, v152
    v_exp_f32 v50, v50
    v_add3_u32 v4, v4, v141, v142
    v_add3_u32 v5, v5, v153, v154
    v_mfma_f32_32x32x16_bf16 v[112:127], v[244:247], v[92:95], v[112:127]
    v_add3_u32 v4, v4, v143, v155
    v_cvt_pk_bf16_f32 v80, v48, v49
    v_add3_u32 v4, v4, v5, s37
    v_exp_f32 v51, v51
    v_add_u32_dpp v5, v129, v129 quad_perm:[1,0,3,2] row_mask:0xf bank_mask:0xf
    v_exp_f32 v52, v52
    v_add_u32_dpp v4, v4, v4 quad_perm:[1,0,3,2] row_mask:0xf bank_mask:0xf
    v_cvt_pk_bf16_f32 v81, v50, v51
    v_exp_f32 v53, v53
    v_add_u32_dpp v4, v4, v4 quad_perm:[2,3,0,1] row_mask:0xf bank_mask:0xf
    v_exp_f32 v54, v54
    v_cmp_ne_u32 vcc, v5, v4
    v_cvt_pk_bf16_f32 v82, v52, v53
    s_or_b32 s68, vcc_lo, vcc_hi
    s_and_b32 s68, s68, 0x88888888
    s_cbranch_scc1 L_kr7
L_kc7:
    v_mfma_f32_32x32x16_bf16 v[64:79], v[136:139], v[24:27], 0
    v_permlane16_swap_b32 v140, v144
    v_exp_f32 v55, v55
    buffer_load_dwordx4 v[224:227], v11, s[40:43], s32 offen offset:0 sc1
    s_mov_b64 exec, 1
    v_mov_b32 v6, 1
    ds_add_u32 v2, v6 offset:56
    s_mov_b64 exec, -1
    v_exp_f32 v56, v56
    v_permlane16_swap_b32 v141, v145
    v_cvt_pk_bf16_f32 v83, v54, v55
    v_exp_f32 v57, v57
    v_exp_f32 v58, v58
    v_mfma_f32_32x32x16_bf16 v[96:111], v[240:243], v[80:83], 0
    v_cvt_pk_bf16_f32 v84, v56, v57
    v_permlane16_swap_b32 v142, v146
    v_exp_f32 v59, v59
    v_exp_f32 v60, v60
    v_permlane16_swap_b32 v143, v147
    v_cvt_pk_bf16_f32 v85, v58, v59
    v_exp_f32 v61, v61
    v_exp_f32 v62, v62
    v_cvt_pk_bf16_f32 v86, v60, v61
    v_exp_f32 v63, v63
    s_cmp_eq_u32 s26, 0
    s_cbranch_scc1 L_ex2
    v_exp_f32 v64, v64
    v_cvt_pk_bf16_f32 v87, v62, v63
    v_exp_f32 v65, v65
    v_exp_f32 v66, v66
    v_mfma_f32_32x32x16_bf16 v[96:111], v[244:247], v[84:87], v[96:111]
    v_cvt_pk_bf16_f32 v88, v64, v65
    v_exp_f32 v67, v67
    v_exp_f32 v68, v68
    v_cvt_pk_bf16_f32 v89, v66, v67
    v_exp_f32 v69, v69
    v_exp_f32 v70, v70
    v_cvt_pk_bf16_f32 v90, v68, v69
    v_mfma_f32_32x32x16_bf16 v[48:63], v[148:151], v[24:27], 0
    v_permlane16_swap_b32 v152, v156
    v_exp_f32 v71, v71
    v_exp_f32 v72, v72
    v_permlane16_swap_b32 v153, v157
    v_cvt_pk_bf16_f32 v91, v70, v71
    v_exp_f32 v73, v73
    v_exp_f32 v74, v74
    v_mfma_f32_32x32x16_bf16 v[112:127], v[140:143], v[88:91], v[112:127]
    ds_read_b128 v[32:35], v15 offset:2192
    ds_read_b128 v[36:39], v15 offset:2224
    ds_read_b128 v[40:43], v15 offset:2256
    ds_read_b128 v[44:47], v15 offset:2288
    v_cvt_pk_bf16_f32 v92, v72, v73
    v_permlane16_swap_b32 v154, v158
    v_exp_f32 v75, v75
    v_exp_f32 v76, v76
    v_permlane16_swap_b32 v155, v159
    v_cvt_pk_bf16_f32 v93, v74, v75
    v_exp_f32 v77, v77
    v_exp_f32 v78, v78
    v_cvt_pk_bf16_f32 v94, v76, v77
    v_exp_f32 v79, v79
    s_waitcnt vmcnt(9)
    v_exp_f32 v48, v48
    v_add3_u32 v4, v160, v161, v162
    v_add3_u32 v5, v172, v173, v174
    v_cvt_pk_bf16_f32 v95, v78, v79
    v_exp_f32 v49, v49
    v_add3_u32 v4, v4, v163, v164
    v_add3_u32 v5, v5, v175, v176
    v_exp_f32 v50, v50
    v_add3_u32 v4, v4, v165, v166
    v_add3_u32 v5, v5, v177, v178
    v_mfma_f32_32x32x16_bf16 v[112:127], v[144:147], v[92:95], v[112:127]
    v_add3_u32 v4, v4, v167, v179
    v_cvt_pk_bf16_f32 v80, v48, v49
    v_add3_u32 v4, v4, v5, s37
    v_exp_f32 v51, v51
    v_add_u32_dpp v5, v129, v129 quad_perm:[1,0,3,2] row_mask:0xf bank_mask:0xf
    v_exp_f32 v52, v52
    v_add_u32_dpp v4, v4, v4 quad_perm:[1,0,3,2] row_mask:0xf bank_mask:0xf
    v_cvt_pk_bf16_f32 v81, v50, v51
    v_exp_f32 v53, v53
    v_add_u32_dpp v4, v4, v4 quad_perm:[2,3,0,1] row_mask:0xf bank_mask:0xf
    v_exp_f32 v54, v54
    v_cmp_ne_u32 vcc, v5, v4
    v_cvt_pk_bf16_f32 v82, v52, v53
    s_or_b32 s68, vcc_lo, vcc_hi
    s_and_b32 s68, s68, 0x22222222
    s_cbranch_scc1 L_kr5
L_kc5:
    v_mfma_f32_32x32x16_bf16 v[64:79], v[160:163], v[24:27], 0
    v_permlane16_swap_b32 v164, v168
    v_exp_f32 v55, v55
    v_exp_f32 v56, v56
    v_permlane16_swap_b32 v165, v169
    v_cvt_pk_bf16_f32 v83, v54, v55
    v_exp_f32 v57, v57
    v_exp_f32 v58, v58
    v_mfma_f32_32x32x16_bf16 v[112:127], v[152:155], v[80:83], v[112:127]
    v_cvt_pk_bf16_f32 v84, v56, v57
    v_permlane16_swap_b32 v166, v170
    v_exp_f32 v59, v59
    v_exp_f32 v60, v60
    v_permlane16_swap_b32 v167, v171
    v_cvt_pk_bf16_f32 v85, v58, v59
    v_exp_f32 v61, v61
    v_exp_f32 v62, v62
    v_cvt_pk_bf16_f32 v86, v60, v61
    v_exp_f32 v63, v63
    s_cmp_eq_u32 s26, 1
    s_cbranch_scc1 L_ex4
    v_exp_f32 v64, v64
    v_cvt_pk_bf16_f32 v87, v62, v63
    v_exp_f32 v65, v65
    v_exp_f32 v66, v66
    v_mfma_f32_32x32x16_bf16 v[112:127], v[156:159], v[84:87], v[112:127]
    v_cvt_pk_bf16_f32 v88, v64, v65
    v_exp_f32 v67, v67
    v_exp_f32 v68, v68
    v_cvt_pk_bf16_f32 v89, v66, v67
    v_exp_f32 v69, v69
    v_exp_f32 v70, v70
    v_cvt_pk_bf16_f32 v90, v68, v69
    v_mfma_f32_32x32x16_bf16 v[48:63], v[172:175], v[24:27], 0
    v_permlane16_swap_b32 v176, v180
    v_exp_f32 v71, v71
    v_exp_f32 v72, v72
    v_permlane16_swap_b32 v177, v181
    v_cvt_pk_bf16_f32 v91, v70, v71
    v_exp_f32 v73, v73
    v_exp_f32 v74, v74
    v_mfma_f32_32x32x16_bf16 v[112:127], v[164:167], v[88:91], v[112:127]
    v_cvt_pk_bf16_f32 v92, v72, v73
    v_permlane16_swap_b32 v178, v182
    v_exp_f32 v75, v75
    v_exp_f32 v76, v76
    v_permlane16_swap_b32 v179, v183
    v_cvt_pk_bf16_f32 v93, v74, v75
    v_exp_f32 v77, v77
    v_exp_f32 v78, v78
    v_cvt_pk_bf16_f32 v94, v76, v77
    v_exp_f32 v79, v79
    s_waitcnt vmcnt(4)
    v_exp_f32 v48, v48
    v_add3_u32 v4, v184, v185, v186
    v_add3_u32 v5, v196, v197, v198
    v_cvt_pk_bf16_f32 v95, v78, v79
    v_exp_f32 v49, v49
    v_add3_u32 v4, v4, v187, v188
    v_add3_u32 v5, v5, v199, v200
    v_exp_f32 v50, v50
    v_add3_u32 v4, v4, v189, v190
    v_add3_u32 v5, v5, v201, v202
    v_mfma_f32_32x32x16_bf16 v[112:127], v[168:171], v[92:95], v[112:127]
    v_add3_u32 v4, v4, v191, v203
    v_cvt_pk_bf16_f32 v80, v48, v49
    v_add3_u32 v4, v4, v5, s37
    v_exp_f32 v51, v51
    v_add_u32_dpp v5, v128, v128 quad_perm:[1,0,3,2] row_mask:0xf bank_mask:0xf
    v_exp_f32 v52, v52
    v_add_u32_dpp v4, v4, v4 quad_perm:[1,0,3,2] row_mask:0xf bank_mask:0xf
    v_cvt_pk_bf16_f32 v81, v50, v51
    v_exp_f32 v53, v53
    v_add_u32_dpp v4, v4, v4 quad_perm:[2,3,0,1] row_mask:0xf bank_mask:0xf
    v_exp_f32 v54, v54
    v_cmp_ne_u32 vcc, v5, v4
    v_cvt_pk_bf16_f32 v82, v52, v53
    s_or_b32 s68, vcc_lo, vcc_hi
    s_and_b32 s68, s68, 0x88888888
    s_cbranch_scc1 L_kr3
L_kc3:
    v_mfma_f32_32x32x16_bf16 v[64:79], v[184:187], v[24:27], 0
    v_permlane16_swap_b32 v188, v192
    v_exp_f32 v55, v55
    v_exp_f32 v56, v56
    v_permlane16_swap_b32 v189, v193
    v_cvt_pk_bf16_f32 v83, v54, v55
    v_exp_f32 v57, v57
    v_exp_f32 v58, v58
    v_mfma_f32_32x32x16_bf16 v[112:127], v[176:179], v[80:83], v[112:127]
    v_cvt_pk_bf16_f32 v84, v56, v57
    v_permlane16_swap_b32 v190, v194
    v_exp_f32 v59, v59
    v_exp_f32 v60, v60
    v_permlane16_swap_b32 v191, v195
    v_cvt_pk_bf16_f32 v85, v58, v59
    v_exp_f32 v61, v61
    v_exp_f32 v62, v62
    v_cvt_pk_bf16_f32 v86, v60, v61
    v_exp_f32 v63, v63
    s_cmp_eq_u32 s26, 2
    s_cbranch_scc1 L_ex6
    v_exp_f32 v64, v64
    v_cvt_pk_bf16_f32 v87, v62, v63
    v_exp_f32 v65, v65
    v_exp_f32 v66, v66
    v_mfma_f32_32x32x16_bf16 v[112:127], v[180:183], v[84:87], v[112:127]
    v_cvt_pk_bf16_f32 v88, v64, v65
    v_exp_f32 v67, v67
    v_exp_f32 v68, v68
    v_cvt_pk_bf16_f32 v89, v66, v67
    v_exp_f32 v69, v69
    v_exp_f32 v70, v70
    v_cvt_pk_bf16_f32 v90, v68, v69
    v_mfma_f32_32x32x16_bf16 v[48:63], v[196:199], v[24:27], 0
    v_permlane16_swap_b32 v200, v204
    v_exp_f32 v71, v71
    v_exp_f32 v72, v72
    v_permlane16_swap_b32 v201, v205
    v_cvt_pk_bf16_f32 v91, v70, v71
    v_exp_f32 v73, v73
    v_exp_f32 v74, v74
    v_mfma_f32_32x32x16_bf16 v[112:127], v[188:191], v[88:91], v[112:127]
    v_cvt_pk_bf16_f32 v92, v72, v73
    v_permlane16_swap_b32 v202, v206
    v_exp_f32 v75, v75
    v_exp_f32 v76, v76
    v_permlane16_swap_b32 v203, v207
    v_cvt_pk_bf16_f32 v93, v74, v75
    v_exp_f32 v77, v77
    v_exp_f32 v78, v78
    v_cvt_pk_bf16_f32 v94, v76, v77
    v_exp_f32 v79, v79
    s_waitcnt vmcnt(0)
    v_exp_f32 v48, v48
    v_add3_u32 v4, v208, v209, v210
    v_add3_u32 v5, v220, v221, v222
    v_cvt_pk_bf16_f32 v95, v78, v79
    v_exp_f32 v49, v49
    v_add3_u32 v4, v4, v211, v212
    v_add3_u32 v5, v5, v223, v224
    v_exp_f32 v50, v50
    v_add3_u32 v4, v4, v213, v214
    v_add3_u32 v5, v5, v225, v226
    v_mfma_f32_32x32x16_bf16 v[112:127], v[192:195], v[92:95], v[112:127]
    v_add3_u32 v4, v4, v215, v227
    v_cvt_pk_bf16_f32 v80, v48, v49
    v_add3_u32 v4, v4, v5, s37
    v_exp_f32 v51, v51
    v_add_u32_dpp v5, v128, v128 quad_perm:[1,0,3,2] row_mask:0xf bank_mask:0xf
    v_exp_f32 v52, v52
    v_add_u32_dpp v4, v4, v4 quad_perm:[1,0,3,2] row_mask:0xf bank_mask:0xf
    v_cvt_pk_bf16_f32 v81, v50, v51
    v_exp_f32 v53, v53
    v_add_u32_dpp v4, v4, v4 quad_perm:[2,3,0,1] row_mask:0xf bank_mask:0xf
    v_exp_f32 v54, v54
    v_cmp_ne_u32 vcc, v5, v4
    v_cvt_pk_bf16_f32 v82, v52, v53
    s_or_b32 s68, vcc_lo, vcc_hi
    s_and_b32 s68, s68, 0x22222222
    s_cbranch_scc1 L_kr1
L_kc1:
    s_waitcnt lgkmcnt(0)
    v_mfma_f32_32x32x16_bf16 v[64:79], v[208:211], v[24:27], v[32:47]
    v_permlane16_swap_b32 v212, v216
    v_exp_f32 v55, v55
    v_exp_f32 v56, v56
    v_permlane16_swap_b32 v213, v217
    v_cvt_pk_bf16_f32 v83, v54, v55
    v_exp_f32 v57, v57
    v_exp_f32 v58, v58
    v_mfma_f32_32x32x16_bf16 v[112:127], v[200:203], v[80:83], v[112:127]
    v_cvt_pk_bf16_f32 v84, v56, v57
    v_permlane16_swap_b32 v214, v218
    v_exp_f32 v59, v59
    v_exp_f32 v60, v60
    v_permlane16_swap_b32 v215, v219
    v_cvt_pk_bf16_f32 v85, v58, v59
    v_exp_f32 v61, v61
    v_exp_f32 v62, v62
    v_cvt_pk_bf16_f32 v86, v60, v61
    v_exp_f32 v63, v63
    s_cmp_eq_u32 s26, 3
    s_cbranch_scc1 L_ex8
    v_exp_f32 v64, v64
    v_cvt_pk_bf16_f32 v87, v62, v63
    v_exp_f32 v65, v65
    v_exp_f32 v66, v66
    v_mfma_f32_32x32x16_bf16 v[112:127], v[204:207], v[84:87], v[112:127]
    v_cvt_pk_bf16_f32 v88, v64, v65
    v_exp_f32 v67, v67
    v_exp_f32 v68, v68
    v_cvt_pk_bf16_f32 v89, v66, v67
    v_exp_f32 v69, v69
    v_exp_f32 v70, v70
    v_cvt_pk_bf16_f32 v90, v68, v69
    v_mfma_f32_32x32x16_bf16 v[48:63], v[136:139], v[20:23], 0
    v_permlane16_swap_b32 v224, v228
    v_exp_f32 v71, v71
    v_exp_f32 v72, v72
    v_permlane16_swap_b32 v225, v229
    v_cvt_pk_bf16_f32 v91, v70, v71
    v_exp_f32 v73, v73
    v_exp_f32 v74, v74
    v_mfma_f32_32x32x16_bf16 v[112:127], v[212:215], v[88:91], v[112:127]
    v_cvt_pk_bf16_f32 v92, v72, v73
    v_permlane16_swap_b32 v226, v230
    v_exp_f32 v75, v75
    v_exp_f32 v76, v76
    v_permlane16_swap_b32 v227, v231
    v_cvt_pk_bf16_f32 v93, v74, v75
    v_exp_f32 v77, v77
    v_exp_f32 v78, v78
    v_cvt_pk_bf16_f32 v94, v76, v77
    v_exp_f32 v79, v79
    v_exp_f32 v48, v48
    v_cvt_pk_bf16_f32 v95, v78, v79
    v_exp_f32 v49, v49
    v_exp_f32 v50, v50
    v_mfma_f32_32x32x16_bf16 v[112:127], v[216:219], v[92:95], v[112:127]
    v_cvt_pk_bf16_f32 v80, v48, v49
    v_exp_f32 v51, v51
    v_exp_f32 v52, v52
    v_cvt_pk_bf16_f32 v81, v50, v51
    v_exp_f32 v53, v53
    v_exp_f32 v54, v54
    v_cvt_pk_bf16_f32 v82, v52, v53
    v_mfma_f32_32x32x16_bf16 v[64:79], v[148:151], v[20:23], 0
    v_exp_f32 v55, v55
    v_exp_f32 v56, v56
    v_cvt_pk_bf16_f32 v83, v54, v55
    v_exp_f32 v57, v57
    v_exp_f32 v58, v58
    v_mfma_f32_32x32x16_bf16 v[96:111], v[140:143], v[80:83], v[96:111]
    v_cvt_pk_bf16_f32 v84, v56, v57
    v_exp_f32 v59, v59
    v_exp_f32 v60, v60
    v_cvt_pk_bf16_f32 v85, v58, v59
    v_exp_f32 v61, v61
    v_exp_f32 v62, v62
    v_cvt_pk_bf16_f32 v86, v60, v61
    v_exp_f32 v63, v63
L_afin:
    v_cmp_nle_f32 vcc, 0x12800000, v120
    v_cmp_nge_f32 s[54:55], s53, v120
    s_or_b64 vcc, vcc, s[54:55]
    s_cbranch_vccnz L_adef
    v_rcp_f32 v4, v120
    s_add_u32 s72, s58, 32768
    s_add_u32 s73, s59, 2048
    s_mov_b64 exec, 0xff
    buffer_atomic_swap v14, v13, s[40:43], s98 offen offset:0 sc1
    s_mov_b64 exec, -1
    v_pk_mul_f32 v[112:113], v[4:5], v[112:113] op_sel_hi:[0,1]
    v_pk_mul_f32 v[114:115], v[4:5], v[114:115] op_sel_hi:[0,1]
    v_pk_mul_f32 v[116:117], v[4:5], v[116:117] op_sel_hi:[0,1]
    v_pk_mul_f32 v[118:119], v[4:5], v[118:119] op_sel_hi:[0,1]
    v_cvt_pk_bf16_f32 v112, v112, v113
    v_cvt_pk_bf16_f32 v113, v114, v115
    v_cvt_pk_bf16_f32 v114, v116, v117
    v_cvt_pk_bf16_f32 v115, v118, v119
    buffer_store_dwordx4 v[112:115], v10, s[40:43], s72 offen sc1
    v_add3_u32 v5, v112, v113, s65
    v_add3_u32 v5, v5, v114, v115
    s_nop 1
    v_add_u32_dpp v5, v5, v5 quad_perm:[1,0,3,2] row_mask:0xf bank_mask:0xf
    s_nop 1
    v_add_u32_dpp v5, v5, v5 quad_perm:[2,3,0,1] row_mask:0xf bank_mask:0xf
    buffer_store_dword v5, v19, s[40:43], s73 offen sc1
    ds_write_b32 v2, v2 offset:76
L_afd:
    s_cmp_eq_u32 s26, 0
    s_cbranch_scc1 L_attn_done
    v_exp_f32 v64, v64
    v_cvt_pk_bf16_f32 v87, v62, v63
    v_exp_f32 v65, v65
    v_exp_f32 v66, v66
    v_mfma_f32_32x32x16_bf16 v[96:111], v[144:147], v[84:87], v[96:111]
    v_cvt_pk_bf16_f32 v88, v64, v65
    v_exp_f32 v67, v67
    v_exp_f32 v68, v68
    v_cvt_pk_bf16_f32 v89, v66, v67
    v_exp_f32 v69, v69
    v_exp_f32 v70, v70
    v_cvt_pk_bf16_f32 v90, v68, v69
    v_mfma_f32_32x32x16_bf16 v[48:63], v[160:163], v[20:23], 0
    v_exp_f32 v71, v71
    v_exp_f32 v72, v72
    v_cvt_pk_bf16_f32 v91, v70, v71
    v_exp_f32 v73, v73
    v_exp_f32 v74, v74
    v_mfma_f32_32x32x16_bf16 v[96:111], v[152:155], v[88:91], v[96:111]
    v_cvt_pk_bf16_f32 v92, v72, v73
    v_exp_f32 v75, v75
    v_exp_f32 v76, v76
    v_cvt_pk_bf16_f32 v93, v74, v75
    v_exp_f32 v77, v77
    v_exp_f32 v78, v78
    v_cvt_pk_bf16_f32 v94, v76, v77
    v_exp_f32 v79, v79
    s_cmp_eq_u32 s26, 1
    s_cbranch_scc1 L_ex11
    v_exp_f32 v48, v48
    v_cvt_pk_bf16_f32 v95, v78, v79
    v_exp_f32 v49, v49
    v_exp_f32 v50, v50
    v_mfma_f32_32x32x16_bf16 v[96:111], v[156:159], v[92:95], v[96:111]
    v_cvt_pk_bf16_f32 v80, v48, v49
    v_exp_f32 v51, v51
    v_exp_f32 v52, v52
    v_cvt_pk_bf16_f32 v81, v50, v51
    v_exp_f32 v53, v53
    v_exp_f32 v54, v54
    v_cvt_pk_bf16_f32 v82, v52, v53
    v_mfma_f32_32x32x16_bf16 v[64:79], v[172:175], v[20:23], 0
    v_exp_f32 v55, v55
    v_exp_f32 v56, v56
    v_cvt_pk_bf16_f32 v83, v54, v55
    v_exp_f32 v57, v57
    v_exp_f32 v58, v58
    v_mfma_f32_32x32x16_bf16 v[96:111], v[164:167], v[80:83], v[96:111]
    v_cvt_pk_bf16_f32 v84, v56, v57
    v_exp_f32 v59, v59
    v_exp_f32 v60, v60
    v_cvt_pk_bf16_f32 v85, v58, v59
    v_exp_f32 v61, v61
    v_exp_f32 v62, v62
    v_cvt_pk_bf16_f32 v86, v60, v61
    v_exp_f32 v63, v63
    v_exp_f32 v64, v64
    v_cvt_pk_bf16_f32 v87, v62, v63
    v_exp_f32 v65, v65
    v_exp_f32 v66, v66
    v_mfma_f32_32x32x16_bf16 v[96:111], v[168:171], v[84:87], v[96:111]
    v_cvt_pk_bf16_f32 v88, v64, v65
    v_exp_f32 v67, v67
    v_exp_f32 v68, v68
    v_cvt_pk_bf16_f32 v89, v66, v67
    v_exp_f32 v69, v69
    v_exp_f32 v70, v70
    v_cvt_pk_bf16_f32 v90, v68, v69
    v_mfma_f32_32x32x16_bf16 v[48:63], v[184:187], v[20:23], 0
    v_exp_f32 v71, v71
    v_exp_f32 v72, v72
    v_cvt_pk_bf16_f32 v91, v70, v71
    v_exp_f32 v73, v73
    v_exp_f32 v74, v74
    v_mfma_f32_32x32x16_bf16 v[96:111], v[176:179], v[88:91], v[96:111]
    v_cvt_pk_bf16_f32 v92, v72, v73
    v_exp_f32 v75, v75
    v_exp_f32 v76, v76
    v_cvt_pk_bf16_f32 v93, v74, v75
    v_exp_f32 v77, v77
    v_exp_f32 v78, v78
    v_cvt_pk_bf16_f32 v94, v76, v77
    v_exp_f32 v79, v79
    s_cmp_eq_u32 s26, 2
    s_cbranch_scc1 L_ex13
    v_exp_f32 v48, v48
    v_cvt_pk_bf16_f32 v95, v78, v79
    v_exp_f32 v49, v49
    v_exp_f32 v50, v50
    v_mfma_f32_32x32x16_bf16 v[96:111], v[180:183], v[92:95], v[96:111]
    v_cvt_pk_bf16_f32 v80, v48, v49
    v_exp_f32 v51, v51
    v_exp_f32 v52, v52
    v_cvt_pk_bf16_f32 v81, v50, v51
    v_exp_f32 v53, v53
    v_exp_f32 v54, v54
    v_cvt_pk_bf16_f32 v82, v52, v53
    v_mfma_f32_32x32x16_bf16 v[64:79], v[196:199], v[20:23], 0
    v_exp_f32 v55, v55
    v_exp_f32 v56, v56
    v_cvt_pk_bf16_f32 v83, v54, v55
    v_exp_f32 v57, v57
    v_exp_f32 v58, v58
    v_mfma_f32_32x32x16_bf16 v[96:111], v[188:191], v[80:83], v[96:111]
    v_cvt_pk_bf16_f32 v84, v56, v57
    v_exp_f32 v59, v59
    v_exp_f32 v60, v60
    v_cvt_pk_bf16_f32 v85, v58, v59
    v_exp_f32 v61, v61
    v_exp_f32 v62, v62
    v_cvt_pk_bf16_f32 v86, v60, v61
    v_exp_f32 v63, v63
    v_exp_f32 v64, v64
    v_cvt_pk_bf16_f32 v87, v62, v63
    v_exp_f32 v65, v65
    v_exp_f32 v66, v66
    v_mfma_f32_32x32x16_bf16 v[96:111], v[192:195], v[84:87], v[96:111]
    v_cvt_pk_bf16_f32 v88, v64, v65
    v_exp_f32 v67, v67
    v_exp_f32 v68, v68
    v_cvt_pk_bf16_f32 v89, v66, v67
    v_exp_f32 v69, v69
    v_exp_f32 v70, v70
    v_cvt_pk_bf16_f32 v90, v68, v69
    v_mfma_f32_32x32x16_bf16 v[48:63], v[208:211], v[20:23], 0
    v_exp_f32 v71, v71
    v_exp_f32 v72, v72
    v_cvt_pk_bf16_f32 v91, v70, v71
    v_exp_f32 v73, v73
    v_exp_f32 v74, v74
    v_mfma_f32_32x32x16_bf16 v[96:111], v[200:203], v[88:91], v[96:111]
    v_cvt_pk_bf16_f32 v92, v72, v73
    v_exp_f32 v75, v75
    v_exp_f32 v76, v76
    v_cvt_pk_bf16_f32 v93, v74, v75
    v_exp_f32 v77, v77
    v_exp_f32 v78, v78
    v_cvt_pk_bf16_f32 v94, v76, v77
    v_exp_f32 v79, v79
    s_cmp_eq_u32 s26, 3
    s_cbranch_scc1 L_ex15
    v_exp_f32 v48, v48
    v_cvt_pk_bf16_f32 v95, v78, v79
    v_exp_f32 v49, v49
    v_exp_f32 v50, v50
    v_mfma_f32_32x32x16_bf16 v[96:111], v[204:207], v[92:95], v[96:111]
    v_cvt_pk_bf16_f32 v80, v48, v49
    v_exp_f32 v51, v51
    v_exp_f32 v52, v52
    v_cvt_pk_bf16_f32 v81, v50, v51
    v_exp_f32 v53, v53
    v_exp_f32 v54, v54
    v_cvt_pk_bf16_f32 v82, v52, v53
    v_mfma_f32_32x32x16_bf16 v[64:79], v[220:223], v[20:23], v[32:47]
    v_exp_f32 v55, v55
    v_exp_f32 v56, v56
    v_cvt_pk_bf16_f32 v83, v54, v55
    v_exp_f32 v57, v57
    v_exp_f32 v58, v58
    v_mfma_f32_32x32x16_bf16 v[96:111], v[212:215], v[80:83], v[96:111]
    v_cvt_pk_bf16_f32 v84, v56, v57
    v_exp_f32 v59, v59
    v_exp_f32 v60, v60
    v_cvt_pk_bf16_f32 v85, v58, v59
    v_exp_f32 v61, v61
    v_exp_f32 v62, v62
    v_cvt_pk_bf16_f32 v86, v60, v61
    v_exp_f32 v63, v63
    v_exp_f32 v64, v64
    v_cvt_pk_bf16_f32 v87, v62, v63
    v_exp_f32 v65, v65
    v_exp_f32 v66, v66
    v_mfma_f32_32x32x16_bf16 v[96:111], v[216:219], v[84:87], v[96:111]
    v_cvt_pk_bf16_f32 v88, v64, v65
    v_exp_f32 v67, v67
    v_exp_f32 v68, v68
    v_cvt_pk_bf16_f32 v89, v66, v67
    v_exp_f32 v69, v69
    v_exp_f32 v70, v70
    v_cvt_pk_bf16_f32 v90, v68, v69
    v_exp_f32 v71, v71
    v_exp_f32 v72, v72
    v_cvt_pk_bf16_f32 v91, v70, v71
    v_exp_f32 v73, v73
    v_exp_f32 v74, v74
    v_mfma_f32_32x32x16_bf16 v[96:111], v[224:227], v[88:91], v[96:111]
    v_cvt_pk_bf16_f32 v92, v72, v73
    v_exp_f32 v75, v75
    v_exp_f32 v76, v76
    v_cvt_pk_bf16_f32 v93, v74, v75
    v_exp_f32 v77, v77
    v_exp_f32 v78, v78
    v_cvt_pk_bf16_f32 v94, v76, v77
    v_exp_f32 v79, v79
    s_nop 0
    v_cvt_pk_bf16_f32 v95, v78, v79
    s_nop 1
    v_mfma_f32_32x32x16_bf16 v[96:111], v[228:231], v[92:95], v[96:111]
L_attn_done:
    ds_read_b64 v[6:7], v2 offset:32
    s_cmp_lg_u32 s60, 0
    s_cbranch_scc1 L_attn_slow
    s_nop 7
    s_nop 1
    v_cmp_nle_f32 vcc, 0x12800000, v104
    v_cmp_nge_f32 s[54:55], s53, v104
    s_or_b64 vcc, vcc, s[54:55]
    s_cbranch_vccnz L_attn_slow
L_attn_fin:
    v_rcp_f32 v4, v104
    s_mov_b64 exec, 0xff
    buffer_atomic_swap v14, v13, s[40:43], s98 offen offset:512 sc1
    s_mov_b64 exec, -1
    v_pk_mul_f32 v[96:97], v[4:5], v[96:97] op_sel_hi:[0,1]
    v_pk_mul_f32 v[98:99], v[4:5], v[98:99] op_sel_hi:[0,1]
    v_pk_mul_f32 v[100:101], v[4:5], v[100:101] op_sel_hi:[0,1]
    v_pk_mul_f32 v[102:103], v[4:5], v[102:103] op_sel_hi:[0,1]
    v_cvt_pk_bf16_f32 v96, v96, v97
    v_cvt_pk_bf16_f32 v97, v98, v99
    v_cvt_pk_bf16_f32 v98, v100, v101
    v_cvt_pk_bf16_f32 v99, v102, v103
    buffer_store_dwordx4 v[96:99], v10, s[40:43], s58 offen sc1
    v_add3_u32 v5, v96, v97, s65
    v_add3_u32 v5, v5, v98, v99
    s_nop 1
    v_add_u32_dpp v5, v5, v5 quad_perm:[1,0,3,2] row_mask:0xf bank_mask:0xf
    s_nop 1
    v_add_u32_dpp v5, v5, v5 quad_perm:[2,3,0,1] row_mask:0xf bank_mask:0xf
    buffer_store_dword v5, v19, s[40:43], s59 offen sc1
    s_waitcnt lgkmcnt(0)
    v_readfirstlane_b32 s68, v6
    s_lshr_b32 s68, s68, s75
    s_and_b32 s68, s68, 0xff
    s_cmp_eq_u32 s68, 0xff
    s_cbranch_scc0 CL_21
CD_22:
    buffer_load_dwordx4 v[136:139], v10, s[40:43], s61 offen offset:0 sc1
    buffer_load_dwordx4 v[140:143], v10, s[40:43], s61 offen offset:1024 sc1
    buffer_load_dwordx4 v[144:147], v10, s[40:43], s61 offen offset:2048 sc1
    buffer_load_dwordx4 v[148:151], v10, s[40:43], s61 offen offset:3072 sc1
    buffer_load_dwordx4 v[152:155], v10, s[40:43], s63 offen offset:0 sc1
    buffer_load_dwordx4 v[156:159], v10, s[40:43], s63 offen offset:1024 sc1
    buffer_load_dwordx4 v[160:163], v10, s[40:43], s63 offen offset:2048 sc1
    buffer_load_dwordx4 v[164:167], v10, s[40:43], s63 offen offset:3072 sc1
    buffer_load_dword v232, v12, s[40:43], s74 offen offset:2048 sc1
    buffer_load_dword v233, v12, s[40:43], s74 offen offset:2304 sc1
    s_lshl_b32 s72, s3, 10
    v_add_u32 v28, s72, v10
    v_add_u32 v28, v28, v2
    v_xor_b32 v22, 16, v133
    ds_read_b64 v[24:25], v2 offset:0
    ds_read_b64 v[26:27], v2 offset:64
    ds_read_b32 v29, v134 offset:1152
    ds_read_b32 v31, v134 offset:1024
    ds_read_b128 v[112:115], v28 offset:4096
    ds_read_b128 v[116:119], v28 offset:8192
    ds_read_b64 v[120:121], v133 offset:4096
    ds_read_b64 v[122:123], v22 offset:4096
    ds_read_b64 v[124:125], v133 offset:0
    ds_read_b64 v[126:127], v22 offset:0
    s_waitcnt lgkmcnt(0)
    v_min_u32 v26, v26, v27
    v_add_u32 v26, 3, v26
    v_min3_u32 v24, v24, v25, v26
    s_nop 0
    v_readfirstlane_b32 s68, v24
    s_cmp_ge_u32 s68, 11
    s_cbranch_scc0 CL_23
CD_24:
    ds_read_b64_tr_b16 v[168:169], v130 offset:0
    ds_read_b64_tr_b16 v[170:171], v130 offset:1024
    ds_read_b64_tr_b16 v[176:177], v130 offset:2048
    ds_read_b64_tr_b16 v[178:179], v130 offset:3072
    ds_read_b64_tr_b16 v[184:185], v130 offset:4096
    ds_read_b64_tr_b16 v[186:187], v130 offset:5120
    ds_read_b64_tr_b16 v[192:193], v130 offset:6144
    ds_read_b64_tr_b16 v[194:195], v130 offset:7168
    ds_read_b64_tr_b16 v[200:201], v130 offset:8192
    ds_read_b64_tr_b16 v[202:203], v130 offset:9216
    ds_read_b64_tr_b16 v[208:209], v130 offset:10240
    ds_read_b64_tr_b16 v[210:211], v130 offset:11264
    ds_read_b64_tr_b16 v[216:217], v130 offset:12288
    ds_read_b64_tr_b16 v[218:219], v130 offset:13312
    ds_read_b64_tr_b16 v[224:225], v130 offset:14336
    ds_read_b64_tr_b16 v[226:227], v130 offset:15360
    ds_read_b64_tr_b16 v[172:173], v131 offset:0
    ds_read_b64_tr_b16 v[174:175], v131 offset:1024
    ds_read_b64_tr_b16 v[180:181], v131 offset:2048
    ds_read_b64_tr_b16 v[182:183], v131 offset:3072
    ds_read_b64_tr_b16 v[188:189], v131 offset:4096
    ds_read_b64_tr_b16 v[190:191], v131 offset:5120
    ds_read_b64_tr_b16 v[196:197], v131 offset:6144
    ds_read_b64_tr_b16 v[198:199], v131 offset:7168
    ds_read_b64_tr_b16 v[204:205], v131 offset:8192
    ds_read_b64_tr_b16 v[206:207], v131 offset:9216
    ds_read_b64_tr_b16 v[212:213], v131 offset:10240
    ds_read_b64_tr_b16 v[214:215], v131 offset:11264
    ds_read_b64_tr_b16 v[220:221], v131 offset:12288
    ds_read_b64_tr_b16 v[222:223], v131 offset:13312
    ds_read_b64_tr_b16 v[228:229], v131 offset:14336
    ds_read_b64_tr_b16 v[230:231], v131 offset:15360
    v_xor_b32 v16, 49152, v132
    v_xor_b32 v17, 32768, v132
    v_xor_b32 v18, 16384, v132
    s_lshl_b32 s72, s3, 2
    v_add_u32 v20, s72, v2
    v_mov_b32 v21, 1
    v_cmp_ne_u32 s[56:57], 0, v29
    v_cmp_ne_u32 s[58:59], 0, v31
    s_mov_b32 s67, 0
    v_lshlrev_b32 v96, 16, v120
    v_and_b32 v97, 0xffff0000, v120
    v_lshlrev_b32 v98, 16, v121
    v_and_b32 v99, 0xffff0000, v121
    v_lshlrev_b32 v100, 16, v122
    v_and_b32 v101, 0xffff0000, v122
    v_lshlrev_b32 v102, 16, v123
    v_and_b32 v103, 0xffff0000, v123
    v_lshlrev_b32 v104, 16, v112
    v_and_b32 v105, 0xffff0000, v112
    v_lshlrev_b32 v106, 16, v113
    v_and_b32 v107, 0xffff0000, v113
    v_lshlrev_b32 v108, 16, v114
    v_and_b32 v109, 0xffff0000, v114
    v_lshlrev_b32 v110, 16, v115
    v_and_b32 v111, 0xffff0000, v115
    s_cmp_lg_u64 s[56:57], 0
    s_cbranch_scc1 FX_25
FD_26:
    v_lshlrev_b32 v236, 16, v124
    v_and_b32 v237, 0xffff0000, v124
    v_lshlrev_b32 v238, 16, v125
    v_and_b32 v239, 0xffff0000, v125
    v_lshlrev_b32 v240, 16, v126
    v_and_b32 v241, 0xffff0000, v126
    v_lshlrev_b32 v242, 16, v127
    v_and_b32 v243, 0xffff0000, v127
    v_lshlrev_b32 v244, 16, v116
    v_and_b32 v245, 0xffff0000, v116
    v_lshlrev_b32 v246, 16, v117
    v_and_b32 v247, 0xffff0000, v117
    v_lshlrev_b32 v248, 16, v118
    v_and_b32 v249, 0xffff0000, v118
    v_lshlrev_b32 v250, 16, v119
    v_and_b32 v251, 0xffff0000, v119
    s_cmp_lg_u64 s[58:59], 0
    s_cbranch_scc1 FX_27
FD_28:
    s_mov_b32 s76, 0
L_pm0:
    s_waitcnt vmcnt(9) lgkmcnt(15)
    v_mfma_f32_32x32x16_bf16 v[32:47], v[168:171], v[136:139], 0
    s_waitcnt vmcnt(8) lgkmcnt(15)
    v_mfma_f32_32x32x16_bf16 v[32:47], v[176:179], v[140:143], v[32:47]
    s_waitcnt vmcnt(7) lgkmcnt(15)
    v_mfma_f32_32x32x16_bf16 v[32:47], v[184:187], v[144:147], v[32:47]
    s_waitcnt vmcnt(6) lgkmcnt(15)
    v_mfma_f32_32x32x16_bf16 v[32:47], v[192:195], v[148:151], v[32:47]
    s_waitcnt vmcnt(5) lgkmcnt(15)
    v_mfma_f32_32x32x16_bf16 v[32:47], v[200:203], v[152:155], v[32:47]
    s_waitcnt vmcnt(4) lgkmcnt(15)
    v_mfma_f32_32x32x16_bf16 v[32:47], v[208:211], v[156:159], v[32:47]
    s_waitcnt vmcnt(3) lgkmcnt(15)
    v_mfma_f32_32x32x16_bf16 v[32:47], v[216:219], v[160:163], v[32:47]
    s_waitcnt vmcnt(2) lgkmcnt(15)
    v_mfma_f32_32x32x16_bf16 v[32:47], v[224:227], v[164:167], v[32:47]
    s_waitcnt vmcnt(0)
    s_waitcnt lgkmcnt(14)
    v_mfma_f32_32x32x16_bf16 v[48:63], v[172:175], v[136:139], 0
    v_add3_u32 v4, v136, v137, s64
    v_add3_u32 v5, v152, v153, 0
    v_add3_u32 v4, v4, v138, v139
    v_add3_u32 v5, v5, v154, v155
    v_add3_u32 v4, v4, v140, v141
    v_add3_u32 v5, v5, v156, v157
    s_waitcnt lgkmcnt(12)
    v_mfma_f32_32x32x16_bf16 v[48:63], v[180:183], v[140:143], v[48:63]
    v_add3_u32 v4, v4, v142, v143
    v_add3_u32 v5, v5, v158, v159
    v_add3_u32 v4, v4, v144, v145
    v_add3_u32 v5, v5, v160, v161
    v_add3_u32 v4, v4, v146, v147
    v_add3_u32 v5, v5, v162, v163
    s_waitcnt lgkmcnt(10)
    v_mfma_f32_32x32x16_bf16 v[48:63], v[188:191], v[144:147], v[48:63]
    v_add3_u32 v4, v4, v148, v149
    v_add3_u32 v5, v5, v164, v165
    v_add3_u32 v4, v4, v150, v151
    v_add3_u32 v5, v5, v166, v167
    v_sub_u32 v4, v4, v232
    v_sub_u32 v5, v5, v233
    s_waitcnt lgkmcnt(0)
    v_mfma_f32_32x32x16_bf16 v[48:63], v[196:199], v[148:151], v[48:63]
    v_add_u32 v4, v4, v5
    s_nop 1
    v_add_u32_dpp v4, v4, v4 quad_perm:[1,0,3,2] row_mask:0xf bank_mask:0xf
    s_nop 1
    v_add_u32_dpp v4, v4, v4 quad_perm:[2,3,0,1] row_mask:0xf bank_mask:0xf
    v_cmp_ne_u32 vcc, 0, v4
    ds_read_b32 v7, v2 offset:36
    s_nop 0
    v_mfma_f32_32x32x16_bf16 v[48:63], v[204:207], v[152:155], v[48:63]
    s_cbranch_vccnz L_redo0
    ds_write_b128 v132, v[32:35] offset:0
    s_nop 0
    v_mfma_f32_32x32x16_bf16 v[48:63], v[212:215], v[156:159], v[48:63]
    ds_read_b32 v7, v2 offset:36
    ds_write_b128 v132, v[36:39] offset:1024
    s_waitcnt lgkmcnt(3)
    v_readfirstlane_b32 s68, v7
    s_lshr_b32 s68, s68, s75
    s_and_b32 s68, s68, 0xff
    s_cmp_eq_u32 s68, 0xff
    s_cbranch_scc1 PB_29
PD_30:
    s_nop 0
    v_mfma_f32_32x32x16_bf16 v[48:63], v[220:223], v[160:163], v[48:63]
    ds_write_b128 v132, v[40:43] offset:2048
    s_nop 0
    v_mfma_f32_32x32x16_bf16 v[48:63], v[228:231], v[164:167], v[48:63]
    ds_write_b128 v132, v[44:47] offset:3072
    s_waitcnt lgkmcnt(3)
    v_readfirstlane_b32 s68, v7
    s_lshr_b32 s68, s68, s75
    s_and_b32 s68, s68, 0xff
    s_cmp_eq_u32 s68, 0xff
    s_cbranch_scc1 PB_31
PD_32:
L_rd0:
    ds_read_b32 v7, v2 offset:36
    s_nop 7
    ds_write_b128 v132, v[48:51] offset:4096
    ds_write_b128 v132, v[52:55] offset:5120
    ds_write_b32 v20, v21 offset:80
    s_cmp_lg_u32 s76, 0
    s_cbranch_scc1 L_bi
    s_mov_b32 s67, 0
BW_33:
    s_waitcnt lgkmcnt(0)
    v_readfirstlane_b32 s68, v7
    s_lshr_b32 s68, s68, s75
    s_and_b32 s68, s68, 0xff
    s_cmp_eq_u32 s68, 0xff
    s_cbranch_scc1 BW_33d
    ds_read_b32 v7, v2 offset:36
    s_add_u32 s67, s67, 1
    s_cmp_lt_u32 s67, 4194304
    s_cbranch_scc1 BW_33
BW_33d:
    buffer_load_dwordx4 v[64:67], v10, s[40:43], s38 offen offset:0 sc1
    buffer_load_dwordx4 v[68:71], v10, s[40:43], s38 offen offset:1024 sc1
    buffer_load_dwordx4 v[72:75], v10, s[40:43], s38 offen offset:2048 sc1
    buffer_load_dwordx4 v[76:79], v10, s[40:43], s38 offen offset:3072 sc1
    buffer_load_dwordx4 v[80:83], v10, s[40:43], s39 offen offset:0 sc1
    buffer_load_dwordx4 v[84:87], v10, s[40:43], s39 offen offset:1024 sc1
    buffer_load_dwordx4 v[88:91], v10, s[40:43], s39 offen offset:2048 sc1
    buffer_load_dwordx4 v[92:95], v10, s[40:43], s39 offen offset:3072 sc1
    buffer_load_dword v234, v12, s[40:43], s74 offen offset:0 sc1
    buffer_load_dword v235, v12, s[40:43], s74 offen offset:256 sc1
L_bi:
    ds_read_b128 v[4:7], v2 offset:80
    ds_read_b128 v[136:139], v16 offset:0
    ds_read_b128 v[140:143], v16 offset:1024
    ds_read_b128 v[144:147], v17 offset:2048
    ds_read_b128 v[148:151], v17 offset:3072
    ds_read_b128 v[152:155], v18 offset:4096
    ds_read_b128 v[156:159], v18 offset:5120
    v_pk_fma_f32 v[96:97], v[104:105], v[56:57], v[96:97]
    v_pk_fma_f32 v[98:99], v[106:107], v[58:59], v[98:99]
    v_pk_fma_f32 v[100:101], v[108:109], v[60:61], v[100:101]
    v_pk_fma_f32 v[102:103], v[110:111], v[62:63], v[102:103]
    s_waitcnt lgkmcnt(6)
    v_min_u32 v4, v4, v5
    v_min3_u32 v4, v4, v6, v7
    s_nop 0
    v_readfirstlane_b32 s68, v4
    s_cmp_lg_u32 s68, 0
    s_cbranch_scc0 CL_34
CD_35:
    s_waitcnt lgkmcnt(4)
    v_pk_fma_f32 v[96:97], v[104:105], v[136:137], v[96:97]
    v_pk_fma_f32 v[98:99], v[106:107], v[138:139], v[98:99]
    v_pk_fma_f32 v[100:101], v[108:109], v[140:141], v[100:101]
    v_pk_fma_f32 v[102:103], v[110:111], v[142:143], v[102:103]
    s_waitcnt lgkmcnt(2)
    v_pk_fma_f32 v[96:97], v[104:105], v[144:145], v[96:97]
    v_pk_fma_f32 v[98:99], v[106:107], v[146:147], v[98:99]
    v_pk_fma_f32 v[100:101], v[108:109], v[148:149], v[100:101]
    v_pk_fma_f32 v[102:103], v[110:111], v[150:151], v[102:103]
    s_waitcnt lgkmcnt(0)
    v_pk_fma_f32 v[96:97], v[104:105], v[152:153], v[96:97]
    v_pk_fma_f32 v[98:99], v[106:107], v[154:155], v[98:99]
    v_pk_fma_f32 v[100:101], v[108:109], v[156:157], v[100:101]
    v_pk_fma_f32 v[102:103], v[110:111], v[158:159], v[102:103]
    v_cvt_pk_bf16_f32 v40, v96, v97
    v_cvt_pk_bf16_f32 v41, v98, v99
    v_cvt_pk_bf16_f32 v42, v100, v101
    v_cvt_pk_bf16_f32 v43, v102, v103
    s_cmp_lg_u64 s[56:57], 0
    s_cbranch_scc1 HX_36
HD_37:
    s_nop 0
    v_permlane32_swap_b32 v40, v42
    v_permlane32_swap_b32 v41, v43
L_e0d:
    s_mov_b32 s67, 0
L_pm1:
    s_waitcnt vmcnt(9)
    v_mfma_f32_32x32x16_bf16 v[96:111], v[168:171], v[64:67], 0
    s_waitcnt vmcnt(8)
    v_mfma_f32_32x32x16_bf16 v[96:111], v[176:179], v[68:71], v[96:111]
    s_waitcnt vmcnt(7)
    v_mfma_f32_32x32x16_bf16 v[96:111], v[184:187], v[72:75], v[96:111]
    s_waitcnt vmcnt(6)
    v_mfma_f32_32x32x16_bf16 v[96:111], v[192:195], v[76:79], v[96:111]
    s_waitcnt vmcnt(5)
    v_mfma_f32_32x32x16_bf16 v[96:111], v[200:203], v[80:83], v[96:111]
    s_waitcnt vmcnt(4)
    v_mfma_f32_32x32x16_bf16 v[96:111], v[208:211], v[84:87], v[96:111]
    s_waitcnt vmcnt(3)
    v_mfma_f32_32x32x16_bf16 v[96:111], v[216:219], v[88:91], v[96:111]
    s_waitcnt vmcnt(2)
    v_mfma_f32_32x32x16_bf16 v[96:111], v[224:227], v[92:95], v[96:111]
    s_waitcnt vmcnt(0)
    v_mfma_f32_32x32x16_bf16 v[112:127], v[172:175], v[64:67], 0
    v_add3_u32 v4, v64, v65, s64
    v_add3_u32 v5, v80, v81, 0
    v_add3_u32 v4, v4, v66, v67
    v_add3_u32 v5, v5, v82, v83
    v_add3_u32 v4, v4, v68, v69
    v_add3_u32 v5, v5, v84, v85
    v_mfma_f32_32x32x16_bf16 v[112:127], v[180:183], v[68:71], v[112:127]
    v_add3_u32 v4, v4, v70, v71
    v_add3_u32 v5, v5, v86, v87
    v_add3_u32 v4, v4, v72, v73
    v_add3_u32 v5, v5, v88, v89
    v_add3_u32 v4, v4, v74, v75
    v_add3_u32 v5, v5, v90, v91
    v_mfma_f32_32x32x16_bf16 v[112:127], v[188:191], v[72:75], v[112:127]
    v_add3_u32 v4, v4, v76, v77
    v_add3_u32 v5, v5, v92, v93
    v_add3_u32 v4, v4, v78, v79
    v_add3_u32 v5, v5, v94, v95
    v_sub_u32 v4, v4, v234
    v_sub_u32 v5, v5, v235
    v_mfma_f32_32x32x16_bf16 v[112:127], v[196:199], v[76:79], v[112:127]
    v_add_u32 v4, v4, v5
    s_nop 1
    v_add_u32_dpp v4, v4, v4 quad_perm:[1,0,3,2] row_mask:0xf bank_mask:0xf
    s_nop 1
    v_add_u32_dpp v4, v4, v4 quad_perm:[2,3,0,1] row_mask:0xf bank_mask:0xf
    v_cmp_ne_u32 vcc, 0, v4
    v_mfma_f32_32x32x16_bf16 v[112:127], v[204:207], v[80:83], v[112:127]
    s_not_b64 exec, s[56:57]
    buffer_store_dwordx4 v[40:43], v135, s[44:47], s101 offen
    s_mov_b64 exec, -1
    s_cbranch_vccnz L_redo1
    ds_write_b128 v132, v[96:99] offset:8192
    v_mfma_f32_32x32x16_bf16 v[112:127], v[212:215], v[84:87], v[112:127]
    ds_write_b128 v132, v[100:103] offset:9216
    v_mfma_f32_32x32x16_bf16 v[112:127], v[220:223], v[88:91], v[112:127]
    ds_write_b128 v132, v[104:107] offset:10240
    v_mfma_f32_32x32x16_bf16 v[112:127], v[228:231], v[92:95], v[112:127]
    ds_write_b128 v132, v[108:111] offset:11264
L_rd1:
    s_nop 7
    s_nop 3
    ds_write_b128 v132, v[112:115] offset:12288
    ds_write_b128 v132, v[116:119] offset:13312
    ds_write_b32 v20, v21 offset:96
    ds_read_b128 v[4:7], v2 offset:96
    ds_read_b128 v[64:67], v16 offset:8192
    ds_read_b128 v[68:71], v16 offset:9216
    ds_read_b128 v[72:75], v17 offset:10240
    ds_read_b128 v[76:79], v17 offset:11264
    ds_read_b128 v[80:83], v18 offset:12288
    ds_read_b128 v[84:87], v18 offset:13312
    v_pk_fma_f32 v[236:237], v[244:245], v[120:121], v[236:237]
    v_pk_fma_f32 v[238:239], v[246:247], v[122:123], v[238:239]
    v_pk_fma_f32 v[240:241], v[248:249], v[124:125], v[240:241]
    v_pk_fma_f32 v[242:243], v[250:251], v[126:127], v[242:243]
    s_waitcnt lgkmcnt(6)
    v_min_u32 v4, v4, v5
    v_min3_u32 v4, v4, v6, v7
    s_nop 0
    v_readfirstlane_b32 s68, v4
    s_cmp_lg_u32 s68, 0
    s_cbranch_scc0 CL_38
CD_39:
    s_waitcnt lgkmcnt(4)
    v_pk_fma_f32 v[236:237], v[244:245], v[64:65], v[236:237]
    v_pk_fma_f32 v[238:239], v[246:247], v[66:67], v[238:239]
    v_pk_fma_f32 v[240:241], v[248:249], v[68:69], v[240:241]
    v_pk_fma_f32 v[242:243], v[250:251], v[70:71], v[242:243]
    s_waitcnt lgkmcnt(2)
    v_pk_fma_f32 v[236:237], v[244:245], v[72:73], v[236:237]
    v_pk_fma_f32 v[238:239], v[246:247], v[74:75], v[238:239]
    v_pk_fma_f32 v[240:241], v[248:249], v[76:77], v[240:241]
    v_pk_fma_f32 v[242:243], v[250:251], v[78:79], v[242:243]
    s_waitcnt lgkmcnt(0)
    v_pk_fma_f32 v[236:237], v[244:245], v[80:81], v[236:237]
    v_pk_fma_f32 v[238:239], v[246:247], v[82:83], v[238:239]
    v_pk_fma_f32 v[240:241], v[248:249], v[84:85], v[240:241]
    v_pk_fma_f32 v[242:243], v[250:251], v[86:87], v[242:243]
    v_cvt_pk_bf16_f32 v104, v236, v237
    v_cvt_pk_bf16_f32 v105, v238, v239
    v_cvt_pk_bf16_f32 v106, v240, v241
    v_cvt_pk_bf16_f32 v107, v242, v243
    s_cmp_lg_u64 s[58:59], 0
    s_cbranch_scc1 HX_40
HD_41:
    s_nop 0
    v_permlane32_swap_b32 v104, v106
    v_permlane32_swap_b32 v105, v107
    s_not_b64 exec, s[58:59]
    buffer_store_dwordx4 v[104:107], v135, s[44:47], s62 offen
L_fin:
    s_endpgm
L_ex2:
    v_cvt_pk_bf16_f32 v87, v62, v63
    s_nop 1
    v_mfma_f32_32x32x16_bf16 v[96:111], v[244:247], v[84:87], v[96:111]
    s_nop 7
    s_nop 7
    s_branch L_afin
L_ex4:
    v_cvt_pk_bf16_f32 v87, v62, v63
    s_nop 1
    v_mfma_f32_32x32x16_bf16 v[112:127], v[156:159], v[84:87], v[112:127]
    s_branch L_exA
L_ex6:
    v_cvt_pk_bf16_f32 v87, v62, v63
    s_nop 1
    v_mfma_f32_32x32x16_bf16 v[112:127], v[180:183], v[84:87], v[112:127]
    s_branch L_exA
L_ex8:
    v_cvt_pk_bf16_f32 v87, v62, v63
    s_nop 1
    v_mfma_f32_32x32x16_bf16 v[112:127], v[204:207], v[84:87], v[112:127]
    s_branch L_exA
L_ex11:
    v_cvt_pk_bf16_f32 v95, v78, v79
    s_nop 1
    v_mfma_f32_32x32x16_bf16 v[96:111], v[156:159], v[92:95], v[96:111]
    s_branch L_attn_done
L_ex13:
    v_cvt_pk_bf16_f32 v95, v78, v79
    s_nop 1
    v_mfma_f32_32x32x16_bf16 v[96:111], v[180:183], v[92:95], v[96:111]
    s_branch L_attn_done
L_ex15:
    v_cvt_pk_bf16_f32 v95, v78, v79
    s_nop 1
    v_mfma_f32_32x32x16_bf16 v[96:111], v[204:207], v[92:95], v[96:111]
    s_branch L_attn_done
L_exA:
    v_mfma_f32_32x32x16_bf16 v[48:63], v[136:139], v[20:23], 0
    s_nop 7
    s_nop 7
    v_exp_f32 v48, v48
    v_exp_f32 v49, v49
    v_exp_f32 v50, v50
    v_cvt_pk_bf16_f32 v80, v48, v49
    v_exp_f32 v51, v51
    v_exp_f32 v52, v52
    v_cvt_pk_bf16_f32 v81, v50, v51
    v_exp_f32 v53, v53
    v_exp_f32 v54, v54
    v_cvt_pk_bf16_f32 v82, v52, v53
    v_mfma_f32_32x32x16_bf16 v[64:79], v[148:151], v[20:23], 0
    v_exp_f32 v55, v55
    v_exp_f32 v56, v56
    v_cvt_pk_bf16_f32 v83, v54, v55
    v_exp_f32 v57, v57
    v_exp_f32 v58, v58
    v_mfma_f32_32x32x16_bf16 v[96:111], v[140:143], v[80:83], v[96:111]
    v_cvt_pk_bf16_f32 v84, v56, v57
    v_exp_f32 v59, v59
    v_exp_f32 v60, v60
    v_cvt_pk_bf16_f32 v85, v58, v59
    v_exp_f32 v61, v61
    v_exp_f32 v62, v62
    v_cvt_pk_bf16_f32 v86, v60, v61
    v_exp_f32 v63, v63
    s_branch L_afin
L_adef:
    s_mov_b32 s60, 1
    s_branch L_afd
L_kr1:
    s_cmp_lt_u32 s26, 4
    s_cbranch_scc1 L_kc1
    s_mov_b32 s76, 1
    s_mov_b32 s67, 0
    s_branch L_kr_go
L_kr3:
    s_cmp_lt_u32 s26, 3
    s_cbranch_scc1 L_kc3
    s_mov_b32 s76, 3
    s_mov_b32 s67, 0
    s_branch L_kr_go
L_kr5:
    s_cmp_lt_u32 s26, 2
    s_cbranch_scc1 L_kc5
    s_mov_b32 s76, 5
    s_mov_b32 s67, 0
    s_branch L_kr_go
L_kr7:
    s_cmp_lt_u32 s26, 1
    s_cbranch_scc1 L_kc7
    s_mov_b32 s76, 7
    s_mov_b32 s67, 0
    s_branch L_kr_go
L_kr_go:
    s_waitcnt vmcnt(0)
    s_mov_b32 s77, 0
    s_cmp_eq_u32 s76, 1
    s_cbranch_scc1 L_ch1
    s_cmp_eq_u32 s76, 3
    s_cbranch_scc1 L_ch3
    s_cmp_eq_u32 s76, 5
    s_cbranch_scc1 L_ch5
L_ch7:
    v_add3_u32 v4, v136, v137, v138
    v_add3_u32 v5, v140, v141, v142
    v_add3_u32 v4, v4, v139, v143
    v_add3_u32 v4, v4, v5, s65
    s_nop 1
    v_add_u32_dpp v4, v4, v4 quad_perm:[1,0,3,2] row_mask:0xf bank_mask:0xf
    s_nop 1
    v_add_u32_dpp v4, v4, v4 quad_perm:[2,3,0,1] row_mask:0xf bank_mask:0xf
    v_cmp_ne_u32 vcc, v129, v4
    s_or_b32 s68, vcc_lo, vcc_hi
    s_and_b32 s68, s68, 0x88888888
    s_cbranch_scc0 L_cs7
    buffer_load_dwordx4 v[136:139], v10, s[40:43], s35 offen offset:1024 sc1
    buffer_load_dwordx4 v[140:143], v11, s[40:43], s35 offen offset:1024 sc1
    buffer_load_dword v129, v12, s[40:43], s36 offen offset:256 sc1
    s_bitset1_b32 s77, 7
L_cs7:
L_ch6:
    v_add3_u32 v4, v148, v149, v150
    v_add3_u32 v5, v152, v153, v154
    v_add3_u32 v4, v4, v151, v155
    v_add3_u32 v4, v4, v5, s65
    s_nop 1
    v_add_u32_dpp v4, v4, v4 quad_perm:[1,0,3,2] row_mask:0xf bank_mask:0xf
    s_nop 1
    v_add_u32_dpp v4, v4, v4 quad_perm:[2,3,0,1] row_mask:0xf bank_mask:0xf
    v_cmp_ne_u32 vcc, v129, v4
    s_or_b32 s68, vcc_lo, vcc_hi
    s_and_b32 s68, s68, 0x44444444
    s_cbranch_scc0 L_cs6
    buffer_load_dwordx4 v[148:151], v10, s[40:43], s35 offen offset:0 sc1
    buffer_load_dwordx4 v[152:155], v11, s[40:43], s35 offen offset:0 sc1
    buffer_load_dword v129, v12, s[40:43], s36 offen offset:256 sc1
    s_bitset1_b32 s77, 6
L_cs6:
L_ch5:
    v_add3_u32 v4, v160, v161, v162
    v_add3_u32 v5, v164, v165, v166
    v_add3_u32 v4, v4, v163, v167
    v_add3_u32 v4, v4, v5, s65
    s_nop 1
    v_add_u32_dpp v4, v4, v4 quad_perm:[1,0,3,2] row_mask:0xf bank_mask:0xf
    s_nop 1
    v_add_u32_dpp v4, v4, v4 quad_perm:[2,3,0,1] row_mask:0xf bank_mask:0xf
    v_cmp_ne_u32 vcc, v129, v4
    s_or_b32 s68, vcc_lo, vcc_hi
    s_and_b32 s68, s68, 0x22222222
    s_cbranch_scc0 L_cs5
    buffer_load_dwordx4 v[160:163], v10, s[40:43], s34 offen offset:1024 sc1
    buffer_load_dwordx4 v[164:167], v11, s[40:43], s34 offen offset:1024 sc1
    buffer_load_dword v129, v12, s[40:43], s36 offen offset:256 sc1
    s_bitset1_b32 s77, 5
L_cs5:
L_ch4:
    v_add3_u32 v4, v172, v173, v174
    v_add3_u32 v5, v176, v177, v178
    v_add3_u32 v4, v4, v175, v179
    v_add3_u32 v4, v4, v5, s65
    s_nop 1
    v_add_u32_dpp v4, v4, v4 quad_perm:[1,0,3,2] row_mask:0xf bank_mask:0xf
    s_nop 1
    v_add_u32_dpp v4, v4, v4 quad_perm:[2,3,0,1] row_mask:0xf bank_mask:0xf
    v_cmp_ne_u32 vcc, v129, v4
    s_or_b32 s68, vcc_lo, vcc_hi
    s_and_b32 s68, s68, 0x11111111
    s_cbranch_scc0 L_cs4
    buffer_load_dwordx4 v[172:175], v10, s[40:43], s34 offen offset:0 sc1
    buffer_load_dwordx4 v[176:179], v11, s[40:43], s34 offen offset:0 sc1
    buffer_load_dword v129, v12, s[40:43], s36 offen offset:256 sc1
    s_bitset1_b32 s77, 4
L_cs4:
L_ch3:
    v_add3_u32 v4, v184, v185, v186
    v_add3_u32 v5, v188, v189, v190
    v_add3_u32 v4, v4, v187, v191
    v_add3_u32 v4, v4, v5, s65
    s_nop 1
    v_add_u32_dpp v4, v4, v4 quad_perm:[1,0,3,2] row_mask:0xf bank_mask:0xf
    s_nop 1
    v_add_u32_dpp v4, v4, v4 quad_perm:[2,3,0,1] row_mask:0xf bank_mask:0xf
    v_cmp_ne_u32 vcc, v128, v4
    s_or_b32 s68, vcc_lo, vcc_hi
    s_and_b32 s68, s68, 0x88888888
    s_cbranch_scc0 L_cs3
    buffer_load_dwordx4 v[184:187], v10, s[40:43], s33 offen offset:1024 sc1
    buffer_load_dwordx4 v[188:191], v11, s[40:43], s33 offen offset:1024 sc1
    buffer_load_dword v128, v12, s[40:43], s36 offen offset:0 sc1
    s_bitset1_b32 s77, 3
L_cs3:
L_ch2:
    v_add3_u32 v4, v196, v197, v198
    v_add3_u32 v5, v200, v201, v202
    v_add3_u32 v4, v4, v199, v203
    v_add3_u32 v4, v4, v5, s65
    s_nop 1
    v_add_u32_dpp v4, v4, v4 quad_perm:[1,0,3,2] row_mask:0xf bank_mask:0xf
    s_nop 1
    v_add_u32_dpp v4, v4, v4 quad_perm:[2,3,0,1] row_mask:0xf bank_mask:0xf
    v_cmp_ne_u32 vcc, v128, v4
    s_or_b32 s68, vcc_lo, vcc_hi
    s_and_b32 s68, s68, 0x44444444
    s_cbranch_scc0 L_cs2
    buffer_load_dwordx4 v[196:199], v10, s[40:43], s33 offen offset:0 sc1
    buffer_load_dwordx4 v[200:203], v11, s[40:43], s33 offen offset:0 sc1
    buffer_load_dword v128, v12, s[40:43], s36 offen offset:0 sc1
    s_bitset1_b32 s77, 2
L_cs2:
L_ch1:
    v_add3_u32 v4, v208, v209, v210
    v_add3_u32 v5, v212, v213, v214
    v_add3_u32 v4, v4, v211, v215
    v_add3_u32 v4, v4, v5, s65
    s_nop 1
    v_add_u32_dpp v4, v4, v4 quad_perm:[1,0,3,2] row_mask:0xf bank_mask:0xf
    s_nop 1
    v_add_u32_dpp v4, v4, v4 quad_perm:[2,3,0,1] row_mask:0xf bank_mask:0xf
    v_cmp_ne_u32 vcc, v128, v4
    s_or_b32 s68, vcc_lo, vcc_hi
    s_and_b32 s68, s68, 0x22222222
    s_cbranch_scc0 L_cs1
    buffer_load_dwordx4 v[208:211], v10, s[40:43], s32 offen offset:1024 sc1
    buffer_load_dwordx4 v[212:215], v11, s[40:43], s32 offen offset:1024 sc1
    buffer_load_dword v128, v12, s[40:43], s36 offen offset:0 sc1
    s_bitset1_b32 s77, 1
L_cs1:
L_ch0:
    v_add3_u32 v4, v220, v221, v222
    v_add3_u32 v5, v224, v225, v226
    v_add3_u32 v4, v4, v223, v227
    v_add3_u32 v4, v4, v5, s65
    s_nop 1
    v_add_u32_dpp v4, v4, v4 quad_perm:[1,0,3,2] row_mask:0xf bank_mask:0xf
    s_nop 1
    v_add_u32_dpp v4, v4, v4 quad_perm:[2,3,0,1] row_mask:0xf bank_mask:0xf
    v_cmp_ne_u32 vcc, v128, v4
    s_or_b32 s68, vcc_lo, vcc_hi
    s_and_b32 s68, s68, 0x11111111
    s_cbranch_scc0 L_cs0
    buffer_load_dwordx4 v[220:223], v10, s[40:43], s32 offen offset:0 sc1
    buffer_load_dwordx4 v[224:227], v11, s[40:43], s32 offen offset:0 sc1
    buffer_load_dword v128, v12, s[40:43], s36 offen offset:0 sc1
    s_bitset1_b32 s77, 0
L_cs0:
    s_lshl_b32 s77, s77, 1
    s_lshr_b32 s77, s77, s76
    s_cbranch_scc0 L_kr_ret
    s_add_u32 s67, s67, 1
    s_cmp_lt_u32 s67, 65536
    s_cbranch_scc1 L_kr_go
L_kr_ret:
    s_waitcnt vmcnt(0)
    s_cmp_eq_u32 s76, 1
    s_cbranch_scc1 L_kc1
    s_cmp_eq_u32 s76, 3
    s_cbranch_scc1 L_kc3
    s_cmp_eq_u32 s76, 5
    s_cbranch_scc1 L_kc5
    s_branch L_kc7
L_attn_slow:
    s_nop 7
    s_nop 7
    ds_read_b128 v[32:35], v15 offset:2064
    ds_read_b128 v[36:39], v15 offset:2096
    ds_read_b128 v[40:43], v15 offset:2128
    ds_read_b128 v[44:47], v15 offset:2160
    s_waitcnt lgkmcnt(0)
    v_mov_b32 v30, s52
    v_mov_b32 v31, s52
    s_nop 1
    v_mfma_f32_32x32x16_bf16 v[48:63], v[236:239], v[24:27], v[32:47]
    s_nop 7
    s_nop 7
    v_max3_f32 v31, v48, v49, v31
    v_max3_f32 v31, v50, v51, v31
    v_max3_f32 v31, v52, v53, v31
    v_max3_f32 v31, v54, v55, v31
    v_max3_f32 v31, v56, v57, v31
    v_max3_f32 v31, v58, v59, v31
    v_max3_f32 v31, v60, v61, v31
    v_max3_f32 v31, v62, v63, v31
    s_nop 1
    v_mfma_f32_32x32x16_bf16 v[48:63], v[232:235], v[20:23], v[32:47]
    s_nop 7
    s_nop 7
    v_max3_f32 v30, v48, v49, v30
    v_max3_f32 v30, v50, v51, v30
    v_max3_f32 v30, v52, v53, v30
    v_max3_f32 v30, v54, v55, v30
    v_max3_f32 v30, v56, v57, v30
    v_max3_f32 v30, v58, v59, v30
    v_max3_f32 v30, v60, v61, v30
    v_max3_f32 v30, v62, v63, v30
    s_nop 1
    v_mfma_f32_32x32x16_bf16 v[48:63], v[232:235], v[24:27], 0
    s_nop 7
    s_nop 7
    v_max3_f32 v31, v48, v49, v31
    v_max3_f32 v31, v50, v51, v31
    v_max3_f32 v31, v52, v53, v31
    v_max3_f32 v31, v54, v55, v31
    v_max3_f32 v31, v56, v57, v31
    v_max3_f32 v31, v58, v59, v31
    v_max3_f32 v31, v60, v61, v31
    v_max3_f32 v31, v62, v63, v31
    s_cmp_eq_u32 s26, 0
    s_cbranch_scc1 L_slow_end0
    v_sub_f32 v32, s52, v32
    v_sub_f32 v33, s52, v33
    v_sub_f32 v34, s52, v34
    v_sub_f32 v35, s52, v35
    v_sub_f32 v36, s52, v36
    v_sub_f32 v37, s52, v37
    v_sub_f32 v38, s52, v38
    v_sub_f32 v39, s52, v39
    v_sub_f32 v40, s52, v40
    v_sub_f32 v41, s52, v41
    v_sub_f32 v42, s52, v42
    v_sub_f32 v43, s52, v43
    v_sub_f32 v44, s52, v44
    v_sub_f32 v45, s52, v45
    v_sub_f32 v46, s52, v46
    v_sub_f32 v47, s52, v47
    s_nop 1
    v_mfma_f32_32x32x16_bf16 v[48:63], v[136:139], v[20:23], 0
    s_nop 7
    s_nop 7
    v_max3_f32 v30, v48, v49, v30
    v_max3_f32 v30, v50, v51, v30
    v_max3_f32 v30, v52, v53, v30
    v_max3_f32 v30, v54, v55, v30
    v_max3_f32 v30, v56, v57, v30
    v_max3_f32 v30, v58, v59, v30
    v_max3_f32 v30, v60, v61, v30
    v_max3_f32 v30, v62, v63, v30
    s_nop 1
    v_mfma_f32_32x32x16_bf16 v[48:63], v[136:139], v[24:27], 0
    s_nop 7
    s_nop 7
    v_max3_f32 v31, v48, v49, v31
    v_max3_f32 v31, v50, v51, v31
    v_max3_f32 v31, v52, v53, v31
    v_max3_f32 v31, v54, v55, v31
    v_max3_f32 v31, v56, v57, v31
    v_max3_f32 v31, v58, v59, v31
    v_max3_f32 v31, v60, v61, v31
    v_max3_f32 v31, v62, v63, v31
    s_nop 1
    v_mfma_f32_32x32x16_bf16 v[48:63], v[148:151], v[20:23], 0
    s_nop 7
    s_nop 7
    v_max3_f32 v30, v48, v49, v30
    v_max3_f32 v30, v50, v51, v30
    v_max3_f32 v30, v52, v53, v30
    v_max3_f32 v30, v54, v55, v30
    v_max3_f32 v30, v56, v57, v30
    v_max3_f32 v30, v58, v59, v30
    v_max3_f32 v30, v60, v61, v30
    v_max3_f32 v30, v62, v63, v30
    s_nop 1
    v_mfma_f32_32x32x16_bf16 v[48:63], v[148:151], v[24:27], 0
    s_nop 7
    s_nop 7
    v_max3_f32 v31, v48, v49, v31
    v_max3_f32 v31, v50, v51, v31
    v_max3_f32 v31, v52, v53, v31
    v_max3_f32 v31, v54, v55, v31
    v_max3_f32 v31, v56, v57, v31
    v_max3_f32 v31, v58, v59, v31
    v_max3_f32 v31, v60, v61, v31
    v_max3_f32 v31, v62, v63, v31
    s_cmp_eq_u32 s26, 1
    s_cbranch_scc1 L_slow_end0
    s_nop 1
    v_mfma_f32_32x32x16_bf16 v[48:63], v[160:163], v[20:23], 0
    s_nop 7
    s_nop 7
    v_max3_f32 v30, v48, v49, v30
    v_max3_f32 v30, v50, v51, v30
    v_max3_f32 v30, v52, v53, v30
    v_max3_f32 v30, v54, v55, v30
    v_max3_f32 v30, v56, v57, v30
    v_max3_f32 v30, v58, v59, v30
    v_max3_f32 v30, v60, v61, v30
    v_max3_f32 v30, v62, v63, v30
    s_nop 1
    v_mfma_f32_32x32x16_bf16 v[48:63], v[160:163], v[24:27], 0
    s_nop 7
    s_nop 7
    v_max3_f32 v31, v48, v49, v31
    v_max3_f32 v31, v50, v51, v31
    v_max3_f32 v31, v52, v53, v31
    v_max3_f32 v31, v54, v55, v31
    v_max3_f32 v31, v56, v57, v31
    v_max3_f32 v31, v58, v59, v31
    v_max3_f32 v31, v60, v61, v31
    v_max3_f32 v31, v62, v63, v31
    s_nop 1
    v_mfma_f32_32x32x16_bf16 v[48:63], v[172:175], v[20:23], 0
    s_nop 7
    s_nop 7
    v_max3_f32 v30, v48, v49, v30
    v_max3_f32 v30, v50, v51, v30
    v_max3_f32 v30, v52, v53, v30
    v_max3_f32 v30, v54, v55, v30
    v_max3_f32 v30, v56, v57, v30
    v_max3_f32 v30, v58, v59, v30
    v_max3_f32 v30, v60, v61, v30
    v_max3_f32 v30, v62, v63, v30
    s_nop 1
    v_mfma_f32_32x32x16_bf16 v[48:63], v[172:175], v[24:27], 0
    s_nop 7
    s_nop 7
    v_max3_f32 v31, v48, v49, v31
    v_max3_f32 v31, v50, v51, v31
    v_max3_f32 v31, v52, v53, v31
    v_max3_f32 v31, v54, v55, v31
    v_max3_f32 v31, v56, v57, v31
    v_max3_f32 v31, v58, v59, v31
    v_max3_f32 v31, v60, v61, v31
    v_max3_f32 v31, v62, v63, v31
    s_cmp_eq_u32 s26, 2
    s_cbranch_scc1 L_slow_end0
    s_nop 1
    v_mfma_f32_32x32x16_bf16 v[48:63], v[184:187], v[20:23], 0
    s_nop 7
    s_nop 7
    v_max3_f32 v30, v48, v49, v30
    v_max3_f32 v30, v50, v51, v30
    v_max3_f32 v30, v52, v53, v30
    v_max3_f32 v30, v54, v55, v30
    v_max3_f32 v30, v56, v57, v30
    v_max3_f32 v30, v58, v59, v30
    v_max3_f32 v30, v60, v61, v30
    v_max3_f32 v30, v62, v63, v30
    s_nop 1
    v_mfma_f32_32x32x16_bf16 v[48:63], v[184:187], v[24:27], 0
    s_nop 7
    s_nop 7
    v_max3_f32 v31, v48, v49, v31
    v_max3_f32 v31, v50, v51, v31
    v_max3_f32 v31, v52, v53, v31
    v_max3_f32 v31, v54, v55, v31
    v_max3_f32 v31, v56, v57, v31
    v_max3_f32 v31, v58, v59, v31
    v_max3_f32 v31, v60, v61, v31
    v_max3_f32 v31, v62, v63, v31
    s_nop 1
    v_mfma_f32_32x32x16_bf16 v[48:63], v[196:199], v[20:23], 0
    s_nop 7
    s_nop 7
    v_max3_f32 v30, v48, v49, v30
    v_max3_f32 v30, v50, v51, v30
    v_max3_f32 v30, v52, v53, v30
    v_max3_f32 v30, v54, v55, v30
    v_max3_f32 v30, v56, v57, v30
    v_max3_f32 v30, v58, v59, v30
    v_max3_f32 v30, v60, v61, v30
    v_max3_f32 v30, v62, v63, v30
    s_nop 1
    v_mfma_f32_32x32x16_bf16 v[48:63], v[196:199], v[24:27], 0
    s_nop 7
    s_nop 7
    v_max3_f32 v31, v48, v49, v31
    v_max3_f32 v31, v50, v51, v31
    v_max3_f32 v31, v52, v53, v31
    v_max3_f32 v31, v54, v55, v31
    v_max3_f32 v31, v56, v57, v31
    v_max3_f32 v31, v58, v59, v31
    v_max3_f32 v31, v60, v61, v31
    v_max3_f32 v31, v62, v63, v31
    s_cmp_eq_u32 s26, 3
    s_cbranch_scc1 L_slow_end0
    s_nop 1
    v_mfma_f32_32x32x16_bf16 v[48:63], v[208:211], v[20:23], 0
    s_nop 7
    s_nop 7
    v_max3_f32 v30, v48, v49, v30
    v_max3_f32 v30, v50, v51, v30
    v_max3_f32 v30, v52, v53, v30
    v_max3_f32 v30, v54, v55, v30
    v_max3_f32 v30, v56, v57, v30
    v_max3_f32 v30, v58, v59, v30
    v_max3_f32 v30, v60, v61, v30
    v_max3_f32 v30, v62, v63, v30
    s_nop 1
    v_mfma_f32_32x32x16_bf16 v[48:63], v[208:211], v[24:27], v[32:47]
    s_nop 7
    s_nop 7
    v_max3_f32 v31, v48, v49, v31
    v_max3_f32 v31, v50, v51, v31
    v_max3_f32 v31, v52, v53, v31
    v_max3_f32 v31, v54, v55, v31
    v_max3_f32 v31, v56, v57, v31
    v_max3_f32 v31, v58, v59, v31
    v_max3_f32 v31, v60, v61, v31
    v_max3_f32 v31, v62, v63, v31
    s_nop 1
    v_mfma_f32_32x32x16_bf16 v[48:63], v[220:223], v[20:23], v[32:47]
    s_nop 7
    s_nop 7
    v_max3_f32 v30, v48, v49, v30
    v_max3_f32 v30, v50, v51, v30
    v_max3_f32 v30, v52, v53, v30
    v_max3_f32 v30, v54, v55, v30
    v_max3_f32 v30, v56, v57, v30
    v_max3_f32 v30, v58, v59, v30
    v_max3_f32 v30, v60, v61, v30
    v_max3_f32 v30, v62, v63, v30
L_slow_end0:
    v_mov_b32 v4, v30
    s_nop 1
    v_permlane32_swap_b32 v4, v30
    s_nop 1
    v_max_f32 v30, v4, v30
    v_mov_b32 v4, v31
    s_nop 1
    v_permlane32_swap_b32 v4, v31
    s_nop 1
    v_max_f32 v31, v4, v31
    ds_read_b128 v[32:35], v15 offset:2064
    ds_read_b128 v[36:39], v15 offset:2096
    ds_read_b128 v[40:43], v15 offset:2128
    ds_read_b128 v[44:47], v15 offset:2160
    s_waitcnt lgkmcnt(0)
    s_nop 1
    v_mfma_f32_32x32x16_bf16 v[48:63], v[236:239], v[24:27], v[32:47]
    s_nop 7
    s_nop 7
    v_sub_f32 v48, v48, v31
    v_sub_f32 v49, v49, v31
    v_sub_f32 v50, v50, v31
    v_sub_f32 v51, v51, v31
    v_sub_f32 v52, v52, v31
    v_sub_f32 v53, v53, v31
    v_sub_f32 v54, v54, v31
    v_sub_f32 v55, v55, v31
    v_sub_f32 v56, v56, v31
    v_sub_f32 v57, v57, v31
    v_sub_f32 v58, v58, v31
    v_sub_f32 v59, v59, v31
    v_sub_f32 v60, v60, v31
    v_sub_f32 v61, v61, v31
    v_sub_f32 v62, v62, v31
    v_sub_f32 v63, v63, v31
    v_exp_f32 v48, v48
    v_exp_f32 v49, v49
    v_exp_f32 v50, v50
    v_exp_f32 v51, v51
    v_exp_f32 v52, v52
    v_exp_f32 v53, v53
    v_exp_f32 v54, v54
    v_exp_f32 v55, v55
    v_exp_f32 v56, v56
    v_exp_f32 v57, v57
    v_exp_f32 v58, v58
    v_exp_f32 v59, v59
    v_exp_f32 v60, v60
    v_exp_f32 v61, v61
    v_exp_f32 v62, v62
    v_exp_f32 v63, v63
    s_nop 0
    v_cvt_pk_bf16_f32 v80, v48, v49
    v_cvt_pk_bf16_f32 v81, v50, v51
    v_cvt_pk_bf16_f32 v82, v52, v53
    v_cvt_pk_bf16_f32 v83, v54, v55
    v_cvt_pk_bf16_f32 v84, v56, v57
    v_cvt_pk_bf16_f32 v85, v58, v59
    v_cvt_pk_bf16_f32 v86, v60, v61
    v_cvt_pk_bf16_f32 v87, v62, v63
    s_nop 1
    v_mfma_f32_32x32x16_bf16 v[112:127], v[248:251], v[80:83], 0
    v_mfma_f32_32x32x16_bf16 v[112:127], v[252:255], v[84:87], v[112:127]
    s_nop 7
    s_nop 1
    v_mfma_f32_32x32x16_bf16 v[48:63], v[232:235], v[20:23], v[32:47]
    s_nop 7
    s_nop 7
    v_sub_f32 v48, v48, v30
    v_sub_f32 v49, v49, v30
    v_sub_f32 v50, v50, v30
    v_sub_f32 v51, v51, v30
    v_sub_f32 v52, v52, v30
    v_sub_f32 v53, v53, v30
    v_sub_f32 v54, v54, v30
    v_sub_f32 v55, v55, v30
    v_sub_f32 v56, v56, v30
    v_sub_f32 v57, v57, v30
    v_sub_f32 v58, v58, v30
    v_sub_f32 v59, v59, v30
    v_sub_f32 v60, v60, v30
    v_sub_f32 v61, v61, v30
    v_sub_f32 v62, v62, v30
    v_sub_f32 v63, v63, v30
    v_exp_f32 v48, v48
    v_exp_f32 v49, v49
    v_exp_f32 v50, v50
    v_exp_f32 v51, v51
    v_exp_f32 v52, v52
    v_exp_f32 v53, v53
    v_exp_f32 v54, v54
    v_exp_f32 v55, v55
    v_exp_f32 v56, v56
    v_exp_f32 v57, v57
    v_exp_f32 v58, v58
    v_exp_f32 v59, v59
    v_exp_f32 v60, v60
    v_exp_f32 v61, v61
    v_exp_f32 v62, v62
    v_exp_f32 v63, v63
    s_nop 0
    v_cvt_pk_bf16_f32 v80, v48, v49
    v_cvt_pk_bf16_f32 v81, v50, v51
    v_cvt_pk_bf16_f32 v82, v52, v53
    v_cvt_pk_bf16_f32 v83, v54, v55
    v_cvt_pk_bf16_f32 v84, v56, v57
    v_cvt_pk_bf16_f32 v85, v58, v59
    v_cvt_pk_bf16_f32 v86, v60, v61
    v_cvt_pk_bf16_f32 v87, v62, v63
    s_nop 1
    v_mfma_f32_32x32x16_bf16 v[96:111], v[240:243], v[80:83], 0
    v_mfma_f32_32x32x16_bf16 v[96:111], v[244:247], v[84:87], v[96:111]
    s_nop 7
    s_nop 1
    v_mfma_f32_32x32x16_bf16 v[48:63], v[232:235], v[24:27], 0
    s_nop 7
    s_nop 7
    v_sub_f32 v48, v48, v31
    v_sub_f32 v49, v49, v31
    v_sub_f32 v50, v50, v31
    v_sub_f32 v51, v51, v31
    v_sub_f32 v52, v52, v31
    v_sub_f32 v53, v53, v31
    v_sub_f32 v54, v54, v31
    v_sub_f32 v55, v55, v31
    v_sub_f32 v56, v56, v31
    v_sub_f32 v57, v57, v31
    v_sub_f32 v58, v58, v31
    v_sub_f32 v59, v59, v31
    v_sub_f32 v60, v60, v31
    v_sub_f32 v61, v61, v31
    v_sub_f32 v62, v62, v31
    v_sub_f32 v63, v63, v31
    v_exp_f32 v48, v48
    v_exp_f32 v49, v49
    v_exp_f32 v50, v50
    v_exp_f32 v51, v51
    v_exp_f32 v52, v52
    v_exp_f32 v53, v53
    v_exp_f32 v54, v54
    v_exp_f32 v55, v55
    v_exp_f32 v56, v56
    v_exp_f32 v57, v57
    v_exp_f32 v58, v58
    v_exp_f32 v59, v59
    v_exp_f32 v60, v60
    v_exp_f32 v61, v61
    v_exp_f32 v62, v62
    v_exp_f32 v63, v63
    s_nop 0
    v_cvt_pk_bf16_f32 v80, v48, v49
    v_cvt_pk_bf16_f32 v81, v50, v51
    v_cvt_pk_bf16_f32 v82, v52, v53
    v_cvt_pk_bf16_f32 v83, v54, v55
    v_cvt_pk_bf16_f32 v84, v56, v57
    v_cvt_pk_bf16_f32 v85, v58, v59
    v_cvt_pk_bf16_f32 v86, v60, v61
    v_cvt_pk_bf16_f32 v87, v62, v63
    s_nop 1
    v_mfma_f32_32x32x16_bf16 v[112:127], v[240:243], v[80:83], v[112:127]
    v_mfma_f32_32x32x16_bf16 v[112:127], v[244:247], v[84:87], v[112:127]
    s_nop 7
    s_cmp_eq_u32 s26, 0
    s_cbranch_scc1 L_slow_end1
    v_sub_f32 v32, s52, v32
    v_sub_f32 v33, s52, v33
    v_sub_f32 v34, s52, v34
    v_sub_f32 v35, s52, v35
    v_sub_f32 v36, s52, v36
    v_sub_f32 v37, s52, v37
    v_sub_f32 v38, s52, v38
    v_sub_f32 v39, s52, v39
    v_sub_f32 v40, s52, v40
    v_sub_f32 v41, s52, v41
    v_sub_f32 v42, s52, v42
    v_sub_f32 v43, s52, v43
    v_sub_f32 v44, s52, v44
    v_sub_f32 v45, s52, v45
    v_sub_f32 v46, s52, v46
    v_sub_f32 v47, s52, v47
    s_nop 1
    v_mfma_f32_32x32x16_bf16 v[48:63], v[136:139], v[20:23], 0
    s_nop 7
    s_nop 7
    v_sub_f32 v48, v48, v30
    v_sub_f32 v49, v49, v30
    v_sub_f32 v50, v50, v30
    v_sub_f32 v51, v51, v30
    v_sub_f32 v52, v52, v30
    v_sub_f32 v53, v53, v30
    v_sub_f32 v54, v54, v30
    v_sub_f32 v55, v55, v30
    v_sub_f32 v56, v56, v30
    v_sub_f32 v57, v57, v30
    v_sub_f32 v58, v58, v30
    v_sub_f32 v59, v59, v30
    v_sub_f32 v60, v60, v30
    v_sub_f32 v61, v61, v30
    v_sub_f32 v62, v62, v30
    v_sub_f32 v63, v63, v30
    v_exp_f32 v48, v48
    v_exp_f32 v49, v49
    v_exp_f32 v50, v50
    v_exp_f32 v51, v51
    v_exp_f32 v52, v52
    v_exp_f32 v53, v53
    v_exp_f32 v54, v54
    v_exp_f32 v55, v55
    v_exp_f32 v56, v56
    v_exp_f32 v57, v57
    v_exp_f32 v58, v58
    v_exp_f32 v59, v59
    v_exp_f32 v60, v60
    v_exp_f32 v61, v61
    v_exp_f32 v62, v62
    v_exp_f32 v63, v63
    s_nop 0
    v_cvt_pk_bf16_f32 v80, v48, v49
    v_cvt_pk_bf16_f32 v81, v50, v51
    v_cvt_pk_bf16_f32 v82, v52, v53
    v_cvt_pk_bf16_f32 v83, v54, v55
    v_cvt_pk_bf16_f32 v84, v56, v57
    v_cvt_pk_bf16_f32 v85, v58, v59
    v_cvt_pk_bf16_f32 v86, v60, v61
    v_cvt_pk_bf16_f32 v87, v62, v63
    s_nop 1
    v_mfma_f32_32x32x16_bf16 v[96:111], v[140:143], v[80:83], v[96:111]
    v_mfma_f32_32x32x16_bf16 v[96:111], v[144:147], v[84:87], v[96:111]
    s_nop 7
    s_nop 1
    v_mfma_f32_32x32x16_bf16 v[48:63], v[136:139], v[24:27], 0
    s_nop 7
    s_nop 7
    v_sub_f32 v48, v48, v31
    v_sub_f32 v49, v49, v31
    v_sub_f32 v50, v50, v31
    v_sub_f32 v51, v51, v31
    v_sub_f32 v52, v52, v31
    v_sub_f32 v53, v53, v31
    v_sub_f32 v54, v54, v31
    v_sub_f32 v55, v55, v31
    v_sub_f32 v56, v56, v31
    v_sub_f32 v57, v57, v31
    v_sub_f32 v58, v58, v31
    v_sub_f32 v59, v59, v31
    v_sub_f32 v60, v60, v31
    v_sub_f32 v61, v61, v31
    v_sub_f32 v62, v62, v31
    v_sub_f32 v63, v63, v31
    v_exp_f32 v48, v48
    v_exp_f32 v49, v49
    v_exp_f32 v50, v50
    v_exp_f32 v51, v51
    v_exp_f32 v52, v52
    v_exp_f32 v53, v53
    v_exp_f32 v54, v54
    v_exp_f32 v55, v55
    v_exp_f32 v56, v56
    v_exp_f32 v57, v57
    v_exp_f32 v58, v58
    v_exp_f32 v59, v59
    v_exp_f32 v60, v60
    v_exp_f32 v61, v61
    v_exp_f32 v62, v62
    v_exp_f32 v63, v63
    s_nop 0
    v_cvt_pk_bf16_f32 v80, v48, v49
    v_cvt_pk_bf16_f32 v81, v50, v51
    v_cvt_pk_bf16_f32 v82, v52, v53
    v_cvt_pk_bf16_f32 v83, v54, v55
    v_cvt_pk_bf16_f32 v84, v56, v57
    v_cvt_pk_bf16_f32 v85, v58, v59
    v_cvt_pk_bf16_f32 v86, v60, v61
    v_cvt_pk_bf16_f32 v87, v62, v63
    s_nop 1
    v_mfma_f32_32x32x16_bf16 v[112:127], v[140:143], v[80:83], v[112:127]
    v_mfma_f32_32x32x16_bf16 v[112:127], v[144:147], v[84:87], v[112:127]
    s_nop 7
    s_nop 1
    v_mfma_f32_32x32x16_bf16 v[48:63], v[148:151], v[20:23], 0
    s_nop 7
    s_nop 7
    v_sub_f32 v48, v48, v30
    v_sub_f32 v49, v49, v30
    v_sub_f32 v50, v50, v30
    v_sub_f32 v51, v51, v30
    v_sub_f32 v52, v52, v30
    v_sub_f32 v53, v53, v30
    v_sub_f32 v54, v54, v30
    v_sub_f32 v55, v55, v30
    v_sub_f32 v56, v56, v30
    v_sub_f32 v57, v57, v30
    v_sub_f32 v58, v58, v30
    v_sub_f32 v59, v59, v30
    v_sub_f32 v60, v60, v30
    v_sub_f32 v61, v61, v30
    v_sub_f32 v62, v62, v30
    v_sub_f32 v63, v63, v30
    v_exp_f32 v48, v48
    v_exp_f32 v49, v49
    v_exp_f32 v50, v50
    v_exp_f32 v51, v51
    v_exp_f32 v52, v52
    v_exp_f32 v53, v53
    v_exp_f32 v54, v54
    v_exp_f32 v55, v55
    v_exp_f32 v56, v56
    v_exp_f32 v57, v57
    v_exp_f32 v58, v58
    v_exp_f32 v59, v59
    v_exp_f32 v60, v60
    v_exp_f32 v61, v61
    v_exp_f32 v62, v62
    v_exp_f32 v63, v63
    s_nop 0
    v_cvt_pk_bf16_f32 v80, v48, v49
    v_cvt_pk_bf16_f32 v81, v50, v51
    v_cvt_pk_bf16_f32 v82, v52, v53
    v_cvt_pk_bf16_f32 v83, v54, v55
    v_cvt_pk_bf16_f32 v84, v56, v57
    v_cvt_pk_bf16_f32 v85, v58, v59
    v_cvt_pk_bf16_f32 v86, v60, v61
    v_cvt_pk_bf16_f32 v87, v62, v63
    s_nop 1
    v_mfma_f32_32x32x16_bf16 v[96:111], v[152:155], v[80:83], v[96:111]
    v_mfma_f32_32x32x16_bf16 v[96:111], v[156:159], v[84:87], v[96:111]
    s_nop 7
    s_nop 1
    v_mfma_f32_32x32x16_bf16 v[48:63], v[148:151], v[24:27], 0
    s_nop 7
    s_nop 7
    v_sub_f32 v48, v48, v31
    v_sub_f32 v49, v49, v31
    v_sub_f32 v50, v50, v31
    v_sub_f32 v51, v51, v31
    v_sub_f32 v52, v52, v31
    v_sub_f32 v53, v53, v31
    v_sub_f32 v54, v54, v31
    v_sub_f32 v55, v55, v31
    v_sub_f32 v56, v56, v31
    v_sub_f32 v57, v57, v31
    v_sub_f32 v58, v58, v31
    v_sub_f32 v59, v59, v31
    v_sub_f32 v60, v60, v31
    v_sub_f32 v61, v61, v31
    v_sub_f32 v62, v62, v31
    v_sub_f32 v63, v63, v31
    v_exp_f32 v48, v48
    v_exp_f32 v49, v49
    v_exp_f32 v50, v50
    v_exp_f32 v51, v51
    v_exp_f32 v52, v52
    v_exp_f32 v53, v53
    v_exp_f32 v54, v54
    v_exp_f32 v55, v55
    v_exp_f32 v56, v56
    v_exp_f32 v57, v57
    v_exp_f32 v58, v58
    v_exp_f32 v59, v59
    v_exp_f32 v60, v60
    v_exp_f32 v61, v61
    v_exp_f32 v62, v62
    v_exp_f32 v63, v63
    s_nop 0
    v_cvt_pk_bf16_f32 v80, v48, v49
    v_cvt_pk_bf16_f32 v81, v50, v51
    v_cvt_pk_bf16_f32 v82, v52, v53
    v_cvt_pk_bf16_f32 v83, v54, v55
    v_cvt_pk_bf16_f32 v84, v56, v57
    v_cvt_pk_bf16_f32 v85, v58, v59
    v_cvt_pk_bf16_f32 v86, v60, v61
    v_cvt_pk_bf16_f32 v87, v62, v63
    s_nop 1
    v_mfma_f32_32x32x16_bf16 v[112:127], v[152:155], v[80:83], v[112:127]
    v_mfma_f32_32x32x16_bf16 v[112:127], v[156:159], v[84:87], v[112:127]
    s_nop 7
    s_cmp_eq_u32 s26, 1
    s_cbranch_scc1 L_slow_end1
    s_nop 1
    v_mfma_f32_32x32x16_bf16 v[48:63], v[160:163], v[20:23], 0
    s_nop 7
    s_nop 7
    v_sub_f32 v48, v48, v30
    v_sub_f32 v49, v49, v30
    v_sub_f32 v50, v50, v30
    v_sub_f32 v51, v51, v30
    v_sub_f32 v52, v52, v30
    v_sub_f32 v53, v53, v30
    v_sub_f32 v54, v54, v30
    v_sub_f32 v55, v55, v30
    v_sub_f32 v56, v56, v30
    v_sub_f32 v57, v57, v30
    v_sub_f32 v58, v58, v30
    v_sub_f32 v59, v59, v30
    v_sub_f32 v60, v60, v30
    v_sub_f32 v61, v61, v30
    v_sub_f32 v62, v62, v30
    v_sub_f32 v63, v63, v30
    v_exp_f32 v48, v48
    v_exp_f32 v49, v49
    v_exp_f32 v50, v50
    v_exp_f32 v51, v51
    v_exp_f32 v52, v52
    v_exp_f32 v53, v53
    v_exp_f32 v54, v54
    v_exp_f32 v55, v55
    v_exp_f32 v56, v56
    v_exp_f32 v57, v57
    v_exp_f32 v58, v58
    v_exp_f32 v59, v59
    v_exp_f32 v60, v60
    v_exp_f32 v61, v61
    v_exp_f32 v62, v62
    v_exp_f32 v63, v63
    s_nop 0
    v_cvt_pk_bf16_f32 v80, v48, v49
    v_cvt_pk_bf16_f32 v81, v50, v51
    v_cvt_pk_bf16_f32 v82, v52, v53
    v_cvt_pk_bf16_f32 v83, v54, v55
    v_cvt_pk_bf16_f32 v84, v56, v57
    v_cvt_pk_bf16_f32 v85, v58, v59
    v_cvt_pk_bf16_f32 v86, v60, v61
    v_cvt_pk_bf16_f32 v87, v62, v63
    s_nop 1
    v_mfma_f32_32x32x16_bf16 v[96:111], v[164:167], v[80:83], v[96:111]
    v_mfma_f32_32x32x16_bf16 v[96:111], v[168:171], v[84:87], v[96:111]
    s_nop 7
    s_nop 1
    v_mfma_f32_32x32x16_bf16 v[48:63], v[160:163], v[24:27], 0
    s_nop 7
    s_nop 7
    v_sub_f32 v48, v48, v31
    v_sub_f32 v49, v49, v31
    v_sub_f32 v50, v50, v31
    v_sub_f32 v51, v51, v31
    v_sub_f32 v52, v52, v31
    v_sub_f32 v53, v53, v31
    v_sub_f32 v54, v54, v31
    v_sub_f32 v55, v55, v31
    v_sub_f32 v56, v56, v31
    v_sub_f32 v57, v57, v31
    v_sub_f32 v58, v58, v31
    v_sub_f32 v59, v59, v31
    v_sub_f32 v60, v60, v31
    v_sub_f32 v61, v61, v31
    v_sub_f32 v62, v62, v31
    v_sub_f32 v63, v63, v31
    v_exp_f32 v48, v48
    v_exp_f32 v49, v49
    v_exp_f32 v50, v50
    v_exp_f32 v51, v51
    v_exp_f32 v52, v52
    v_exp_f32 v53, v53
    v_exp_f32 v54, v54
    v_exp_f32 v55, v55
    v_exp_f32 v56, v56
    v_exp_f32 v57, v57
    v_exp_f32 v58, v58
    v_exp_f32 v59, v59
    v_exp_f32 v60, v60
    v_exp_f32 v61, v61
    v_exp_f32 v62, v62
    v_exp_f32 v63, v63
    s_nop 0
    v_cvt_pk_bf16_f32 v80, v48, v49
    v_cvt_pk_bf16_f32 v81, v50, v51
    v_cvt_pk_bf16_f32 v82, v52, v53
    v_cvt_pk_bf16_f32 v83, v54, v55
    v_cvt_pk_bf16_f32 v84, v56, v57
    v_cvt_pk_bf16_f32 v85, v58, v59
    v_cvt_pk_bf16_f32 v86, v60, v61
    v_cvt_pk_bf16_f32 v87, v62, v63
    s_nop 1
    v_mfma_f32_32x32x16_bf16 v[112:127], v[164:167], v[80:83], v[112:127]
    v_mfma_f32_32x32x16_bf16 v[112:127], v[168:171], v[84:87], v[112:127]
    s_nop 7
    s_nop 1
    v_mfma_f32_32x32x16_bf16 v[48:63], v[172:175], v[20:23], 0
    s_nop 7
    s_nop 7
    v_sub_f32 v48, v48, v30
    v_sub_f32 v49, v49, v30
    v_sub_f32 v50, v50, v30
    v_sub_f32 v51, v51, v30
    v_sub_f32 v52, v52, v30
    v_sub_f32 v53, v53, v30
    v_sub_f32 v54, v54, v30
    v_sub_f32 v55, v55, v30
    v_sub_f32 v56, v56, v30
    v_sub_f32 v57, v57, v30
    v_sub_f32 v58, v58, v30
    v_sub_f32 v59, v59, v30
    v_sub_f32 v60, v60, v30
    v_sub_f32 v61, v61, v30
    v_sub_f32 v62, v62, v30
    v_sub_f32 v63, v63, v30
    v_exp_f32 v48, v48
    v_exp_f32 v49, v49
    v_exp_f32 v50, v50
    v_exp_f32 v51, v51
    v_exp_f32 v52, v52
    v_exp_f32 v53, v53
    v_exp_f32 v54, v54
    v_exp_f32 v55, v55
    v_exp_f32 v56, v56
    v_exp_f32 v57, v57
    v_exp_f32 v58, v58
    v_exp_f32 v59, v59
    v_exp_f32 v60, v60
    v_exp_f32 v61, v61
    v_exp_f32 v62, v62
    v_exp_f32 v63, v63
    s_nop 0
    v_cvt_pk_bf16_f32 v80, v48, v49
    v_cvt_pk_bf16_f32 v81, v50, v51
    v_cvt_pk_bf16_f32 v82, v52, v53
    v_cvt_pk_bf16_f32 v83, v54, v55
    v_cvt_pk_bf16_f32 v84, v56, v57
    v_cvt_pk_bf16_f32 v85, v58, v59
    v_cvt_pk_bf16_f32 v86, v60, v61
    v_cvt_pk_bf16_f32 v87, v62, v63
    s_nop 1
    v_mfma_f32_32x32x16_bf16 v[96:111], v[176:179], v[80:83], v[96:111]
    v_mfma_f32_32x32x16_bf16 v[96:111], v[180:183], v[84:87], v[96:111]
    s_nop 7
    s_nop 1
    v_mfma_f32_32x32x16_bf16 v[48:63], v[172:175], v[24:27], 0
    s_nop 7
    s_nop 7
    v_sub_f32 v48, v48, v31
    v_sub_f32 v49, v49, v31
    v_sub_f32 v50, v50, v31
    v_sub_f32 v51, v51, v31
    v_sub_f32 v52, v52, v31
    v_sub_f32 v53, v53, v31
    v_sub_f32 v54, v54, v31
    v_sub_f32 v55, v55, v31
    v_sub_f32 v56, v56, v31
    v_sub_f32 v57, v57, v31
    v_sub_f32 v58, v58, v31
    v_sub_f32 v59, v59, v31
    v_sub_f32 v60, v60, v31
    v_sub_f32 v61, v61, v31
    v_sub_f32 v62, v62, v31
    v_sub_f32 v63, v63, v31
    v_exp_f32 v48, v48
    v_exp_f32 v49, v49
    v_exp_f32 v50, v50
    v_exp_f32 v51, v51
    v_exp_f32 v52, v52
    v_exp_f32 v53, v53
    v_exp_f32 v54, v54
    v_exp_f32 v55, v55
    v_exp_f32 v56, v56
    v_exp_f32 v57, v57
    v_exp_f32 v58, v58
    v_exp_f32 v59, v59
    v_exp_f32 v60, v60
    v_exp_f32 v61, v61
    v_exp_f32 v62, v62
    v_exp_f32 v63, v63
    s_nop 0
    v_cvt_pk_bf16_f32 v80, v48, v49
    v_cvt_pk_bf16_f32 v81, v50, v51
    v_cvt_pk_bf16_f32 v82, v52, v53
    v_cvt_pk_bf16_f32 v83, v54, v55
    v_cvt_pk_bf16_f32 v84, v56, v57
    v_cvt_pk_bf16_f32 v85, v58, v59
    v_cvt_pk_bf16_f32 v86, v60, v61
    v_cvt_pk_bf16_f32 v87, v62, v63
    s_nop 1
    v_mfma_f32_32x32x16_bf16 v[112:127], v[176:179], v[80:83], v[112:127]
    v_mfma_f32_32x32x16_bf16 v[112:127], v[180:183], v[84:87], v[112:127]
    s_nop 7
    s_cmp_eq_u32 s26, 2
    s_cbranch_scc1 L_slow_end1
    s_nop 1
    v_mfma_f32_32x32x16_bf16 v[48:63], v[184:187], v[20:23], 0
    s_nop 7
    s_nop 7
    v_sub_f32 v48, v48, v30
    v_sub_f32 v49, v49, v30
    v_sub_f32 v50, v50, v30
    v_sub_f32 v51, v51, v30
    v_sub_f32 v52, v52, v30
    v_sub_f32 v53, v53, v30
    v_sub_f32 v54, v54, v30
    v_sub_f32 v55, v55, v30
    v_sub_f32 v56, v56, v30
    v_sub_f32 v57, v57, v30
    v_sub_f32 v58, v58, v30
    v_sub_f32 v59, v59, v30
    v_sub_f32 v60, v60, v30
    v_sub_f32 v61, v61, v30
    v_sub_f32 v62, v62, v30
    v_sub_f32 v63, v63, v30
    v_exp_f32 v48, v48
    v_exp_f32 v49, v49
    v_exp_f32 v50, v50
    v_exp_f32 v51, v51
    v_exp_f32 v52, v52
    v_exp_f32 v53, v53
    v_exp_f32 v54, v54
    v_exp_f32 v55, v55
    v_exp_f32 v56, v56
    v_exp_f32 v57, v57
    v_exp_f32 v58, v58
    v_exp_f32 v59, v59
    v_exp_f32 v60, v60
    v_exp_f32 v61, v61
    v_exp_f32 v62, v62
    v_exp_f32 v63, v63
    s_nop 0
    v_cvt_pk_bf16_f32 v80, v48, v49
    v_cvt_pk_bf16_f32 v81, v50, v51
    v_cvt_pk_bf16_f32 v82, v52, v53
    v_cvt_pk_bf16_f32 v83, v54, v55
    v_cvt_pk_bf16_f32 v84, v56, v57
    v_cvt_pk_bf16_f32 v85, v58, v59
    v_cvt_pk_bf16_f32 v86, v60, v61
    v_cvt_pk_bf16_f32 v87, v62, v63
    s_nop 1
    v_mfma_f32_32x32x16_bf16 v[96:111], v[188:191], v[80:83], v[96:111]
    v_mfma_f32_32x32x16_bf16 v[96:111], v[192:195], v[84:87], v[96:111]
    s_nop 7
    s_nop 1
    v_mfma_f32_32x32x16_bf16 v[48:63], v[184:187], v[24:27], 0
    s_nop 7
    s_nop 7
    v_sub_f32 v48, v48, v31
    v_sub_f32 v49, v49, v31
    v_sub_f32 v50, v50, v31
    v_sub_f32 v51, v51, v31
    v_sub_f32 v52, v52, v31
    v_sub_f32 v53, v53, v31
    v_sub_f32 v54, v54, v31
    v_sub_f32 v55, v55, v31
    v_sub_f32 v56, v56, v31
    v_sub_f32 v57, v57, v31
    v_sub_f32 v58, v58, v31
    v_sub_f32 v59, v59, v31
    v_sub_f32 v60, v60, v31
    v_sub_f32 v61, v61, v31
    v_sub_f32 v62, v62, v31
    v_sub_f32 v63, v63, v31
    v_exp_f32 v48, v48
    v_exp_f32 v49, v49
    v_exp_f32 v50, v50
    v_exp_f32 v51, v51
    v_exp_f32 v52, v52
    v_exp_f32 v53, v53
    v_exp_f32 v54, v54
    v_exp_f32 v55, v55
    v_exp_f32 v56, v56
    v_exp_f32 v57, v57
    v_exp_f32 v58, v58
    v_exp_f32 v59, v59
    v_exp_f32 v60, v60
    v_exp_f32 v61, v61
    v_exp_f32 v62, v62
    v_exp_f32 v63, v63
    s_nop 0
    v_cvt_pk_bf16_f32 v80, v48, v49
    v_cvt_pk_bf16_f32 v81, v50, v51
    v_cvt_pk_bf16_f32 v82, v52, v53
    v_cvt_pk_bf16_f32 v83, v54, v55
    v_cvt_pk_bf16_f32 v84, v56, v57
    v_cvt_pk_bf16_f32 v85, v58, v59
    v_cvt_pk_bf16_f32 v86, v60, v61
    v_cvt_pk_bf16_f32 v87, v62, v63
    s_nop 1
    v_mfma_f32_32x32x16_bf16 v[112:127], v[188:191], v[80:83], v[112:127]
    v_mfma_f32_32x32x16_bf16 v[112:127], v[192:195], v[84:87], v[112:127]
    s_nop 7
    s_nop 1
    v_mfma_f32_32x32x16_bf16 v[48:63], v[196:199], v[20:23], 0
    s_nop 7
    s_nop 7
    v_sub_f32 v48, v48, v30
    v_sub_f32 v49, v49, v30
    v_sub_f32 v50, v50, v30
    v_sub_f32 v51, v51, v30
    v_sub_f32 v52, v52, v30
    v_sub_f32 v53, v53, v30
    v_sub_f32 v54, v54, v30
    v_sub_f32 v55, v55, v30
    v_sub_f32 v56, v56, v30
    v_sub_f32 v57, v57, v30
    v_sub_f32 v58, v58, v30
    v_sub_f32 v59, v59, v30
    v_sub_f32 v60, v60, v30
    v_sub_f32 v61, v61, v30
    v_sub_f32 v62, v62, v30
    v_sub_f32 v63, v63, v30
    v_exp_f32 v48, v48
    v_exp_f32 v49, v49
    v_exp_f32 v50, v50
    v_exp_f32 v51, v51
    v_exp_f32 v52, v52
    v_exp_f32 v53, v53
    v_exp_f32 v54, v54
    v_exp_f32 v55, v55
    v_exp_f32 v56, v56
    v_exp_f32 v57, v57
    v_exp_f32 v58, v58
    v_exp_f32 v59, v59
    v_exp_f32 v60, v60
    v_exp_f32 v61, v61
    v_exp_f32 v62, v62
    v_exp_f32 v63, v63
    s_nop 0
    v_cvt_pk_bf16_f32 v80, v48, v49
    v_cvt_pk_bf16_f32 v81, v50, v51
    v_cvt_pk_bf16_f32 v82, v52, v53
    v_cvt_pk_bf16_f32 v83, v54, v55
    v_cvt_pk_bf16_f32 v84, v56, v57
    v_cvt_pk_bf16_f32 v85, v58, v59
    v_cvt_pk_bf16_f32 v86, v60, v61
    v_cvt_pk_bf16_f32 v87, v62, v63
    s_nop 1
    v_mfma_f32_32x32x16_bf16 v[96:111], v[200:203], v[80:83], v[96:111]
    v_mfma_f32_32x32x16_bf16 v[96:111], v[204:207], v[84:87], v[96:111]
    s_nop 7
    s_nop 1
    v_mfma_f32_32x32x16_bf16 v[48:63], v[196:199], v[24:27], 0
    s_nop 7
    s_nop 7
    v_sub_f32 v48, v48, v31
    v_sub_f32 v49, v49, v31
    v_sub_f32 v50, v50, v31
    v_sub_f32 v51, v51, v31
    v_sub_f32 v52, v52, v31
    v_sub_f32 v53, v53, v31
    v_sub_f32 v54, v54, v31
    v_sub_f32 v55, v55, v31
    v_sub_f32 v56, v56, v31
    v_sub_f32 v57, v57, v31
    v_sub_f32 v58, v58, v31
    v_sub_f32 v59, v59, v31
    v_sub_f32 v60, v60, v31
    v_sub_f32 v61, v61, v31
    v_sub_f32 v62, v62, v31
    v_sub_f32 v63, v63, v31
    v_exp_f32 v48, v48
    v_exp_f32 v49, v49
    v_exp_f32 v50, v50
    v_exp_f32 v51, v51
    v_exp_f32 v52, v52
    v_exp_f32 v53, v53
    v_exp_f32 v54, v54
    v_exp_f32 v55, v55
    v_exp_f32 v56, v56
    v_exp_f32 v57, v57
    v_exp_f32 v58, v58
    v_exp_f32 v59, v59
    v_exp_f32 v60, v60
    v_exp_f32 v61, v61
    v_exp_f32 v62, v62
    v_exp_f32 v63, v63
    s_nop 0
    v_cvt_pk_bf16_f32 v80, v48, v49
    v_cvt_pk_bf16_f32 v81, v50, v51
    v_cvt_pk_bf16_f32 v82, v52, v53
    v_cvt_pk_bf16_f32 v83, v54, v55
    v_cvt_pk_bf16_f32 v84, v56, v57
    v_cvt_pk_bf16_f32 v85, v58, v59
    v_cvt_pk_bf16_f32 v86, v60, v61
    v_cvt_pk_bf16_f32 v87, v62, v63
    s_nop 1
    v_mfma_f32_32x32x16_bf16 v[112:127], v[200:203], v[80:83], v[112:127]
    v_mfma_f32_32x32x16_bf16 v[112:127], v[204:207], v[84:87], v[112:127]
    s_nop 7
    s_cmp_eq_u32 s26, 3
    s_cbranch_scc1 L_slow_end1
    s_nop 1
    v_mfma_f32_32x32x16_bf16 v[48:63], v[208:211], v[20:23], 0
    s_nop 7
    s_nop 7
    v_sub_f32 v48, v48, v30
    v_sub_f32 v49, v49, v30
    v_sub_f32 v50, v50, v30
    v_sub_f32 v51, v51, v30
    v_sub_f32 v52, v52, v30
    v_sub_f32 v53, v53, v30
    v_sub_f32 v54, v54, v30
    v_sub_f32 v55, v55, v30
    v_sub_f32 v56, v56, v30
    v_sub_f32 v57, v57, v30
    v_sub_f32 v58, v58, v30
    v_sub_f32 v59, v59, v30
    v_sub_f32 v60, v60, v30
    v_sub_f32 v61, v61, v30
    v_sub_f32 v62, v62, v30
    v_sub_f32 v63, v63, v30
    v_exp_f32 v48, v48
    v_exp_f32 v49, v49
    v_exp_f32 v50, v50
    v_exp_f32 v51, v51
    v_exp_f32 v52, v52
    v_exp_f32 v53, v53
    v_exp_f32 v54, v54
    v_exp_f32 v55, v55
    v_exp_f32 v56, v56
    v_exp_f32 v57, v57
    v_exp_f32 v58, v58
    v_exp_f32 v59, v59
    v_exp_f32 v60, v60
    v_exp_f32 v61, v61
    v_exp_f32 v62, v62
    v_exp_f32 v63, v63
    s_nop 0
    v_cvt_pk_bf16_f32 v80, v48, v49
    v_cvt_pk_bf16_f32 v81, v50, v51
    v_cvt_pk_bf16_f32 v82, v52, v53
    v_cvt_pk_bf16_f32 v83, v54, v55
    v_cvt_pk_bf16_f32 v84, v56, v57
    v_cvt_pk_bf16_f32 v85, v58, v59
    v_cvt_pk_bf16_f32 v86, v60, v61
    v_cvt_pk_bf16_f32 v87, v62, v63
    s_nop 1
    v_mfma_f32_32x32x16_bf16 v[96:111], v[212:215], v[80:83], v[96:111]
    v_mfma_f32_32x32x16_bf16 v[96:111], v[216:219], v[84:87], v[96:111]
    s_nop 7
    s_nop 1
    v_mfma_f32_32x32x16_bf16 v[48:63], v[208:211], v[24:27], v[32:47]
    s_nop 7
    s_nop 7
    v_sub_f32 v48, v48, v31
    v_sub_f32 v49, v49, v31
    v_sub_f32 v50, v50, v31
    v_sub_f32 v51, v51, v31
    v_sub_f32 v52, v52, v31
    v_sub_f32 v53, v53, v31
    v_sub_f32 v54, v54, v31
    v_sub_f32 v55, v55, v31
    v_sub_f32 v56, v56, v31
    v_sub_f32 v57, v57, v31
    v_sub_f32 v58, v58, v31
    v_sub_f32 v59, v59, v31
    v_sub_f32 v60, v60, v31
    v_sub_f32 v61, v61, v31
    v_sub_f32 v62, v62, v31
    v_sub_f32 v63, v63, v31
    v_exp_f32 v48, v48
    v_exp_f32 v49, v49
    v_exp_f32 v50, v50
    v_exp_f32 v51, v51
    v_exp_f32 v52, v52
    v_exp_f32 v53, v53
    v_exp_f32 v54, v54
    v_exp_f32 v55, v55
    v_exp_f32 v56, v56
    v_exp_f32 v57, v57
    v_exp_f32 v58, v58
    v_exp_f32 v59, v59
    v_exp_f32 v60, v60
    v_exp_f32 v61, v61
    v_exp_f32 v62, v62
    v_exp_f32 v63, v63
    s_nop 0
    v_cvt_pk_bf16_f32 v80, v48, v49
    v_cvt_pk_bf16_f32 v81, v50, v51
    v_cvt_pk_bf16_f32 v82, v52, v53
    v_cvt_pk_bf16_f32 v83, v54, v55
    v_cvt_pk_bf16_f32 v84, v56, v57
    v_cvt_pk_bf16_f32 v85, v58, v59
    v_cvt_pk_bf16_f32 v86, v60, v61
    v_cvt_pk_bf16_f32 v87, v62, v63
    s_nop 1
    v_mfma_f32_32x32x16_bf16 v[112:127], v[212:215], v[80:83], v[112:127]
    v_mfma_f32_32x32x16_bf16 v[112:127], v[216:219], v[84:87], v[112:127]
    s_nop 7
    s_nop 1
    v_mfma_f32_32x32x16_bf16 v[48:63], v[220:223], v[20:23], v[32:47]
    s_nop 7
    s_nop 7
    v_sub_f32 v48, v48, v30
    v_sub_f32 v49, v49, v30
    v_sub_f32 v50, v50, v30
    v_sub_f32 v51, v51, v30
    v_sub_f32 v52, v52, v30
    v_sub_f32 v53, v53, v30
    v_sub_f32 v54, v54, v30
    v_sub_f32 v55, v55, v30
    v_sub_f32 v56, v56, v30
    v_sub_f32 v57, v57, v30
    v_sub_f32 v58, v58, v30
    v_sub_f32 v59, v59, v30
    v_sub_f32 v60, v60, v30
    v_sub_f32 v61, v61, v30
    v_sub_f32 v62, v62, v30
    v_sub_f32 v63, v63, v30
    v_exp_f32 v48, v48
    v_exp_f32 v49, v49
    v_exp_f32 v50, v50
    v_exp_f32 v51, v51
    v_exp_f32 v52, v52
    v_exp_f32 v53, v53
    v_exp_f32 v54, v54
    v_exp_f32 v55, v55
    v_exp_f32 v56, v56
    v_exp_f32 v57, v57
    v_exp_f32 v58, v58
    v_exp_f32 v59, v59
    v_exp_f32 v60, v60
    v_exp_f32 v61, v61
    v_exp_f32 v62, v62
    v_exp_f32 v63, v63
    s_nop 0
    v_cvt_pk_bf16_f32 v80, v48, v49
    v_cvt_pk_bf16_f32 v81, v50, v51
    v_cvt_pk_bf16_f32 v82, v52, v53
    v_cvt_pk_bf16_f32 v83, v54, v55
    v_cvt_pk_bf16_f32 v84, v56, v57
    v_cvt_pk_bf16_f32 v85, v58, v59
    v_cvt_pk_bf16_f32 v86, v60, v61
    v_cvt_pk_bf16_f32 v87, v62, v63
    s_nop 1
    v_mfma_f32_32x32x16_bf16 v[96:111], v[224:227], v[80:83], v[96:111]
    v_mfma_f32_32x32x16_bf16 v[96:111], v[228:231], v[84:87], v[96:111]
    s_nop 7
L_slow_end1:
    s_nop 7
    s_nop 7
    s_cmp_eq_u32 s60, 0
    s_cbranch_scc1 L_attn_fin
    v_rcp_f32 v4, v120
    s_add_u32 s72, s58, 32768
    s_add_u32 s73, s59, 2048
    s_mov_b64 exec, 0xff
    buffer_atomic_swap v14, v13, s[40:43], s98 offen offset:0 sc1
    s_mov_b64 exec, -1
    v_pk_mul_f32 v[112:113], v[4:5], v[112:113] op_sel_hi:[0,1]
    v_pk_mul_f32 v[114:115], v[4:5], v[114:115] op_sel_hi:[0,1]
    v_pk_mul_f32 v[116:117], v[4:5], v[116:117] op_sel_hi:[0,1]
    v_pk_mul_f32 v[118:119], v[4:5], v[118:119] op_sel_hi:[0,1]
    v_cvt_pk_bf16_f32 v112, v112, v113
    v_cvt_pk_bf16_f32 v113, v114, v115
    v_cvt_pk_bf16_f32 v114, v116, v117
    v_cvt_pk_bf16_f32 v115, v118, v119
    buffer_store_dwordx4 v[112:115], v10, s[40:43], s72 offen sc1
    v_add3_u32 v5, v112, v113, s65
    v_add3_u32 v5, v5, v114, v115
    s_nop 1
    v_add_u32_dpp v5, v5, v5 quad_perm:[1,0,3,2] row_mask:0xf bank_mask:0xf
    s_nop 1
    v_add_u32_dpp v5, v5, v5 quad_perm:[2,3,0,1] row_mask:0xf bank_mask:0xf
    buffer_store_dword v5, v19, s[40:43], s73 offen sc1
    ds_write_b32 v2, v2 offset:76
    s_branch L_attn_fin
SP_5:
    s_mov_b32 s67, 0
SP_5b:
    buffer_load_dwordx2 v[4:5], v3, s[40:43], s74 offen sc1
    s_add_u32 s67, s67, 1
    s_waitcnt vmcnt(0)
    v_cmp_ne_u32 vcc, s65, v5
    s_cbranch_vccz SD_6
    s_cmp_lt_u32 s67, 65536
    s_cbranch_scc1 SP_5b
    s_branch SD_6
CL_7:
    s_mov_b32 s67, 0
CL_7b:
    ds_read_b128 v[4:7], v2 offset:16
    ds_read_b32 v120, v27 offset:12288
    ds_read_b32 v124, v27 offset:12800
    s_add_u32 s67, s67, 1
    s_waitcnt lgkmcnt(0)
    v_min_u32 v4, v4, v5
    v_min3_u32 v4, v4, v6, v7
    s_nop 0
    v_readfirstlane_b32 s68, v4
    s_cmp_lg_u32 s68, 0
    s_cbranch_scc1 CD_8
    s_cmp_lt_u32 s67, 4194304
    s_cbranch_scc1 CL_7b
    s_branch CD_8
CL_9:
    s_mov_b32 s67, 0
CL_9b:
    ds_read_b64 v[6:7], v2 offset:0
    s_add_u32 s67, s67, 1
    s_waitcnt lgkmcnt(0)
    v_min_u32 v6, v6, v7
    s_nop 0
    v_readfirstlane_b32 s68, v6
    s_cmp_ge_u32 s68, 4
    s_cbranch_scc1 CD_10
    s_cmp_lt_u32 s67, 4194304
    s_cbranch_scc1 CL_9b
    s_branch CD_10
CL_11:
    s_mov_b32 s67, 0
CL_11b:
    ds_read_b64 v[6:7], v2 offset:0
    s_add_u32 s67, s67, 1
    s_waitcnt lgkmcnt(0)
    v_min_u32 v6, v6, v7
    s_nop 0
    v_readfirstlane_b32 s68, v6
    s_cmp_ge_u32 s68, 6
    s_cbranch_scc1 CD_12
    s_cmp_lt_u32 s67, 4194304
    s_cbranch_scc1 CL_11b
    s_branch CD_12
CL_13:
    s_mov_b32 s67, 0
CL_13b:
    ds_read_b64 v[6:7], v2 offset:0
    s_add_u32 s67, s67, 1
    s_waitcnt lgkmcnt(0)
    v_min_u32 v6, v6, v7
    s_nop 0
    v_readfirstlane_b32 s68, v6
    s_cmp_ge_u32 s68, 8
    s_cbranch_scc1 CD_14
    s_cmp_lt_u32 s67, 4194304
    s_cbranch_scc1 CL_13b
    s_branch CD_14
CL_17:
    s_mov_b32 s67, 0
CL_17b:
    ds_read_b64 v[4:5], v2 offset:8
    ds_read_b32 v120, v27 offset:14336
    s_add_u32 s67, s67, 1
    s_waitcnt lgkmcnt(0)
    v_min_u32 v4, v4, v5
    s_nop 0
    v_readfirstlane_b32 s68, v4
    s_cmp_lg_u32 s68, 0
    s_cbranch_scc1 CD_18
    s_cmp_lt_u32 s67, 4194304
    s_cbranch_scc1 CL_17b
    s_branch CD_18
CL_21:
    s_mov_b32 s67, 0
CL_21b:
    ds_read_b32 v6, v2 offset:32
    s_add_u32 s67, s67, 1
    s_waitcnt lgkmcnt(0)
    v_readfirstlane_b32 s68, v6
    s_lshr_b32 s68, s68, s75
    s_and_b32 s68, s68, 0xff
    s_cmp_eq_u32 s68, 0xff
    s_cbranch_scc1 CD_22
    s_cmp_lt_u32 s67, 4194304
    s_cbranch_scc1 CL_21b
    s_branch CD_22
CL_23:
    s_mov_b32 s67, 0
CL_23b:
    ds_read_b64 v[24:25], v2 offset:0
    ds_read_b64 v[26:27], v2 offset:64
    ds_read_b32 v29, v134 offset:1152
    ds_read_b32 v31, v134 offset:1024
    ds_read_b128 v[112:115], v28 offset:4096
    ds_read_b128 v[116:119], v28 offset:8192
    s_add_u32 s67, s67, 1
    s_waitcnt lgkmcnt(0)
    v_min_u32 v26, v26, v27
    v_add_u32 v26, 3, v26
    v_min3_u32 v24, v24, v25, v26
    s_nop 0
    v_readfirstlane_b32 s68, v24
    s_cmp_ge_u32 s68, 11
    s_cbranch_scc1 CD_24
    s_cmp_lt_u32 s67, 4194304
    s_cbranch_scc1 CL_23b
    s_branch CD_24
FX_25:
    s_mov_b64 exec, s[56:57]
    v_mov_b32 v96, 0
    v_mov_b32 v104, 1.0
    v_mov_b32 v97, 0
    v_mov_b32 v105, 1.0
    v_mov_b32 v98, 0
    v_mov_b32 v106, 1.0
    v_mov_b32 v99, 0
    v_mov_b32 v107, 1.0
    v_mov_b32 v100, 0
    v_mov_b32 v108, 1.0
    v_mov_b32 v101, 0
    v_mov_b32 v109, 1.0
    v_mov_b32 v102, 0
    v_mov_b32 v110, 1.0
    v_mov_b32 v103, 0
    v_mov_b32 v111, 1.0
    s_mov_b64 exec, -1
    s_branch FD_26
FX_27:
    s_mov_b64 exec, s[58:59]
    v_mov_b32 v236, 0
    v_mov_b32 v244, 1.0
    v_mov_b32 v237, 0
    v_mov_b32 v245, 1.0
    v_mov_b32 v238, 0
    v_mov_b32 v246, 1.0
    v_mov_b32 v239, 0
    v_mov_b32 v247, 1.0
    v_mov_b32 v240, 0
    v_mov_b32 v248, 1.0
    v_mov_b32 v241, 0
    v_mov_b32 v249, 1.0
    v_mov_b32 v242, 0
    v_mov_b32 v250, 1.0
    v_mov_b32 v243, 0
    v_mov_b32 v251, 1.0
    s_mov_b64 exec, -1
    s_branch FD_28
PB_29:
    s_cmp_lg_u32 s76, 0
    s_cbranch_scc1 PD_30
    s_mov_b32 s76, 1
    buffer_load_dwordx4 v[64:67], v10, s[40:43], s38 offen offset:0 sc1
    buffer_load_dwordx4 v[68:71], v10, s[40:43], s38 offen offset:1024 sc1
    buffer_load_dwordx4 v[72:75], v10, s[40:43], s38 offen offset:2048 sc1
    buffer_load_dwordx4 v[76:79], v10, s[40:43], s38 offen offset:3072 sc1
    buffer_load_dwordx4 v[80:83], v10, s[40:43], s39 offen offset:0 sc1
    buffer_load_dwordx4 v[84:87], v10, s[40:43], s39 offen offset:1024 sc1
    buffer_load_dwordx4 v[88:91], v10, s[40:43], s39 offen offset:2048 sc1
    buffer_load_dwordx4 v[92:95], v10, s[40:43], s39 offen offset:3072 sc1
    buffer_load_dword v234, v12, s[40:43], s74 offen offset:0 sc1
    buffer_load_dword v235, v12, s[40:43], s74 offen offset:256 sc1
    s_branch PD_30
PB_31:
    s_cmp_lg_u32 s76, 0
    s_cbranch_scc1 PD_32
    s_mov_b32 s76, 1
    buffer_load_dwordx4 v[64:67], v10, s[40:43], s38 offen offset:0 sc1
    buffer_load_dwordx4 v[68:71], v10, s[40:43], s38 offen offset:1024 sc1
    buffer_load_dwordx4 v[72:75], v10, s[40:43], s38 offen offset:2048 sc1
    buffer_load_dwordx4 v[76:79], v10, s[40:43], s38 offen offset:3072 sc1
    buffer_load_dwordx4 v[80:83], v10, s[40:43], s39 offen offset:0 sc1
    buffer_load_dwordx4 v[84:87], v10, s[40:43], s39 offen offset:1024 sc1
    buffer_load_dwordx4 v[88:91], v10, s[40:43], s39 offen offset:2048 sc1
    buffer_load_dwordx4 v[92:95], v10, s[40:43], s39 offen offset:3072 sc1
    buffer_load_dword v234, v12, s[40:43], s74 offen offset:0 sc1
    buffer_load_dword v235, v12, s[40:43], s74 offen offset:256 sc1
    s_branch PD_32
L_redo0:
    s_add_u32 s67, s67, 1
    s_cmp_lt_u32 s67, 65536
    s_cbranch_scc0 L_rd0
    s_nop 7
    s_nop 7
    buffer_load_dwordx4 v[136:139], v10, s[40:43], s61 offen offset:0 sc1
    buffer_load_dwordx4 v[140:143], v10, s[40:43], s61 offen offset:1024 sc1
    buffer_load_dwordx4 v[144:147], v10, s[40:43], s61 offen offset:2048 sc1
    buffer_load_dwordx4 v[148:151], v10, s[40:43], s61 offen offset:3072 sc1
    buffer_load_dwordx4 v[152:155], v10, s[40:43], s63 offen offset:0 sc1
    buffer_load_dwordx4 v[156:159], v10, s[40:43], s63 offen offset:1024 sc1
    buffer_load_dwordx4 v[160:163], v10, s[40:43], s63 offen offset:2048 sc1
    buffer_load_dwordx4 v[164:167], v10, s[40:43], s63 offen offset:3072 sc1
    buffer_load_dword v232, v12, s[40:43], s74 offen offset:2048 sc1
    buffer_load_dword v233, v12, s[40:43], s74 offen offset:2304 sc1
    s_branch L_pm0
CL_34:
    s_mov_b32 s67, 0
CL_34b:
    ds_read_b128 v[4:7], v2 offset:80
    ds_read_b128 v[136:139], v16 offset:0
    ds_read_b128 v[140:143], v16 offset:1024
    ds_read_b128 v[144:147], v17 offset:2048
    ds_read_b128 v[148:151], v17 offset:3072
    ds_read_b128 v[152:155], v18 offset:4096
    ds_read_b128 v[156:159], v18 offset:5120
    s_add_u32 s67, s67, 1
    s_waitcnt lgkmcnt(0)
    v_min_u32 v4, v4, v5
    v_min3_u32 v4, v4, v6, v7
    s_nop 0
    v_readfirstlane_b32 s68, v4
    s_cmp_lg_u32 s68, 0
    s_cbranch_scc1 CD_35
    s_cmp_lt_u32 s67, 4194304
    s_cbranch_scc1 CL_34b
    s_branch CD_35
HX_36:
    s_mov_b64 exec, s[56:57]
    v_lshlrev_b32 v4, 8, v29
    v_lshl_add_u32 v4, v9, 4, v4
    s_lshl_b32 s72, s3, 6
    v_add3_u32 v4, v4, s72, v2
    v_lshl_add_u32 v5, v29, 2, v2
    ds_write_b128 v4, v[96:99] offset:12032
    ds_write_b128 v4, v[100:103] offset:12064
    s_mov_b32 exec_hi, 0
    ds_add_u32 v5, v21 offset:124
    s_mov_b64 exec, -1
    s_branch HD_37
L_redo1:
    s_add_u32 s67, s67, 1
    s_cmp_lt_u32 s67, 65536
    s_cbranch_scc0 L_rd1
    s_nop 7
    s_nop 7
    buffer_load_dwordx4 v[64:67], v10, s[40:43], s38 offen offset:0 sc1
    buffer_load_dwordx4 v[68:71], v10, s[40:43], s38 offen offset:1024 sc1
    buffer_load_dwordx4 v[72:75], v10, s[40:43], s38 offen offset:2048 sc1
    buffer_load_dwordx4 v[76:79], v10, s[40:43], s38 offen offset:3072 sc1
    buffer_load_dwordx4 v[80:83], v10, s[40:43], s39 offen offset:0 sc1
    buffer_load_dwordx4 v[84:87], v10, s[40:43], s39 offen offset:1024 sc1
    buffer_load_dwordx4 v[88:91], v10, s[40:43], s39 offen offset:2048 sc1
    buffer_load_dwordx4 v[92:95], v10, s[40:43], s39 offen offset:3072 sc1
    buffer_load_dword v234, v12, s[40:43], s74 offen offset:0 sc1
    buffer_load_dword v235, v12, s[40:43], s74 offen offset:256 sc1
    s_branch L_pm1
CL_38:
    s_mov_b32 s67, 0
CL_38b:
    ds_read_b128 v[4:7], v2 offset:96
    ds_read_b128 v[64:67], v16 offset:8192
    ds_read_b128 v[68:71], v16 offset:9216
    ds_read_b128 v[72:75], v17 offset:10240
    ds_read_b128 v[76:79], v17 offset:11264
    ds_read_b128 v[80:83], v18 offset:12288
    ds_read_b128 v[84:87], v18 offset:13312
    s_add_u32 s67, s67, 1
    s_waitcnt lgkmcnt(0)
    v_min_u32 v4, v4, v5
    v_min3_u32 v4, v4, v6, v7
    s_nop 0
    v_readfirstlane_b32 s68, v4
    s_cmp_lg_u32 s68, 0
    s_cbranch_scc1 CD_39
    s_cmp_lt_u32 s67, 4194304
    s_cbranch_scc1 CL_38b
    s_branch CD_39
HX_40:
    s_mov_b64 exec, s[58:59]
    v_lshlrev_b32 v4, 8, v31
    v_lshl_add_u32 v4, v9, 4, v4
    s_lshl_b32 s72, s3, 6
    v_add3_u32 v4, v4, s72, v2
    v_lshl_add_u32 v5, v31, 2, v2
    ds_write_b128 v4, v[236:239] offset:12032
    ds_write_b128 v4, v[240:243] offset:12064
    s_mov_b32 exec_hi, 0
    ds_add_u32 v5, v21 offset:124
    s_mov_b64 exec, -1
    s_branch HD_41
L_moe:
    s_setprio 2
    v_lshrrev_b32 v17, 4, v1
    s_mov_b32 s78, 0x00ff00ff
    s_mov_b32 s79, 0x00ff00ff
    s_cmp_lg_u32 s73, 0
    s_cbranch_scc1 L_rgslow
    v_lshl_or_b32 v166, v102, 16, 6
    v_med3_u32 v78, v77, v78, v166
    v_med3_u32 v77, v76, v77, v166
    v_max_u32 v76, v76, v166
    v_and_or_b32 v167, v102, s77, 7
    v_med3_u32 v78, v77, v78, v167
    v_med3_u32 v77, v76, v77, v167
    v_max_u32 v76, v76, v167
    v_lshl_or_b32 v168, v104, 16, 8
    v_med3_u32 v78, v77, v78, v168
    v_med3_u32 v77, v76, v77, v168
    v_max_u32 v76, v76, v168
    v_and_or_b32 v169, v104, s77, 9
    v_med3_u32 v78, v77, v78, v169
    v_med3_u32 v77, v76, v77, v169
    v_max_u32 v76, v76, v169
    v_lshl_or_b32 v170, v106, 16, 10
    v_med3_u32 v78, v77, v78, v170
    v_med3_u32 v77, v76, v77, v170
    v_max_u32 v76, v76, v170
    v_and_or_b32 v171, v106, s77, 11
    v_med3_u32 v78, v77, v78, v171
    v_med3_u32 v77, v76, v77, v171
    v_max_u32 v76, v76, v171
    v_lshl_or_b32 v172, v108, 16, 12
    v_med3_u32 v78, v77, v78, v172
    v_med3_u32 v77, v76, v77, v172
    v_max_u32 v76, v76, v172
    v_and_or_b32 v173, v108, s77, 13
    v_med3_u32 v78, v77, v78, v173
    v_med3_u32 v77, v76, v77, v173
    v_max_u32 v76, v76, v173
    v_lshl_or_b32 v174, v110, 16, 14
    v_med3_u32 v78, v77, v78, v174
    v_med3_u32 v77, v76, v77, v174
    v_max_u32 v76, v76, v174
    v_and_or_b32 v175, v110, s77, 15
    v_med3_u32 v78, v77, v78, v175
    v_med3_u32 v77, v76, v77, v175
    v_max_u32 v76, v76, v175
    v_lshl_or_b32 v176, v112, 16, 16
    v_med3_u32 v78, v77, v78, v176
    v_med3_u32 v77, v76, v77, v176
    v_max_u32 v76, v76, v176
    v_and_or_b32 v177, v112, s77, 17
    v_med3_u32 v78, v77, v78, v177
    v_med3_u32 v77, v76, v77, v177
    v_max_u32 v76, v76, v177
    v_lshl_or_b32 v178, v114, 16, 18
    v_med3_u32 v78, v77, v78, v178
    v_med3_u32 v77, v76, v77, v178
    v_max_u32 v76, v76, v178
    v_and_or_b32 v179, v114, s77, 19
    v_med3_u32 v78, v77, v78, v179
    v_med3_u32 v77, v76, v77, v179
    v_max_u32 v76, v76, v179
    v_lshl_or_b32 v180, v116, 16, 20
    v_med3_u32 v78, v77, v78, v180
    v_med3_u32 v77, v76, v77, v180
    v_max_u32 v76, v76, v180
    v_and_or_b32 v181, v116, s77, 21
    v_med3_u32 v78, v77, v78, v181
    v_med3_u32 v77, v76, v77, v181
    v_max_u32 v76, v76, v181
    v_lshl_or_b32 v182, v118, 16, 22
    v_med3_u32 v78, v77, v78, v182
    v_med3_u32 v77, v76, v77, v182
    v_max_u32 v76, v76, v182
    v_and_or_b32 v183, v118, s77, 23
    v_med3_u32 v78, v77, v78, v183
    v_med3_u32 v77, v76, v77, v183
    v_max_u32 v76, v76, v183
    v_lshl_or_b32 v184, v120, 16, 24
    v_med3_u32 v78, v77, v78, v184
    v_med3_u32 v77, v76, v77, v184
    v_max_u32 v76, v76, v184
    v_and_or_b32 v185, v120, s77, 25
    v_med3_u32 v78, v77, v78, v185
    v_med3_u32 v77, v76, v77, v185
    v_max_u32 v76, v76, v185
    v_lshl_or_b32 v186, v122, 16, 26
    v_med3_u32 v78, v77, v78, v186
    v_med3_u32 v77, v76, v77, v186
    v_max_u32 v76, v76, v186
    v_and_or_b32 v187, v122, s77, 27
    v_med3_u32 v78, v77, v78, v187
    v_med3_u32 v77, v76, v77, v187
    v_max_u32 v76, v76, v187
    v_lshl_or_b32 v188, v124, 16, 28
    v_med3_u32 v78, v77, v78, v188
    v_med3_u32 v77, v76, v77, v188
    v_max_u32 v76, v76, v188
    v_and_or_b32 v189, v124, s77, 29
    v_med3_u32 v78, v77, v78, v189
    v_med3_u32 v77, v76, v77, v189
    v_max_u32 v76, v76, v189
    v_lshl_or_b32 v190, v126, 16, 30
    v_med3_u32 v78, v77, v78, v190
    v_med3_u32 v77, v76, v77, v190
    v_max_u32 v76, v76, v190
    v_and_or_b32 v191, v126, s77, 31
    v_med3_u32 v78, v77, v78, v191
    v_med3_u32 v77, v76, v77, v191
    v_max_u32 v76, v76, v191
    v_or_b32 v76, v76, v80
    v_or_b32 v77, v77, v80
    v_or_b32 v78, v78, v80
    s_nop 0
    v_max_u32_dpp v82, v76, v76 quad_perm:[1,0,3,2] row_mask:0xf bank_mask:0xf
    s_nop 1
    v_max_u32_dpp v82, v82, v82 quad_perm:[2,3,0,1] row_mask:0xf bank_mask:0xf
    s_nop 1
    v_max_u32_dpp v82, v82, v82 row_half_mirror row_mask:0xf bank_mask:0xf
    s_nop 1
    v_max_u32_dpp v82, v82, v82 row_mirror row_mask:0xf bank_mask:0xf
    s_nop 1
    v_max_u32_dpp v82, v82, v82 row_bcast:15 row_mask:0xa bank_mask:0xf
    s_nop 1
    v_max_u32_dpp v82, v82, v82 row_bcast:31 row_mask:0xc bank_mask:0xf
    s_nop 0
    v_readlane_b32 s74, v82, 63
    s_nop 1
    v_cmp_eq_u32 vcc, s74, v76
    v_mov_b32 v83, s74
    s_nop 0
    v_cndmask_b32 v76, v76, v77, vcc
    v_cndmask_b32 v77, v77, v78, vcc
    v_cndmask_b32 v78, v78, v81, vcc
    v_max_u32_dpp v82, v76, v76 quad_perm:[1,0,3,2] row_mask:0xf bank_mask:0xf
    v_cndmask_b32_e64 v79, v79, v83, s[62:63]
    s_lshl_b64 s[62:63], s[62:63], 1
    v_max_u32_dpp v82, v82, v82 quad_perm:[2,3,0,1] row_mask:0xf bank_mask:0xf
    s_nop 1
    v_max_u32_dpp v82, v82, v82 row_half_mirror row_mask:0xf bank_mask:0xf
    s_nop 1
    v_max_u32_dpp v82, v82, v82 row_mirror row_mask:0xf bank_mask:0xf
    s_nop 1
    v_max_u32_dpp v82, v82, v82 row_bcast:15 row_mask:0xa bank_mask:0xf
    s_nop 1
    v_max_u32_dpp v82, v82, v82 row_bcast:31 row_mask:0xc bank_mask:0xf
    s_nop 0
    v_readlane_b32 s74, v82, 63
    s_nop 1
    v_cmp_eq_u32 vcc, s74, v76
    v_mov_b32 v83, s74
    s_nop 0
    v_cndmask_b32 v76, v76, v77, vcc
    v_cndmask_b32 v77, v77, v78, vcc
    v_cndmask_b32 v78, v78, v81, vcc
    v_max_u32_dpp v82, v76, v76 quad_perm:[1,0,3,2] row_mask:0xf bank_mask:0xf
    v_cndmask_b32_e64 v79, v79, v83, s[62:63]
    s_lshl_b64 s[62:63], s[62:63], 1
    v_max_u32_dpp v82, v82, v82 quad_perm:[2,3,0,1] row_mask:0xf bank_mask:0xf
    s_nop 1
    v_max_u32_dpp v82, v82, v82 row_half_mirror row_mask:0xf bank_mask:0xf
    s_nop 1
    v_max_u32_dpp v82, v82, v82 row_mirror row_mask:0xf bank_mask:0xf
    s_nop 1
    v_max_u32_dpp v82, v82, v82 row_bcast:15 row_mask:0xa bank_mask:0xf
    s_nop 1
    v_max_u32_dpp v82, v82, v82 row_bcast:31 row_mask:0xc bank_mask:0xf
    s_nop 0
    v_readlane_b32 s74, v82, 63
    s_nop 1
    v_cmp_eq_u32 vcc, s74, v76
    v_mov_b32 v83, s74
    s_nop 0
    v_cndmask_b32 v76, v76, v77, vcc
    v_cndmask_b32 v77, v77, v78, vcc
    v_cndmask_b32 v78, v78, v81, vcc
    v_max_u32_dpp v82, v76, v76 quad_perm:[1,0,3,2] row_mask:0xf bank_mask:0xf
    v_cndmask_b32_e64 v79, v79, v83, s[62:63]
    s_lshl_b64 s[62:63], s[62:63], 1
    v_max_u32_dpp v82, v82, v82 quad_perm:[2,3,0,1] row_mask:0xf bank_mask:0xf
    s_nop 1
    v_max_u32_dpp v82, v82, v82 row_half_mirror row_mask:0xf bank_mask:0xf
    s_nop 1
    v_max_u32_dpp v82, v82, v82 row_mirror row_mask:0xf bank_mask:0xf
    s_nop 1
    v_max_u32_dpp v82, v82, v82 row_bcast:15 row_mask:0xa bank_mask:0xf
    s_nop 1
    v_max_u32_dpp v82, v82, v82 row_bcast:31 row_mask:0xc bank_mask:0xf
    s_nop 0
    v_readlane_b32 s74, v82, 63
    s_nop 1
    v_cmp_eq_u32 vcc, s74, v76
    v_mov_b32 v83, s74
    s_nop 0
    v_cndmask_b32 v76, v76, v77, vcc
    v_cndmask_b32 v77, v77, v78, vcc
    v_cndmask_b32 v78, v78, v81, vcc
    v_max_u32_dpp v82, v76, v76 quad_perm:[1,0,3,2] row_mask:0xf bank_mask:0xf
    v_cndmask_b32_e64 v79, v79, v83, s[62:63]
    s_lshl_b64 s[62:63], s[62:63], 1
    v_max_u32_dpp v82, v82, v82 quad_perm:[2,3,0,1] row_mask:0xf bank_mask:0xf
    s_nop 1
    v_max_u32_dpp v82, v82, v82 row_half_mirror row_mask:0xf bank_mask:0xf
    s_nop 1
    v_max_u32_dpp v82, v82, v82 row_mirror row_mask:0xf bank_mask:0xf
    s_nop 1
    v_max_u32_dpp v82, v82, v82 row_bcast:15 row_mask:0xa bank_mask:0xf
    s_nop 1
    v_max_u32_dpp v82, v82, v82 row_bcast:31 row_mask:0xc bank_mask:0xf
    s_nop 0
    v_readlane_b32 s74, v82, 63
    s_nop 1
    v_cmp_eq_u32 vcc, s74, v76
    v_mov_b32 v83, s74
    s_nop 0
    v_cndmask_b32 v76, v76, v77, vcc
    v_cndmask_b32 v77, v77, v78, vcc
    v_cndmask_b32 v78, v78, v81, vcc
    v_max_u32_dpp v82, v76, v76 quad_perm:[1,0,3,2] row_mask:0xf bank_mask:0xf
    v_cndmask_b32_e64 v79, v79, v83, s[62:63]
    s_lshl_b64 s[62:63], s[62:63], 1
    v_max_u32_dpp v82, v82, v82 quad_perm:[2,3,0,1] row_mask:0xf bank_mask:0xf
    s_nop 1
    v_max_u32_dpp v82, v82, v82 row_half_mirror row_mask:0xf bank_mask:0xf
    s_nop 1
    v_max_u32_dpp v82, v82, v82 row_mirror row_mask:0xf bank_mask:0xf
    s_nop 1
    v_max_u32_dpp v82, v82, v82 row_bcast:15 row_mask:0xa bank_mask:0xf
    s_nop 1
    v_max_u32_dpp v82, v82, v82 row_bcast:31 row_mask:0xc bank_mask:0xf
    s_nop 0
    v_readlane_b32 s74, v82, 63
    s_nop 1
    v_cmp_eq_u32 vcc, s74, v76
    v_mov_b32 v83, s74
    s_nop 0
    v_cndmask_b32 v76, v76, v77, vcc
    v_cndmask_b32 v77, v77, v78, vcc
    v_cndmask_b32 v78, v78, v81, vcc
    v_max_u32_dpp v82, v76, v76 quad_perm:[1,0,3,2] row_mask:0xf bank_mask:0xf
    v_cndmask_b32_e64 v79, v79, v83, s[62:63]
    s_lshl_b64 s[62:63], s[62:63], 1
    v_max_u32_dpp v82, v82, v82 quad_perm:[2,3,0,1] row_mask:0xf bank_mask:0xf
    s_nop 1
    v_max_u32_dpp v82, v82, v82 row_half_mirror row_mask:0xf bank_mask:0xf
    s_nop 1
    v_max_u32_dpp v82, v82, v82 row_mirror row_mask:0xf bank_mask:0xf
    s_nop 1
    v_max_u32_dpp v82, v82, v82 row_bcast:15 row_mask:0xa bank_mask:0xf
    s_nop 1
    v_max_u32_dpp v82, v82, v82 row_bcast:31 row_mask:0xc bank_mask:0xf
    s_nop 0
    v_readlane_b32 s74, v82, 63
    s_nop 1
    v_cmp_eq_u32 vcc, s74, v76
    v_mov_b32 v83, s74
    s_nop 0
    v_cndmask_b32 v76, v76, v77, vcc
    v_cndmask_b32 v77, v77, v78, vcc
    v_cndmask_b32 v78, v78, v81, vcc
    v_max_u32_dpp v82, v76, v76 quad_perm:[1,0,3,2] row_mask:0xf bank_mask:0xf
    v_cndmask_b32_e64 v79, v79, v83, s[62:63]
    s_lshl_b64 s[62:63], s[62:63], 1
    v_max_u32_dpp v82, v82, v82 quad_perm:[2,3,0,1] row_mask:0xf bank_mask:0xf
    s_nop 1
    v_max_u32_dpp v82, v82, v82 row_half_mirror row_mask:0xf bank_mask:0xf
    s_nop 1
    v_max_u32_dpp v82, v82, v82 row_mirror row_mask:0xf bank_mask:0xf
    s_nop 1
    v_max_u32_dpp v82, v82, v82 row_bcast:15 row_mask:0xa bank_mask:0xf
    s_nop 1
    v_max_u32_dpp v82, v82, v82 row_bcast:31 row_mask:0xc bank_mask:0xf
    s_nop 0
    v_readlane_b32 s74, v82, 63
    s_nop 1
    v_cmp_eq_u32 vcc, s74, v76
    v_mov_b32 v83, s74
    s_nop 0
L_tfin:
    v_cmp_eq_u32 vcc, 0, v76
    v_cndmask_b32_e64 v79, v79, v83, s[62:63]
    s_cbranch_vccnz L_tslow
L_tdone:
    v_and_b32 v4, 28, v79
    v_bfe_u32 v6, v79, 5, 6
    v_and_b32 v15, 3, v79
    v_lshl_or_b32 v15, v4, 6, v15
    v_lshl_or_b32 v15, v6, 2, v15
    s_cmp_eq_u32 s27, 3
    s_cbranch_scc1 L_sig
    s_lshl_b32 s54, s71, 8
    s_mov_b32 s55, 49152
    v_lshlrev_b32 v4, 10, v15
    v_lshl_add_u32 v4, v17, 4, v4
    v_lshlrev_b32 v6, 3, v15
    s_mov_b64 exec, s[78:79]
    buffer_load_dwordx4 v[128:131], v4, s[28:31], s54 offen offset:0
    buffer_load_dwordx4 v[132:135], v4, s[28:31], s54 offen offset:64
    buffer_load_dwordx4 v[136:139], v4, s[28:31], s54 offen offset:128
    buffer_load_dwordx4 v[140:143], v4, s[28:31], s54 offen offset:192
    s_not_b64 exec, s[78:79]
    buffer_load_dwordx4 v[144:147], v4, s[28:31], s54 offen offset:0
    buffer_load_dwordx4 v[148:151], v4, s[28:31], s54 offen offset:64
    buffer_load_dwordx4 v[152:155], v4, s[28:31], s54 offen offset:128
    buffer_load_dwordx4 v[156:159], v4, s[28:31], s54 offen offset:192
    s_mov_b64 exec, -1
    buffer_load_dwordx2 v[28:29], v6, s[40:43], s55 offen sc1
    s_add_u32 m0, s38, 0
    s_nop 0
    buffer_load_dwordx4 v71, s[56:59], s44 offen nt lds
    buffer_load_dwordx4 v72, s[56:59], s44 offen offset:1024 nt lds
    s_add_u32 s44, s44, 8192
    s_add_u32 m0, s38, 2048
    s_nop 0
    buffer_load_dwordx4 v71, s[56:59], s44 offen nt lds
    buffer_load_dwordx4 v72, s[56:59], s44 offen offset:1024 nt lds
    s_add_u32 s44, s44, 8192
    s_add_u32 m0, s38, 4096
    s_nop 0
    buffer_load_dwordx4 v71, s[56:59], s44 offen nt lds
    buffer_load_dwordx4 v72, s[56:59], s44 offen offset:1024 nt lds
    s_add_u32 s44, s44, 8192
    s_add_u32 m0, s38, 6144
    s_nop 0
    buffer_load_dwordx4 v71, s[56:59], s44 offen nt lds
    buffer_load_dwordx4 v72, s[56:59], s44 offen offset:1024 nt lds
L_sig:
    v_lshrrev_b32 v4, 6, v15
    v_cmp_eq_u32 vcc, s26, v4
    v_and_b32 v4, 63, v15
    v_lshl_add_u32 v4, v4, 2, v2
    v_add_u32 v5, 1, v1
    s_and_b32 s47, vcc_lo, 0xff
    s_mov_b32 exec_hi, 0
    s_mov_b32 exec_lo, s47
    ds_write_b32 v4, v5 offset:1024
    s_mov_b64 exec, 0x80
    ds_write_b32 v2, v5 offset:64
    s_mov_b64 exec, -1
    s_mov_b32 s59, 0x04000c0c
    s_mov_b32 s60, 0x0706000c
    s_or_b32 s68, s26, s27
    s_cbranch_scc0 L_bump
L_nobump:
    s_cmp_eq_u32 s27, 3
    s_cbranch_scc1 L_cons
    v_bfe_u32 v24, v1, 2, 2
    v_and_b32 v25, 3, v1
    v_lshlrev_b32 v25, 3, v25
    v_lshl_add_u32 v26, v17, 3, v24
    v_lshl_add_u32 v26, v26, 6, v25
    v_and_b32 v27, 1, v17
    v_lshl_add_u32 v26, v27, 5, v26
    v_lshl_add_u32 v30, v17, 2, v24
    v_lshl_add_u32 v31, v30, 8, v25
    v_and_b32 v30, 7, v30
    v_lshl_add_u32 v31, v30, 5, v31
    v_add_u32 v20, s36, v26
    v_add_u32 v21, s37, v26
    v_xor_b32 v22, 32, v20
    v_xor_b32 v23, 32, v21
    v_add_u32 v31, s38, v31
    v_mov_b32 v51, s65
    v_mov_b32 v55, s65
    s_mov_b32 s56, 0x07060501
    s_mov_b32 s57, 0x07060502
    s_mov_b32 s58, 0x07060503
    s_lshl_b32 s52, s70, 13
    s_add_u32 s52, s52, 17825792
    s_lshl_b32 s53, s71, 11
    s_add_u32 s61, s52, s53
    s_xor_b32 s62, s53, 2048
    s_add_u32 s62, s62, s52
    s_xor_b32 s63, s53, 4096
    s_add_u32 s63, s63, s52
    s_xor_b32 s53, s53, 6144
    s_add_u32 s53, s53, s52
    s_and_b32 s45, s27, 7
    s_lshl_b32 s45, s45, 5
    s_add_u32 s45, s45, s26
    s_andn2_b32 s45, s45, 3
    s_lshl_b32 s45, s45, 8
    s_add_u32 s45, s45, 1048608
    s_lshl_b32 s46, s71, 8
    s_add_u32 s46, s46, s45
    s_lshl_b32 s68, s71, 2
    s_add_u32 s45, s45, s68
    s_lshl_b32 s49, 1, s71
    s_andn2_b32 s49, 15, s49
    v_lshlrev_b32 v19, 8, v1
    v_lshlrev_b32 v10, 2, v1
    v_and_b32 v4, 7, v1
    v_bfe_u32 v7, v1, 3, 1
    v_lshlrev_b32 v11, 13, v4
    v_lshl_add_u32 v11, v7, 10, v11
    v_mul_u32_u24 v4, 114688, v4
    v_lshl_add_u32 v4, v7, 6, v4
    v_lshl_add_u32 v18, v17, 4, v4
    s_lshl_b32 s48, s71, 11
    s_lshr_b32 s68, s70, 3
    s_lshl_b32 s68, s68, 7
    s_add_u32 s48, s48, s68
    s_and_b32 s68, s70, 7
    s_lshl_b32 s68, s68, 2
    s_add_u32 s48, s48, s68
    s_add_u32 s48, s48, 18350080
    s_waitcnt vmcnt(17)
    ds_read_b64_tr_b16 v[192:193], v20 offset:0
    ds_read_b64_tr_b16 v[194:195], v20 offset:256
    ds_read_b64_tr_b16 v[224:225], v21 offset:0
    ds_read_b64_tr_b16 v[226:227], v21 offset:256
    ds_read_b64_tr_b16 v[208:209], v22 offset:0
    ds_read_b64_tr_b16 v[210:211], v22 offset:256
    ds_read_b64_tr_b16 v[240:241], v23 offset:0
    ds_read_b64_tr_b16 v[242:243], v23 offset:256
    ds_read_b64_tr_b16 v[196:197], v20 offset:2048
    ds_read_b64_tr_b16 v[198:199], v20 offset:2304
    ds_read_b64_tr_b16 v[228:229], v21 offset:2048
    ds_read_b64_tr_b16 v[230:231], v21 offset:2304
    ds_read_b64_tr_b16 v[212:213], v22 offset:2048
    ds_read_b64_tr_b16 v[214:215], v22 offset:2304
    ds_read_b64_tr_b16 v[244:245], v23 offset:2048
    ds_read_b64_tr_b16 v[246:247], v23 offset:2304
    ds_read_b64_tr_b16 v[200:201], v20 offset:4096
    ds_read_b64_tr_b16 v[202:203], v20 offset:4352
    ds_read_b64_tr_b16 v[232:233], v21 offset:4096
    ds_read_b64_tr_b16 v[234:235], v21 offset:4352
    ds_read_b64_tr_b16 v[216:217], v22 offset:4096
    ds_read_b64_tr_b16 v[218:219], v22 offset:4352
    ds_read_b64_tr_b16 v[248:249], v23 offset:4096
    ds_read_b64_tr_b16 v[250:251], v23 offset:4352
    ds_read_b64_tr_b16 v[204:205], v20 offset:6144
    ds_read_b64_tr_b16 v[206:207], v20 offset:6400
    ds_read_b64_tr_b16 v[236:237], v21 offset:6144
    ds_read_b64_tr_b16 v[238:239], v21 offset:6400
    ds_read_b64_tr_b16 v[220:221], v22 offset:6144
    ds_read_b64_tr_b16 v[222:223], v22 offset:6400
    ds_read_b64_tr_b16 v[252:253], v23 offset:6144
    ds_read_b64_tr_b16 v[254:255], v23 offset:6400
    s_waitcnt vmcnt(9) lgkmcnt(0)
    v_mfma_f32_16x16x32_bf16 v[32:35], v[192:195], v[128:131], 0
    v_mfma_f32_16x16x32_bf16 v[40:43], v[224:227], v[128:131], 0
    v_mfma_f32_16x16x32_bf16 v[36:39], v[208:211], v[144:147], 0
    v_mfma_f32_16x16x32_bf16 v[44:47], v[240:243], v[144:147], 0
    v_mfma_f32_16x16x32_bf16 v[32:35], v[196:199], v[132:135], v[32:35]
    v_mfma_f32_16x16x32_bf16 v[40:43], v[228:231], v[132:135], v[40:43]
    v_mfma_f32_16x16x32_bf16 v[36:39], v[212:215], v[148:151], v[36:39]
    v_mfma_f32_16x16x32_bf16 v[44:47], v[244:247], v[148:151], v[44:47]
    v_mfma_f32_16x16x32_bf16 v[32:35], v[200:203], v[136:139], v[32:35]
    v_mfma_f32_16x16x32_bf16 v[40:43], v[232:235], v[136:139], v[40:43]
    v_mfma_f32_16x16x32_bf16 v[36:39], v[216:219], v[152:155], v[36:39]
    v_mfma_f32_16x16x32_bf16 v[44:47], v[248:251], v[152:155], v[44:47]
    v_mfma_f32_16x16x32_bf16 v[32:35], v[204:207], v[140:143], v[32:35]
    v_mfma_f32_16x16x32_bf16 v[40:43], v[236:239], v[140:143], v[40:43]
    v_mfma_f32_16x16x32_bf16 v[36:39], v[220:223], v[156:159], v[36:39]
    v_mfma_f32_16x16x32_bf16 v[44:47], v[252:255], v[156:159], v[44:47]
    s_waitcnt vmcnt(8)
    v_cmp_ne_u32 vcc, s65, v29
    v_lshlrev_b32 v30, 16, v28
    s_cbranch_vccnz L_sg6
L_sg6d:
    v_xor_b32 v30, 0x80000000, v30
    v_and_b32 v29, s77, v28
    v_rcp_f32 v28, v29
    s_nop 2
    v_fmac_f32_dpp v32, v32, v30 row_shl:8 row_mask:0xf bank_mask:0x3
    v_fmac_f32_dpp v36, v36, v30 row_shr:8 row_mask:0xf bank_mask:0xc
    v_fmac_f32_dpp v40, v40, v30 row_shl:8 row_mask:0xf bank_mask:0x3
    v_fmac_f32_dpp v44, v44, v30 row_shr:8 row_mask:0xf bank_mask:0xc
    v_fmac_f32_dpp v33, v33, v30 row_shl:8 row_mask:0xf bank_mask:0x3
    v_fmac_f32_dpp v37, v37, v30 row_shr:8 row_mask:0xf bank_mask:0xc
    v_fmac_f32_dpp v41, v41, v30 row_shl:8 row_mask:0xf bank_mask:0x3
    v_fmac_f32_dpp v45, v45, v30 row_shr:8 row_mask:0xf bank_mask:0xc
    v_fmac_f32_dpp v34, v34, v30 row_shl:8 row_mask:0xf bank_mask:0x3
    v_fmac_f32_dpp v38, v38, v30 row_shr:8 row_mask:0xf bank_mask:0xc
    v_fmac_f32_dpp v42, v42, v30 row_shl:8 row_mask:0xf bank_mask:0x3
    v_fmac_f32_dpp v46, v46, v30 row_shr:8 row_mask:0xf bank_mask:0xc
    v_fmac_f32_dpp v35, v35, v30 row_shl:8 row_mask:0xf bank_mask:0x3
    v_fmac_f32_dpp v39, v39, v30 row_shr:8 row_mask:0xf bank_mask:0xc
    v_fmac_f32_dpp v43, v43, v30 row_shl:8 row_mask:0xf bank_mask:0x3
    v_fmac_f32_dpp v47, v47, v30 row_shr:8 row_mask:0xf bank_mask:0xc
    v_perm_b32 v48, v36, v45, s56
    v_perm_b32 v49, v37, v45, s57
    v_perm_b32 v50, v44, v45, s58
    v_perm_b32 v52, v38, v47, s56
    v_perm_b32 v53, v39, v47, s57
    v_perm_b32 v54, v46, v47, s58
    s_mov_b64 exec, s[78:79]
    v_perm_b32 v48, v32, v41, s56
    v_perm_b32 v49, v33, v41, s57
    v_perm_b32 v50, v40, v41, s58
    v_perm_b32 v52, v34, v43, s56
    v_perm_b32 v53, v35, v43, s57
    v_perm_b32 v54, v42, v43, s58
    s_mov_b64 exec, -1
    buffer_store_dwordx4 v[48:51], v68, s[40:43], s61 offen offset:0 sc1
    buffer_store_dwordx4 v[52:55], v68, s[40:43], s61 offen offset:1024 sc1
    s_mov_b32 exec_hi, 0
    s_mov_b32 exec_lo, s49
    buffer_atomic_swap v51, v19, s[40:43], s45 offen sc1
    v_mov_b32 v5, 0
    buffer_atomic_or v5, v10, s[40:43], s46 offen sc0 sc1
    s_mov_b64 exec, -1
    s_mul_i32 s54, s71, 28672
    s_lshl_b32 s55, s70, 8
    s_add_u32 s54, s54, s55
    s_add_u32 s54, s54, 16777216
    s_add_u32 s55, s54, 14336
    v_mul_f32 v29, 0xbfb8aa3b, v28
    v_mov_b32 v227, s65
    v_mov_b32 v231, s65
    v_mov_b32 v235, s65
    v_mov_b32 v239, s65
    v_mov_b32 v66, v50
    v_perm_b32 v67, v50, v49, s59
    v_perm_b32 v67, v67, v48, s60
    v_mov_b32 v70, v54
    v_perm_b32 v71, v54, v53, s59
    v_perm_b32 v71, v71, v52, s60
    s_mov_b32 s50, s49
    s_mov_b32 s51, 0
    s_mov_b64 exec, s[50:51]
    s_waitcnt vmcnt(0)
    v_cmpx_ne_u32 vcc, s65, v5
    s_cbranch_execz L_pgfd
    s_mov_b64 exec, -1
    s_setprio 0
    s_mov_b32 s67, 0
W_42:
    ds_read_b32 v4, v2 offset:56
    s_waitcnt lgkmcnt(0)
    v_readfirstlane_b32 s68, v4
    s_cmp_ge_u32 s68, 1
    s_cbranch_scc1 D_43
    s_add_u32 s67, s67, 1
    s_cmp_lt_u32 s67, 4194304
    s_cbranch_scc1 W_42
D_43:
    s_setprio 2
    s_mov_b32 s76, 0
    s_mov_b64 exec, s[50:51]
L_pgf:
    v_mov_b32 v5, 0
    buffer_atomic_or v5, v10, s[40:43], s46 offen sc0 sc1
L_pgfw:
    s_add_u32 s76, s76, 1
    s_cmp_lt_u32 s76, 65536
    s_waitcnt vmcnt(0)
    v_cmpx_ne_u32 vcc, s65, v5
    s_cbranch_scc0 L_pgfd
    s_cbranch_execnz L_pgf
L_pgfd:
    s_mov_b64 exec, -1
    buffer_load_dwordx4 v[160:163], v68, s[40:43], s62 offen offset:0 sc1
    buffer_load_dwordx4 v[164:167], v68, s[40:43], s62 offen offset:1024 sc1
    buffer_load_dwordx4 v[168:171], v68, s[40:43], s63 offen offset:0 sc1
    buffer_load_dwordx4 v[172:175], v68, s[40:43], s63 offen offset:1024 sc1
    buffer_load_dwordx4 v[176:179], v68, s[40:43], s53 offen offset:0 sc1
    buffer_load_dwordx4 v[180:183], v68, s[40:43], s53 offen offset:1024 sc1
    s_mov_b32 s76, 0
    ds_read_b64_tr_b16 v[96:97], v31 offset:0
    ds_read_b64_tr_b16 v[98:99], v31 offset:4096
    v_xor_b32 v27, 32, v31
    ds_read_b64_tr_b16 v[100:101], v27 offset:0
    ds_read_b64_tr_b16 v[102:103], v27 offset:4096
    v_xor_b32 v27, 64, v31
    ds_read_b64_tr_b16 v[104:105], v27 offset:0
    ds_read_b64_tr_b16 v[106:107], v27 offset:4096
    v_xor_b32 v27, 96, v31
    ds_read_b64_tr_b16 v[108:109], v27 offset:0
    ds_read_b64_tr_b16 v[110:111], v27 offset:4096
    v_xor_b32 v27, 128, v31
    ds_read_b64_tr_b16 v[112:113], v27 offset:0
    ds_read_b64_tr_b16 v[114:115], v27 offset:4096
    v_xor_b32 v27, 160, v31
    ds_read_b64_tr_b16 v[116:117], v27 offset:0
    ds_read_b64_tr_b16 v[118:119], v27 offset:4096
    v_xor_b32 v27, 192, v31
    ds_read_b64_tr_b16 v[120:121], v27 offset:0
    ds_read_b64_tr_b16 v[122:123], v27 offset:4096
    v_xor_b32 v27, 224, v31
    ds_read_b64_tr_b16 v[124:125], v27 offset:0
    ds_read_b64_tr_b16 v[126:127], v27 offset:4096
L_pgs:
    s_waitcnt vmcnt(5)
    v_cmpx_eq_u32 vcc, s65, v163
    v_perm_b32 v163, v162, v161, s59
    v_perm_b32 v163, v163, v160, s60
    v_pk_add_f32 v[32:33], v[48:49], v[160:161]
    v_pk_add_f32 v[34:35], v[66:67], v[162:163]
    s_waitcnt vmcnt(4)
    v_cmpx_eq_u32 vcc, s65, v167
    v_perm_b32 v167, v166, v165, s59
    v_perm_b32 v167, v167, v164, s60
    v_pk_add_f32 v[36:37], v[52:53], v[164:165]
    v_pk_add_f32 v[38:39], v[70:71], v[166:167]
    s_waitcnt vmcnt(3)
    v_cmpx_eq_u32 vcc, s65, v171
    v_perm_b32 v171, v170, v169, s59
    v_perm_b32 v171, v171, v168, s60
    v_pk_add_f32 v[32:33], v[32:33], v[168:169]
    v_pk_add_f32 v[34:35], v[34:35], v[170:171]
    s_waitcnt vmcnt(2)
    v_cmpx_eq_u32 vcc, s65, v175
    v_perm_b32 v175, v174, v173, s59
    v_perm_b32 v175, v175, v172, s60
    v_pk_add_f32 v[36:37], v[36:37], v[172:173]
    v_pk_add_f32 v[38:39], v[38:39], v[174:175]
    s_waitcnt vmcnt(1)
    v_cmpx_eq_u32 vcc, s65, v179
    v_perm_b32 v179, v178, v177, s59
    v_perm_b32 v179, v179, v176, s60
    v_pk_add_f32 v[32:33], v[32:33], v[176:177]
    v_pk_add_f32 v[34:35], v[34:35], v[178:179]
    s_waitcnt vmcnt(0)
    v_cmpx_eq_u32 vcc, s65, v183
    v_perm_b32 v183, v182, v181, s59
    v_perm_b32 v183, v183, v180, s60
    v_pk_add_f32 v[36:37], v[36:37], v[180:181]
    v_pk_add_f32 v[38:39], v[38:39], v[182:183]
    s_not_b64 vcc, exec
    s_mov_b64 exec, -1
    s_cbranch_scc1 L_pgr
L_pgd:
    v_mul_f32 v40, v32, v29
    v_mul_f32 v41, v33, v29
    v_mul_f32 v42, v36, v29
    v_mul_f32 v43, v37, v29
    v_pk_mul_f32 v[32:33], v[32:33], v[28:29] op_sel_hi:[1,0]
    v_pk_mul_f32 v[34:35], v[34:35], v[28:29] op_sel_hi:[1,0]
    v_pk_mul_f32 v[36:37], v[36:37], v[28:29] op_sel_hi:[1,0]
    v_pk_mul_f32 v[38:39], v[38:39], v[28:29] op_sel_hi:[1,0]
    v_exp_f32 v40, v40
    v_exp_f32 v41, v41
    v_exp_f32 v42, v42
    v_exp_f32 v43, v43
    v_pk_mul_f32 v[44:45], v[32:33], v[34:35]
    v_pk_mul_f32 v[46:47], v[36:37], v[38:39]
    v_pk_add_f32 v[40:41], v[40:41], 1.0 op_sel_hi:[1,0]
    v_pk_add_f32 v[42:43], v[42:43], 1.0 op_sel_hi:[1,0]
    v_rcp_f32 v40, v40
    v_rcp_f32 v41, v41
    v_rcp_f32 v42, v42
    v_rcp_f32 v43, v43
    s_nop 0
    v_pk_mul_f32 v[44:45], v[44:45], v[40:41]
    v_pk_mul_f32 v[46:47], v[46:47], v[42:43]
    v_cvt_pk_bf16_f32 v60, v44, v45
    v_cvt_pk_bf16_f32 v61, v46, v47
    v_cvt_pk_bf16_f32 v56, v44, v45
    v_cvt_pk_bf16_f32 v57, v46, v47
    v_cvt_pk_bf16_f32 v58, v44, v45
    v_cvt_pk_bf16_f32 v59, v46, v47
    v_mov_b32_dpp v56, v60 row_shr:8 row_mask:0xf bank_mask:0xc
    v_mov_b32_dpp v58, v60 row_shl:8 row_mask:0xf bank_mask:0x3
    v_mov_b32_dpp v57, v61 row_shr:8 row_mask:0xf bank_mask:0xc
    v_mov_b32_dpp v59, v61 row_shl:8 row_mask:0xf bank_mask:0x3
    s_waitcnt lgkmcnt(0)
    s_nop 0
    v_mfma_f32_16x16x32_bf16 v[192:195], v[96:99], v[56:59], 0
    v_mfma_f32_16x16x32_bf16 v[200:203], v[104:107], v[56:59], 0
    v_mfma_f32_16x16x32_bf16 v[208:211], v[112:115], v[56:59], 0
    v_mfma_f32_16x16x32_bf16 v[216:219], v[120:123], v[56:59], 0
    v_mfma_f32_16x16x32_bf16 v[196:199], v[100:103], v[56:59], 0
    v_mfma_f32_16x16x32_bf16 v[204:207], v[108:111], v[56:59], 0
    v_mfma_f32_16x16x32_bf16 v[212:215], v[116:119], v[56:59], 0
    v_mfma_f32_16x16x32_bf16 v[220:223], v[124:127], v[56:59], 0
    s_nop 1
    v_perm_b32 v224, v192, v195, s56
    v_perm_b32 v225, v193, v195, s57
    v_perm_b32 v226, v194, v195, s58
    v_perm_b32 v228, v200, v203, s56
    v_perm_b32 v229, v201, v203, s57
    v_perm_b32 v230, v202, v203, s58
    v_perm_b32 v232, v208, v211, s56
    v_perm_b32 v233, v209, v211, s57
    v_perm_b32 v234, v210, v211, s58
    v_perm_b32 v236, v216, v219, s56
    v_perm_b32 v237, v217, v219, s57
    v_perm_b32 v238, v218, v219, s58
    s_not_b64 exec, s[78:79]
    v_perm_b32 v224, v196, v199, s56
    v_perm_b32 v225, v197, v199, s57
    v_perm_b32 v226, v198, v199, s58
    v_perm_b32 v228, v204, v207, s56
    v_perm_b32 v229, v205, v207, s57
    v_perm_b32 v230, v206, v207, s58
    v_perm_b32 v232, v212, v215, s56
    v_perm_b32 v233, v213, v215, s57
    v_perm_b32 v234, v214, v215, s58
    v_perm_b32 v236, v220, v223, s56
    v_perm_b32 v237, v221, v223, s57
    v_perm_b32 v238, v222, v223, s58
    s_mov_b64 exec, -1
    buffer_store_dwordx4 v[224:227], v18, s[40:43], s54 offen offset:0 sc1
    buffer_store_dwordx4 v[228:231], v18, s[40:43], s54 offen offset:128 sc1
    buffer_store_dwordx4 v[232:235], v18, s[40:43], s55 offen offset:0 sc1
    buffer_store_dwordx4 v[236:239], v18, s[40:43], s55 offen offset:128 sc1
    s_mov_b64 exec, 0xffff
    buffer_atomic_swap v227, v11, s[40:43], s48 offen sc1
    s_mov_b64 exec, -1
L_cons:
    s_cmp_eq_u32 s47, 0
    s_cbranch_scc1 L_cons_done
    s_ff1_i32_b32 s73, s47
    s_bitset0_b32 s47, s73
    s_lshl_b32 s68, s73, 3
    s_add_u32 s68, s68, s27
    s_mul_i32 s52, s68, 14336
    s_add_u32 s52, s52, 16777216
    s_add_u32 s53, s52, 4096
    s_add_u32 s54, s52, 8192
    s_add_u32 s55, s52, 12288
    v_lshrrev_b32 v19, 3, v1
    v_and_b32 v5, 7, v1
    v_lshlrev_b32 v5, 2, v5
    v_lshl_add_u32 v19, v19, 7, v5
    s_lshl_b32 s46, s68, 10
    s_add_u32 s46, s46, 18350080
    s_mov_b32 s50, -1
    s_mov_b32 s51, 0xffffff
    v_ashrrev_i32 v4, 31, v79
    v_not_b32 v4, v4
    v_or_b32 v4, 0x80000000, v4
    v_xor_b32 v4, v4, v79
    v_and_b32 v4, s77, v4
    v_mul_f32 v4, 0xbfb8aa3b, v4
    v_exp_f32 v4, v4
    v_and_b32 v6, 15, v1
    v_add_f32 v4, 1.0, v4
    v_rcp_f32 v8, v4
    v_lshl_add_u32 v6, v6, 4, v2
    v_cvt_pk_bf16_f32 v4, v8, v8
    v_lshlrev_b32 v8, 16, v4
    s_mov_b32 s36, s20
    s_and_b32 s37, s21, 0xffff
    s_mov_b32 s38, 2097152
    s_mov_b32 s39, 0x00020000
    v_lshlrev_b32 v9, 3, v1
    v_readlane_b32 s49, v15, s73
    v_bfe_u32 v7, v1, 1, 3
    v_and_b32 v24, 1, v1
    s_and_b32 s56, s49, 63
    s_bfe_u32 s58, s56, 0x30001
    v_xor_b32 v7, s58, v7
    v_lshlrev_b32 v7, 4, v7
    v_lshl_add_u32 v7, v24, 3, v7
    s_and_b32 s58, s26, 3
    s_lshl_b32 s58, s58, 13
    s_lshl_b32 s57, s56, 7
    s_add_u32 s58, s58, s57
    v_add_u32 v7, s58, v7
    s_lshl_b32 s56, s56, 2
    v_add_u32 v24, s56, v2
    ds_read_b64 v[44:45], v7
    ds_read_b32 v26, v24 offset:1792
    ds_read_b32 v27, v24 offset:1536
    s_lshl_b32 s49, s49, 10
    s_lshl_b32 s56, s27, 7
    s_add_u32 s49, s49, s56
    s_waitcnt lgkmcnt(0)
    v_lshlrev_b32 v40, 16, v44
    v_and_b32 v41, s77, v44
    v_lshlrev_b32 v42, 16, v45
    v_and_b32 v43, s77, v45
    v_sub_f32 v44, v40, v27
    v_sub_f32 v45, v41, v27
    v_sub_f32 v46, v42, v27
    v_sub_f32 v47, v43, v27
    v_mul_f32 v44, v44, v26
    v_mul_f32 v45, v45, v26
    v_mul_f32 v46, v46, v26
    v_mul_f32 v47, v47, v26
    s_setprio 0
    s_mov_b32 s67, 0
W_44:
    ds_read_b64 v[4:5], v2 offset:0
    s_waitcnt lgkmcnt(0)
    v_min_u32 v4, v4, v5
    s_nop 0
    v_readfirstlane_b32 s68, v4
    s_cmp_ge_u32 s68, 11
    s_cbranch_scc1 D_45
    s_add_u32 s67, s67, 1
    s_cmp_lt_u32 s67, 4194304
    s_cbranch_scc1 W_44
D_45:
    s_mov_b32 s76, 0
    s_mov_b64 exec, s[50:51]
L_yfl:
    v_mov_b32 v5, 0
    buffer_atomic_or v5, v19, s[40:43], s46 offen sc0 sc1
L_yflw:
    s_add_u32 s76, s76, 1
    s_cmp_lt_u32 s76, 65536
    s_waitcnt vmcnt(0)
    v_cmpx_ne_u32 vcc, s65, v5
    s_cbranch_scc0 L_yfld
    s_cbranch_execnz L_yfl
L_yfld:
    s_mov_b64 exec, -1
L_ysel:
    buffer_load_dwordx4 v[128:131], v68, s[40:43], s52 offen offset:0 sc1
    buffer_load_dwordx4 v[132:135], v68, s[40:43], s52 offen offset:1024 sc1
    buffer_load_dwordx4 v[136:139], v68, s[40:43], s52 offen offset:2048 sc1
    buffer_load_dwordx4 v[140:143], v68, s[40:43], s52 offen offset:3072 sc1
    buffer_load_dwordx4 v[144:147], v68, s[40:43], s53 offen offset:0 sc1
    buffer_load_dwordx4 v[148:151], v68, s[40:43], s53 offen offset:1024 sc1
    buffer_load_dwordx4 v[152:155], v68, s[40:43], s53 offen offset:2048 sc1
    buffer_load_dwordx4 v[156:159], v68, s[40:43], s53 offen offset:3072 sc1
    buffer_load_dwordx4 v[160:163], v68, s[40:43], s54 offen offset:0 sc1
    buffer_load_dwordx4 v[164:167], v68, s[40:43], s54 offen offset:1024 sc1
    buffer_load_dwordx4 v[168:171], v68, s[40:43], s54 offen offset:2048 sc1
    buffer_load_dwordx4 v[172:175], v68, s[40:43], s54 offen offset:3072 sc1
    buffer_load_dwordx4 v[176:179], v68, s[40:43], s55 offen offset:0 sc1
    buffer_load_dwordx4 v[180:183], v68, s[40:43], s55 offen offset:1024 sc1
    s_cmp_lg_u32 s47, 0
    s_cbranch_scc1 L_two
    v_readlane_b32 s57, v8, s73
    s_mov_b32 s76, 0
L_ys0:
    s_waitcnt vmcnt(13)
    v_cmpx_eq_u32 vcc, s65, v131
    v_perm_b32 v131, v130, v129, s59
    v_perm_b32 v131, v131, v128, s60
    s_waitcnt vmcnt(12)
    v_cmpx_eq_u32 vcc, s65, v135
    v_perm_b32 v135, v134, v133, s59
    v_perm_b32 v135, v135, v132, s60
    v_pk_add_f32 v[32:33], v[128:129], v[132:133]
    v_pk_add_f32 v[34:35], v[130:131], v[134:135]
    s_waitcnt vmcnt(11)
    v_cmpx_eq_u32 vcc, s65, v139
    v_perm_b32 v139, v138, v137, s59
    v_perm_b32 v139, v139, v136, s60
    v_pk_add_f32 v[32:33], v[32:33], v[136:137]
    v_pk_add_f32 v[34:35], v[34:35], v[138:139]
    s_waitcnt vmcnt(10)
    v_cmpx_eq_u32 vcc, s65, v143
    v_perm_b32 v143, v142, v141, s59
    v_perm_b32 v143, v143, v140, s60
    v_pk_add_f32 v[32:33], v[32:33], v[140:141]
    v_pk_add_f32 v[34:35], v[34:35], v[142:143]
    s_waitcnt vmcnt(9)
    v_cmpx_eq_u32 vcc, s65, v147
    v_perm_b32 v147, v146, v145, s59
    v_perm_b32 v147, v147, v144, s60
    v_pk_add_f32 v[32:33], v[32:33], v[144:145]
    v_pk_add_f32 v[34:35], v[34:35], v[146:147]
    s_waitcnt vmcnt(8)
    v_cmpx_eq_u32 vcc, s65, v151
    v_perm_b32 v151, v150, v149, s59
    v_perm_b32 v151, v151, v148, s60
    v_pk_add_f32 v[32:33], v[32:33], v[148:149]
    v_pk_add_f32 v[34:35], v[34:35], v[150:151]
    s_waitcnt vmcnt(7)
    v_cmpx_eq_u32 vcc, s65, v155
    v_perm_b32 v155, v154, v153, s59
    v_perm_b32 v155, v155, v152, s60
    v_pk_add_f32 v[32:33], v[32:33], v[152:153]
    v_pk_add_f32 v[34:35], v[34:35], v[154:155]
    s_waitcnt vmcnt(6)
    v_cmpx_eq_u32 vcc, s65, v159
    v_perm_b32 v159, v158, v157, s59
    v_perm_b32 v159, v159, v156, s60
    v_pk_add_f32 v[32:33], v[32:33], v[156:157]
    v_pk_add_f32 v[34:35], v[34:35], v[158:159]
    s_waitcnt vmcnt(5)
    v_cmpx_eq_u32 vcc, s65, v163
    v_perm_b32 v163, v162, v161, s59
    v_perm_b32 v163, v163, v160, s60
    v_pk_add_f32 v[32:33], v[32:33], v[160:161]
    v_pk_add_f32 v[34:35], v[34:35], v[162:163]
    s_waitcnt vmcnt(4)
    v_cmpx_eq_u32 vcc, s65, v167
    v_perm_b32 v167, v166, v165, s59
    v_perm_b32 v167, v167, v164, s60
    v_pk_add_f32 v[32:33], v[32:33], v[164:165]
    v_pk_add_f32 v[34:35], v[34:35], v[166:167]
    s_waitcnt vmcnt(3)
    v_cmpx_eq_u32 vcc, s65, v171
    v_perm_b32 v171, v170, v169, s59
    v_perm_b32 v171, v171, v168, s60
    v_pk_add_f32 v[32:33], v[32:33], v[168:169]
    v_pk_add_f32 v[34:35], v[34:35], v[170:171]
    s_waitcnt vmcnt(2)
    v_cmpx_eq_u32 vcc, s65, v175
    v_perm_b32 v175, v174, v173, s59
    v_perm_b32 v175, v175, v172, s60
    v_pk_add_f32 v[32:33], v[32:33], v[172:173]
    v_pk_add_f32 v[34:35], v[34:35], v[174:175]
    s_waitcnt vmcnt(1)
    v_cmpx_eq_u32 vcc, s65, v179
    v_perm_b32 v179, v178, v177, s59
    v_perm_b32 v179, v179, v176, s60
    v_pk_add_f32 v[32:33], v[32:33], v[176:177]
    v_pk_add_f32 v[34:35], v[34:35], v[178:179]
    s_waitcnt vmcnt(0)
    v_cmpx_eq_u32 vcc, s65, v183
    v_perm_b32 v183, v182, v181, s59
    v_perm_b32 v183, v183, v180, s60
    v_pk_add_f32 v[32:33], v[32:33], v[180:181]
    v_pk_add_f32 v[34:35], v[34:35], v[182:183]
    s_not_b64 vcc, exec
    s_mov_b64 exec, -1
    s_cbranch_scc1 L_ys0r
L_ys0d:
    v_mov_b32 v36, v32
    v_mov_b32 v37, v33
    v_mov_b32 v38, v34
    v_mov_b32 v39, v35
    v_permlane32_swap_b32 v36, v32
    v_permlane32_swap_b32 v37, v33
    v_permlane32_swap_b32 v38, v34
    v_permlane32_swap_b32 v39, v35
    v_pk_add_f32 v[32:33], v[32:33], v[36:37]
    v_pk_add_f32 v[34:35], v[34:35], v[38:39]
    v_mov_b32 v36, v32
    v_mov_b32 v37, v33
    v_mov_b32 v38, v34
    v_mov_b32 v39, v35
    v_permlane16_swap_b32 v36, v32
    v_permlane16_swap_b32 v37, v33
    v_permlane16_swap_b32 v38, v34
    v_permlane16_swap_b32 v39, v35
    v_pk_add_f32 v[32:33], v[32:33], v[36:37]
    v_pk_add_f32 v[34:35], v[34:35], v[38:39]
    v_fmac_f32 v44, s57, v32
    v_fmac_f32 v45, s57, v33
    v_fmac_f32 v46, s57, v34
    v_fmac_f32 v47, s57, v35
    v_mul_f32 v32, 0xbfb8aa3b, v44
    v_mul_f32 v33, 0xbfb8aa3b, v45
    v_mul_f32 v34, 0xbfb8aa3b, v46
    v_mul_f32 v35, 0xbfb8aa3b, v47
    v_exp_f32 v32, v32
    v_exp_f32 v33, v33
    v_exp_f32 v34, v34
    v_exp_f32 v35, v35
    v_add_f32 v32, 1.0, v32
    v_add_f32 v33, 1.0, v33
    v_add_f32 v34, 1.0, v34
    v_add_f32 v35, 1.0, v35
    v_rcp_f32 v32, v32
    v_rcp_f32 v33, v33
    v_rcp_f32 v34, v34
    v_rcp_f32 v35, v35
    v_mul_f32 v44, v44, v32
    v_mul_f32 v45, v45, v33
    v_mul_f32 v46, v46, v34
    v_mul_f32 v47, v47, v35
    s_setprio 0
    s_lshl_b32 s58, s73, 8
    v_add_u32 v7, s58, v6
    s_lshl_b32 s58, s73, 2
    v_add_u32 v24, s58, v2
    s_mov_b32 s76, 0
    s_mov_b64 exec, 1
L_yf1:
    ds_read_b32 v25, v24 offset:128
    s_add_u32 s76, s76, 1
    s_waitcnt lgkmcnt(0)
    v_readfirstlane_b32 s58, v25
    s_cmp_ge_u32 s58, 4
    s_cbranch_scc1 L_yf1d
    s_cmp_lt_u32 s76, 4194304
    s_cbranch_scc1 L_yf1
L_yf1d:
    s_mov_b64 exec, -1
    ds_read_b128 v[32:35], v7 offset:12288
    s_waitcnt lgkmcnt(0)
    v_fmac_f32 v40, v44, v32
    v_fmac_f32 v41, v45, v33
    v_fmac_f32 v42, v46, v34
    v_fmac_f32 v43, v47, v35
    v_cvt_pk_bf16_f32 v40, v40, v41
    v_cvt_pk_bf16_f32 v41, v42, v43
    s_mov_b64 exec, 0xffff
    buffer_store_dwordx2 v[40:41], v9, s[36:39], s49 offen
    s_mov_b64 exec, -1
L_cut:
L_cons_done:
    s_waitcnt lgkmcnt(0)
    s_endpgm
L_two:
    s_ff1_i32_b32 s75, s47
    s_bitset0_b32 s47, s75
    s_lshl_b32 s68, s75, 3
    s_add_u32 s68, s68, s27
    s_mul_i32 s61, s68, 14336
    s_add_u32 s61, s61, 16777216
    s_add_u32 s62, s61, 4096
    s_add_u32 s63, s61, 8192
    s_add_u32 s45, s61, 12288
    buffer_load_dwordx4 v[184:187], v68, s[40:43], s61 offen offset:0 sc1
    buffer_load_dwordx4 v[188:191], v68, s[40:43], s61 offen offset:1024 sc1
    buffer_load_dwordx4 v[192:195], v68, s[40:43], s61 offen offset:2048 sc1
    buffer_load_dwordx4 v[196:199], v68, s[40:43], s61 offen offset:3072 sc1
    buffer_load_dwordx4 v[200:203], v68, s[40:43], s62 offen offset:0 sc1
    buffer_load_dwordx4 v[204:207], v68, s[40:43], s62 offen offset:1024 sc1
    buffer_load_dwordx4 v[208:211], v68, s[40:43], s62 offen offset:2048 sc1
    buffer_load_dwordx4 v[212:215], v68, s[40:43], s62 offen offset:3072 sc1
    buffer_load_dwordx4 v[216:219], v68, s[40:43], s63 offen offset:0 sc1
    buffer_load_dwordx4 v[220:223], v68, s[40:43], s63 offen offset:1024 sc1
    buffer_load_dwordx4 v[224:227], v68, s[40:43], s63 offen offset:2048 sc1
    buffer_load_dwordx4 v[228:231], v68, s[40:43], s63 offen offset:3072 sc1
    buffer_load_dwordx4 v[232:235], v68, s[40:43], s45 offen offset:0 sc1
    buffer_load_dwordx4 v[236:239], v68, s[40:43], s45 offen offset:1024 sc1
    v_readlane_b32 s44, v15, s75
    v_bfe_u32 v7, v1, 1, 3
    v_and_b32 v24, 1, v1
    s_and_b32 s56, s44, 63
    s_bfe_u32 s58, s56, 0x30001
    v_xor_b32 v7, s58, v7
    v_lshlrev_b32 v7, 4, v7
    v_lshl_add_u32 v7, v24, 3, v7
    s_and_b32 s58, s26, 3
    s_lshl_b32 s58, s58, 13
    s_lshl_b32 s57, s56, 7
    s_add_u32 s58, s58, s57
    v_add_u32 v7, s58, v7
    s_lshl_b32 s56, s56, 2
    v_add_u32 v24, s56, v2
    ds_read_b64 v[52:53], v7
    ds_read_b32 v26, v24 offset:1792
    ds_read_b32 v27, v24 offset:1536
    s_lshl_b32 s44, s44, 10
    s_lshl_b32 s56, s27, 7
    s_add_u32 s44, s44, s56
    s_waitcnt lgkmcnt(0)
    v_lshlrev_b32 v48, 16, v52
    v_and_b32 v49, s77, v52
    v_lshlrev_b32 v50, 16, v53
    v_and_b32 v51, s77, v53
    v_sub_f32 v52, v48, v27
    v_sub_f32 v53, v49, v27
    v_sub_f32 v54, v50, v27
    v_sub_f32 v55, v51, v27
    v_mul_f32 v52, v52, v26
    v_mul_f32 v53, v53, v26
    v_mul_f32 v54, v54, v26
    v_mul_f32 v55, v55, v26
    v_readlane_b32 s57, v8, s73
    s_mov_b32 s76, 0
L_ys2:
    s_waitcnt vmcnt(27)
    v_cmpx_eq_u32 vcc, s65, v131
    v_perm_b32 v131, v130, v129, s59
    v_perm_b32 v131, v131, v128, s60
    s_waitcnt vmcnt(26)
    v_cmpx_eq_u32 vcc, s65, v135
    v_perm_b32 v135, v134, v133, s59
    v_perm_b32 v135, v135, v132, s60
    v_pk_add_f32 v[32:33], v[128:129], v[132:133]
    v_pk_add_f32 v[34:35], v[130:131], v[134:135]
    s_waitcnt vmcnt(25)
    v_cmpx_eq_u32 vcc, s65, v139
    v_perm_b32 v139, v138, v137, s59
    v_perm_b32 v139, v139, v136, s60
    v_pk_add_f32 v[32:33], v[32:33], v[136:137]
    v_pk_add_f32 v[34:35], v[34:35], v[138:139]
    s_waitcnt vmcnt(24)
    v_cmpx_eq_u32 vcc, s65, v143
    v_perm_b32 v143, v142, v141, s59
    v_perm_b32 v143, v143, v140, s60
    v_pk_add_f32 v[32:33], v[32:33], v[140:141]
    v_pk_add_f32 v[34:35], v[34:35], v[142:143]
    s_waitcnt vmcnt(23)
    v_cmpx_eq_u32 vcc, s65, v147
    v_perm_b32 v147, v146, v145, s59
    v_perm_b32 v147, v147, v144, s60
    v_pk_add_f32 v[32:33], v[32:33], v[144:145]
    v_pk_add_f32 v[34:35], v[34:35], v[146:147]
    s_waitcnt vmcnt(22)
    v_cmpx_eq_u32 vcc, s65, v151
    v_perm_b32 v151, v150, v149, s59
    v_perm_b32 v151, v151, v148, s60
    v_pk_add_f32 v[32:33], v[32:33], v[148:149]
    v_pk_add_f32 v[34:35], v[34:35], v[150:151]
    s_waitcnt vmcnt(21)
    v_cmpx_eq_u32 vcc, s65, v155
    v_perm_b32 v155, v154, v153, s59
    v_perm_b32 v155, v155, v152, s60
    v_pk_add_f32 v[32:33], v[32:33], v[152:153]
    v_pk_add_f32 v[34:35], v[34:35], v[154:155]
    s_waitcnt vmcnt(20)
    v_cmpx_eq_u32 vcc, s65, v159
    v_perm_b32 v159, v158, v157, s59
    v_perm_b32 v159, v159, v156, s60
    v_pk_add_f32 v[32:33], v[32:33], v[156:157]
    v_pk_add_f32 v[34:35], v[34:35], v[158:159]
    s_waitcnt vmcnt(19)
    v_cmpx_eq_u32 vcc, s65, v163
    v_perm_b32 v163, v162, v161, s59
    v_perm_b32 v163, v163, v160, s60
    v_pk_add_f32 v[32:33], v[32:33], v[160:161]
    v_pk_add_f32 v[34:35], v[34:35], v[162:163]
    s_waitcnt vmcnt(18)
    v_cmpx_eq_u32 vcc, s65, v167
    v_perm_b32 v167, v166, v165, s59
    v_perm_b32 v167, v167, v164, s60
    v_pk_add_f32 v[32:33], v[32:33], v[164:165]
    v_pk_add_f32 v[34:35], v[34:35], v[166:167]
    s_waitcnt vmcnt(17)
    v_cmpx_eq_u32 vcc, s65, v171
    v_perm_b32 v171, v170, v169, s59
    v_perm_b32 v171, v171, v168, s60
    v_pk_add_f32 v[32:33], v[32:33], v[168:169]
    v_pk_add_f32 v[34:35], v[34:35], v[170:171]
    s_waitcnt vmcnt(16)
    v_cmpx_eq_u32 vcc, s65, v175
    v_perm_b32 v175, v174, v173, s59
    v_perm_b32 v175, v175, v172, s60
    v_pk_add_f32 v[32:33], v[32:33], v[172:173]
    v_pk_add_f32 v[34:35], v[34:35], v[174:175]
    s_waitcnt vmcnt(15)
    v_cmpx_eq_u32 vcc, s65, v179
    v_perm_b32 v179, v178, v177, s59
    v_perm_b32 v179, v179, v176, s60
    v_pk_add_f32 v[32:33], v[32:33], v[176:177]
    v_pk_add_f32 v[34:35], v[34:35], v[178:179]
    s_waitcnt vmcnt(14)
    v_cmpx_eq_u32 vcc, s65, v183
    v_perm_b32 v183, v182, v181, s59
    v_perm_b32 v183, v183, v180, s60
    v_pk_add_f32 v[32:33], v[32:33], v[180:181]
    v_pk_add_f32 v[34:35], v[34:35], v[182:183]
    s_not_b64 vcc, exec
    s_mov_b64 exec, -1
    s_cbranch_scc1 L_ys2r
L_ys2d:
    v_mov_b32 v36, v32
    v_mov_b32 v37, v33
    v_mov_b32 v38, v34
    v_mov_b32 v39, v35
    v_permlane32_swap_b32 v36, v32
    v_permlane32_swap_b32 v37, v33
    v_permlane32_swap_b32 v38, v34
    v_permlane32_swap_b32 v39, v35
    v_pk_add_f32 v[32:33], v[32:33], v[36:37]
    v_pk_add_f32 v[34:35], v[34:35], v[38:39]
    v_mov_b32 v36, v32
    v_mov_b32 v37, v33
    v_mov_b32 v38, v34
    v_mov_b32 v39, v35
    v_permlane16_swap_b32 v36, v32
    v_permlane16_swap_b32 v37, v33
    v_permlane16_swap_b32 v38, v34
    v_permlane16_swap_b32 v39, v35
    v_pk_add_f32 v[32:33], v[32:33], v[36:37]
    v_pk_add_f32 v[34:35], v[34:35], v[38:39]
    v_fmac_f32 v44, s57, v32
    v_fmac_f32 v45, s57, v33
    v_fmac_f32 v46, s57, v34
    v_fmac_f32 v47, s57, v35
    v_mul_f32 v32, 0xbfb8aa3b, v44
    v_mul_f32 v33, 0xbfb8aa3b, v45
    v_mul_f32 v34, 0xbfb8aa3b, v46
    v_mul_f32 v35, 0xbfb8aa3b, v47
    v_exp_f32 v32, v32
    v_exp_f32 v33, v33
    v_exp_f32 v34, v34
    v_exp_f32 v35, v35
    v_add_f32 v32, 1.0, v32
    v_add_f32 v33, 1.0, v33
    v_add_f32 v34, 1.0, v34
    v_add_f32 v35, 1.0, v35
    v_rcp_f32 v32, v32
    v_rcp_f32 v33, v33
    v_rcp_f32 v34, v34
    v_rcp_f32 v35, v35
    v_mul_f32 v44, v44, v32
    v_mul_f32 v45, v45, v33
    v_mul_f32 v46, v46, v34
    v_mul_f32 v47, v47, v35
    v_readlane_b32 s57, v8, s75
    s_mov_b32 s76, 0
L_ys3:
    s_waitcnt vmcnt(13)
    v_cmpx_eq_u32 vcc, s65, v187
    v_perm_b32 v187, v186, v185, s59
    v_perm_b32 v187, v187, v184, s60
    s_waitcnt vmcnt(12)
    v_cmpx_eq_u32 vcc, s65, v191
    v_perm_b32 v191, v190, v189, s59
    v_perm_b32 v191, v191, v188, s60
    v_pk_add_f32 v[32:33], v[184:185], v[188:189]
    v_pk_add_f32 v[34:35], v[186:187], v[190:191]
    s_waitcnt vmcnt(11)
    v_cmpx_eq_u32 vcc, s65, v195
    v_perm_b32 v195, v194, v193, s59
    v_perm_b32 v195, v195, v192, s60
    v_pk_add_f32 v[32:33], v[32:33], v[192:193]
    v_pk_add_f32 v[34:35], v[34:35], v[194:195]
    s_waitcnt vmcnt(10)
    v_cmpx_eq_u32 vcc, s65, v199
    v_perm_b32 v199, v198, v197, s59
    v_perm_b32 v199, v199, v196, s60
    v_pk_add_f32 v[32:33], v[32:33], v[196:197]
    v_pk_add_f32 v[34:35], v[34:35], v[198:199]
    s_waitcnt vmcnt(9)
    v_cmpx_eq_u32 vcc, s65, v203
    v_perm_b32 v203, v202, v201, s59
    v_perm_b32 v203, v203, v200, s60
    v_pk_add_f32 v[32:33], v[32:33], v[200:201]
    v_pk_add_f32 v[34:35], v[34:35], v[202:203]
    s_waitcnt vmcnt(8)
    v_cmpx_eq_u32 vcc, s65, v207
    v_perm_b32 v207, v206, v205, s59
    v_perm_b32 v207, v207, v204, s60
    v_pk_add_f32 v[32:33], v[32:33], v[204:205]
    v_pk_add_f32 v[34:35], v[34:35], v[206:207]
    s_waitcnt vmcnt(7)
    v_cmpx_eq_u32 vcc, s65, v211
    v_perm_b32 v211, v210, v209, s59
    v_perm_b32 v211, v211, v208, s60
    v_pk_add_f32 v[32:33], v[32:33], v[208:209]
    v_pk_add_f32 v[34:35], v[34:35], v[210:211]
    s_waitcnt vmcnt(6)
    v_cmpx_eq_u32 vcc, s65, v215
    v_perm_b32 v215, v214, v213, s59
    v_perm_b32 v215, v215, v212, s60
    v_pk_add_f32 v[32:33], v[32:33], v[212:213]
    v_pk_add_f32 v[34:35], v[34:35], v[214:215]
    s_waitcnt vmcnt(5)
    v_cmpx_eq_u32 vcc, s65, v219
    v_perm_b32 v219, v218, v217, s59
    v_perm_b32 v219, v219, v216, s60
    v_pk_add_f32 v[32:33], v[32:33], v[216:217]
    v_pk_add_f32 v[34:35], v[34:35], v[218:219]
    s_waitcnt vmcnt(4)
    v_cmpx_eq_u32 vcc, s65, v223
    v_perm_b32 v223, v222, v221, s59
    v_perm_b32 v223, v223, v220, s60
    v_pk_add_f32 v[32:33], v[32:33], v[220:221]
    v_pk_add_f32 v[34:35], v[34:35], v[222:223]
    s_waitcnt vmcnt(3)
    v_cmpx_eq_u32 vcc, s65, v227
    v_perm_b32 v227, v226, v225, s59
    v_perm_b32 v227, v227, v224, s60
    v_pk_add_f32 v[32:33], v[32:33], v[224:225]
    v_pk_add_f32 v[34:35], v[34:35], v[226:227]
    s_waitcnt vmcnt(2)
    v_cmpx_eq_u32 vcc, s65, v231
    v_perm_b32 v231, v230, v229, s59
    v_perm_b32 v231, v231, v228, s60
    v_pk_add_f32 v[32:33], v[32:33], v[228:229]
    v_pk_add_f32 v[34:35], v[34:35], v[230:231]
    s_waitcnt vmcnt(1)
    v_cmpx_eq_u32 vcc, s65, v235
    v_perm_b32 v235, v234, v233, s59
    v_perm_b32 v235, v235, v232, s60
    v_pk_add_f32 v[32:33], v[32:33], v[232:233]
    v_pk_add_f32 v[34:35], v[34:35], v[234:235]
    s_waitcnt vmcnt(0)
    v_cmpx_eq_u32 vcc, s65, v239
    v_perm_b32 v239, v238, v237, s59
    v_perm_b32 v239, v239, v236, s60
    v_pk_add_f32 v[32:33], v[32:33], v[236:237]
    v_pk_add_f32 v[34:35], v[34:35], v[238:239]
    s_not_b64 vcc, exec
    s_mov_b64 exec, -1
    s_cbranch_scc1 L_ys3r
L_ys3d:
    v_mov_b32 v36, v32
    v_mov_b32 v37, v33
    v_mov_b32 v38, v34
    v_mov_b32 v39, v35
    v_permlane32_swap_b32 v36, v32
    v_permlane32_swap_b32 v37, v33
    v_permlane32_swap_b32 v38, v34
    v_permlane32_swap_b32 v39, v35
    v_pk_add_f32 v[32:33], v[32:33], v[36:37]
    v_pk_add_f32 v[34:35], v[34:35], v[38:39]
    v_mov_b32 v36, v32
    v_mov_b32 v37, v33
    v_mov_b32 v38, v34
    v_mov_b32 v39, v35
    v_permlane16_swap_b32 v36, v32
    v_permlane16_swap_b32 v37, v33
    v_permlane16_swap_b32 v38, v34
    v_permlane16_swap_b32 v39, v35
    v_pk_add_f32 v[32:33], v[32:33], v[36:37]
    v_pk_add_f32 v[34:35], v[34:35], v[38:39]
    v_fmac_f32 v52, s57, v32
    v_fmac_f32 v53, s57, v33
    v_fmac_f32 v54, s57, v34
    v_fmac_f32 v55, s57, v35
    v_mul_f32 v32, 0xbfb8aa3b, v52
    v_mul_f32 v33, 0xbfb8aa3b, v53
    v_mul_f32 v34, 0xbfb8aa3b, v54
    v_mul_f32 v35, 0xbfb8aa3b, v55
    v_exp_f32 v32, v32
    v_exp_f32 v33, v33
    v_exp_f32 v34, v34
    v_exp_f32 v35, v35
    v_add_f32 v32, 1.0, v32
    v_add_f32 v33, 1.0, v33
    v_add_f32 v34, 1.0, v34
    v_add_f32 v35, 1.0, v35
    v_rcp_f32 v32, v32
    v_rcp_f32 v33, v33
    v_rcp_f32 v34, v34
    v_rcp_f32 v35, v35
    v_mul_f32 v52, v52, v32
    v_mul_f32 v53, v53, v33
    v_mul_f32 v54, v54, v34
    v_mul_f32 v55, v55, v35
    s_setprio 0
    s_lshl_b32 s58, s73, 8
    v_add_u32 v7, s58, v6
    s_lshl_b32 s58, s73, 2
    v_add_u32 v24, s58, v2
    s_mov_b32 s76, 0
    s_mov_b64 exec, 1
L_yf4:
    ds_read_b32 v25, v24 offset:128
    s_add_u32 s76, s76, 1
    s_waitcnt lgkmcnt(0)
    v_readfirstlane_b32 s58, v25
    s_cmp_ge_u32 s58, 4
    s_cbranch_scc1 L_yf4d
    s_cmp_lt_u32 s76, 4194304
    s_cbranch_scc1 L_yf4
L_yf4d:
    s_mov_b64 exec, -1
    ds_read_b128 v[32:35], v7 offset:12288
    s_waitcnt lgkmcnt(0)
    v_fmac_f32 v40, v44, v32
    v_fmac_f32 v41, v45, v33
    v_fmac_f32 v42, v46, v34
    v_fmac_f32 v43, v47, v35
    v_cvt_pk_bf16_f32 v40, v40, v41
    v_cvt_pk_bf16_f32 v41, v42, v43
    s_mov_b64 exec, 0xffff
    buffer_store_dwordx2 v[40:41], v9, s[36:39], s49 offen
    s_mov_b64 exec, -1
    s_lshl_b32 s58, s75, 8
    v_add_u32 v7, s58, v6
    s_lshl_b32 s58, s75, 2
    v_add_u32 v24, s58, v2
    s_mov_b32 s76, 0
    s_mov_b64 exec, 1
L_yf5:
    ds_read_b32 v25, v24 offset:128
    s_add_u32 s76, s76, 1
    s_waitcnt lgkmcnt(0)
    v_readfirstlane_b32 s58, v25
    s_cmp_ge_u32 s58, 4
    s_cbranch_scc1 L_yf5d
    s_cmp_lt_u32 s76, 4194304
    s_cbranch_scc1 L_yf5
L_yf5d:
    s_mov_b64 exec, -1
    ds_read_b128 v[32:35], v7 offset:12288
    s_waitcnt lgkmcnt(0)
    v_fmac_f32 v48, v52, v32
    v_fmac_f32 v49, v53, v33
    v_fmac_f32 v50, v54, v34
    v_fmac_f32 v51, v55, v35
    v_cvt_pk_bf16_f32 v48, v48, v49
    v_cvt_pk_bf16_f32 v49, v50, v51
    s_mov_b64 exec, 0xffff
    buffer_store_dwordx2 v[48:49], v9, s[36:39], s44 offen
    s_mov_b64 exec, -1
    s_cmp_eq_u32 s47, 0
    s_cbranch_scc1 L_cut
    s_ff1_i32_b32 s73, s47
    s_bitset0_b32 s47, s73
    s_lshl_b32 s68, s73, 3
    s_add_u32 s68, s68, s27
    s_mul_i32 s52, s68, 14336
    s_add_u32 s52, s52, 16777216
    s_add_u32 s53, s52, 4096
    s_add_u32 s54, s52, 8192
    s_add_u32 s55, s52, 12288
    s_nop 3
    v_readlane_b32 s49, v15, s73
    v_bfe_u32 v7, v1, 1, 3
    v_and_b32 v24, 1, v1
    s_and_b32 s56, s49, 63
    s_bfe_u32 s58, s56, 0x30001
    v_xor_b32 v7, s58, v7
    v_lshlrev_b32 v7, 4, v7
    v_lshl_add_u32 v7, v24, 3, v7
    s_and_b32 s58, s26, 3
    s_lshl_b32 s58, s58, 13
    s_lshl_b32 s57, s56, 7
    s_add_u32 s58, s58, s57
    v_add_u32 v7, s58, v7
    s_lshl_b32 s56, s56, 2
    v_add_u32 v24, s56, v2
    ds_read_b64 v[44:45], v7
    ds_read_b32 v26, v24 offset:1792
    ds_read_b32 v27, v24 offset:1536
    s_lshl_b32 s49, s49, 10
    s_lshl_b32 s56, s27, 7
    s_add_u32 s49, s49, s56
    s_waitcnt lgkmcnt(0)
    v_lshlrev_b32 v40, 16, v44
    v_and_b32 v41, s77, v44
    v_lshlrev_b32 v42, 16, v45
    v_and_b32 v43, s77, v45
    v_sub_f32 v44, v40, v27
    v_sub_f32 v45, v41, v27
    v_sub_f32 v46, v42, v27
    v_sub_f32 v47, v43, v27
    v_mul_f32 v44, v44, v26
    v_mul_f32 v45, v45, v26
    v_mul_f32 v46, v46, v26
    v_mul_f32 v47, v47, v26
    s_branch L_ysel
L_rgslow:
    s_mov_b32 s60, 4096
    s_mov_b32 s61, 8192
    s_mov_b32 s76, 0
    s_branch L_rgc
L_rgp:
    s_bitcmp1_b32 s72, 0
    s_cbranch_scc0 L_rgs0
    buffer_load_dwordx4 v[96:99], v68, s[40:43], s60 offen offset:0 sc1
L_rgs0:
    s_bitcmp1_b32 s72, 1
    s_cbranch_scc0 L_rgs1
    buffer_load_dwordx4 v[100:103], v68, s[40:43], s60 offen offset:1024 sc1
L_rgs1:
    s_bitcmp1_b32 s72, 2
    s_cbranch_scc0 L_rgs2
    buffer_load_dwordx4 v[104:107], v68, s[40:43], s60 offen offset:2048 sc1
L_rgs2:
    s_bitcmp1_b32 s72, 3
    s_cbranch_scc0 L_rgs3
    buffer_load_dwordx4 v[108:111], v68, s[40:43], s60 offen offset:3072 sc1
L_rgs3:
    s_bitcmp1_b32 s72, 4
    s_cbranch_scc0 L_rgs4
    buffer_load_dwordx4 v[112:115], v68, s[40:43], s61 offen offset:0 sc1
L_rgs4:
    s_bitcmp1_b32 s72, 5
    s_cbranch_scc0 L_rgs5
    buffer_load_dwordx4 v[116:119], v68, s[40:43], s61 offen offset:1024 sc1
L_rgs5:
    s_bitcmp1_b32 s72, 6
    s_cbranch_scc0 L_rgs6
    buffer_load_dwordx4 v[120:123], v68, s[40:43], s61 offen offset:2048 sc1
L_rgs6:
    s_bitcmp1_b32 s72, 7
    s_cbranch_scc0 L_rgs7
    buffer_load_dwordx4 v[124:127], v68, s[40:43], s61 offen offset:3072 sc1
L_rgs7:
    s_waitcnt vmcnt(0)
L_rgc:
    s_mov_b32 s72, 0
    v_cmp_ne_u32 vcc, s65, v97
    v_cmp_ne_u32 s[62:63], s65, v99
    s_or_b64 vcc, vcc, s[62:63]
    s_cselect_b32 s68, 1, 0
    s_or_b32 s72, s72, s68
    v_cmp_ne_u32 vcc, s65, v101
    v_cmp_ne_u32 s[62:63], s65, v103
    s_or_b64 vcc, vcc, s[62:63]
    s_cselect_b32 s68, 2, 0
    s_or_b32 s72, s72, s68
    v_cmp_ne_u32 vcc, s65, v105
    v_cmp_ne_u32 s[62:63], s65, v107
    s_or_b64 vcc, vcc, s[62:63]
    s_cselect_b32 s68, 4, 0
    s_or_b32 s72, s72, s68
    v_cmp_ne_u32 vcc, s65, v109
    v_cmp_ne_u32 s[62:63], s65, v111
    s_or_b64 vcc, vcc, s[62:63]
    s_cselect_b32 s68, 8, 0
    s_or_b32 s72, s72, s68
    v_cmp_ne_u32 vcc, s65, v113
    v_cmp_ne_u32 s[62:63], s65, v115
    s_or_b64 vcc, vcc, s[62:63]
    s_cselect_b32 s68, 16, 0
    s_or_b32 s72, s72, s68
    v_cmp_ne_u32 vcc, s65, v117
    v_cmp_ne_u32 s[62:63], s65, v119
    s_or_b64 vcc, vcc, s[62:63]
    s_cselect_b32 s68, 32, 0
    s_or_b32 s72, s72, s68
    v_cmp_ne_u32 vcc, s65, v121
    v_cmp_ne_u32 s[62:63], s65, v123
    s_or_b64 vcc, vcc, s[62:63]
    s_cselect_b32 s68, 64, 0
    s_or_b32 s72, s72, s68
    v_cmp_ne_u32 vcc, s65, v125
    v_cmp_ne_u32 s[62:63], s65, v127
    s_or_b64 vcc, vcc, s[62:63]
    s_cselect_b32 s68, 128, 0
    s_or_b32 s72, s72, s68
    s_cmp_eq_u32 s72, 0
    s_cbranch_scc1 L_rgd
    s_add_u32 s76, s76, 1
    s_cmp_lt_u32 s76, 65536
    s_cbranch_scc1 L_rgp
L_rgd:
    s_mov_b32 s62, 0x01010101
    s_mov_b32 s63, 0x01010101
    v_lshl_or_b32 v160, v96, 16, 0
    v_and_or_b32 v161, v96, s77, 1
    v_lshl_or_b32 v162, v98, 16, 2
    v_max3_u32 v76, v160, v161, v162
    v_med3_u32 v77, v160, v161, v162
    v_min3_u32 v78, v160, v161, v162
    v_and_or_b32 v163, v98, s77, 3
    v_med3_u32 v78, v77, v78, v163
    v_med3_u32 v77, v76, v77, v163
    v_max_u32 v76, v76, v163
    v_lshl_or_b32 v164, v100, 16, 4
    v_med3_u32 v78, v77, v78, v164
    v_med3_u32 v77, v76, v77, v164
    v_max_u32 v76, v76, v164
    v_and_or_b32 v165, v100, s77, 5
    v_med3_u32 v78, v77, v78, v165
    v_med3_u32 v77, v76, v77, v165
    v_max_u32 v76, v76, v165
    v_lshl_or_b32 v166, v102, 16, 6
    v_med3_u32 v78, v77, v78, v166
    v_med3_u32 v77, v76, v77, v166
    v_max_u32 v76, v76, v166
    v_and_or_b32 v167, v102, s77, 7
    v_med3_u32 v78, v77, v78, v167
    v_med3_u32 v77, v76, v77, v167
    v_max_u32 v76, v76, v167
    v_lshl_or_b32 v168, v104, 16, 8
    v_med3_u32 v78, v77, v78, v168
    v_med3_u32 v77, v76, v77, v168
    v_max_u32 v76, v76, v168
    v_and_or_b32 v169, v104, s77, 9
    v_med3_u32 v78, v77, v78, v169
    v_med3_u32 v77, v76, v77, v169
    v_max_u32 v76, v76, v169
    v_lshl_or_b32 v170, v106, 16, 10
    v_med3_u32 v78, v77, v78, v170
    v_med3_u32 v77, v76, v77, v170
    v_max_u32 v76, v76, v170
    v_and_or_b32 v171, v106, s77, 11
    v_med3_u32 v78, v77, v78, v171
    v_med3_u32 v77, v76, v77, v171
    v_max_u32 v76, v76, v171
    v_lshl_or_b32 v172, v108, 16, 12
    v_med3_u32 v78, v77, v78, v172
    v_med3_u32 v77, v76, v77, v172
    v_max_u32 v76, v76, v172
    v_and_or_b32 v173, v108, s77, 13
    v_med3_u32 v78, v77, v78, v173
    v_med3_u32 v77, v76, v77, v173
    v_max_u32 v76, v76, v173
    v_lshl_or_b32 v174, v110, 16, 14
    v_med3_u32 v78, v77, v78, v174
    v_med3_u32 v77, v76, v77, v174
    v_max_u32 v76, v76, v174
    v_and_or_b32 v175, v110, s77, 15
    v_med3_u32 v78, v77, v78, v175
    v_med3_u32 v77, v76, v77, v175
    v_max_u32 v76, v76, v175
    v_lshl_or_b32 v176, v112, 16, 16
    v_med3_u32 v78, v77, v78, v176
    v_med3_u32 v77, v76, v77, v176
    v_max_u32 v76, v76, v176
    v_and_or_b32 v177, v112, s77, 17
    v_med3_u32 v78, v77, v78, v177
    v_med3_u32 v77, v76, v77, v177
    v_max_u32 v76, v76, v177
    v_lshl_or_b32 v178, v114, 16, 18
    v_med3_u32 v78, v77, v78, v178
    v_med3_u32 v77, v76, v77, v178
    v_max_u32 v76, v76, v178
    v_and_or_b32 v179, v114, s77, 19
    v_med3_u32 v78, v77, v78, v179
    v_med3_u32 v77, v76, v77, v179
    v_max_u32 v76, v76, v179
    v_lshl_or_b32 v180, v116, 16, 20
    v_med3_u32 v78, v77, v78, v180
    v_med3_u32 v77, v76, v77, v180
    v_max_u32 v76, v76, v180
    v_and_or_b32 v181, v116, s77, 21
    v_med3_u32 v78, v77, v78, v181
    v_med3_u32 v77, v76, v77, v181
    v_max_u32 v76, v76, v181
    v_lshl_or_b32 v182, v118, 16, 22
    v_med3_u32 v78, v77, v78, v182
    v_med3_u32 v77, v76, v77, v182
    v_max_u32 v76, v76, v182
    v_and_or_b32 v183, v118, s77, 23
    v_med3_u32 v78, v77, v78, v183
    v_med3_u32 v77, v76, v77, v183
    v_max_u32 v76, v76, v183
    v_lshl_or_b32 v184, v120, 16, 24
    v_med3_u32 v78, v77, v78, v184
    v_med3_u32 v77, v76, v77, v184
    v_max_u32 v76, v76, v184
    v_and_or_b32 v185, v120, s77, 25
    v_med3_u32 v78, v77, v78, v185
    v_med3_u32 v77, v76, v77, v185
    v_max_u32 v76, v76, v185
    v_lshl_or_b32 v186, v122, 16, 26
    v_med3_u32 v78, v77, v78, v186
    v_med3_u32 v77, v76, v77, v186
    v_max_u32 v76, v76, v186
    v_and_or_b32 v187, v122, s77, 27
    v_med3_u32 v78, v77, v78, v187
    v_med3_u32 v77, v76, v77, v187
    v_max_u32 v76, v76, v187
    v_lshl_or_b32 v188, v124, 16, 28
    v_med3_u32 v78, v77, v78, v188
    v_med3_u32 v77, v76, v77, v188
    v_max_u32 v76, v76, v188
    v_and_or_b32 v189, v124, s77, 29
    v_med3_u32 v78, v77, v78, v189
    v_med3_u32 v77, v76, v77, v189
    v_max_u32 v76, v76, v189
    v_lshl_or_b32 v190, v126, 16, 30
    v_med3_u32 v78, v77, v78, v190
    v_med3_u32 v77, v76, v77, v190
    v_max_u32 v76, v76, v190
    v_and_or_b32 v191, v126, s77, 31
    v_med3_u32 v78, v77, v78, v191
    v_med3_u32 v77, v76, v77, v191
    v_max_u32 v76, v76, v191
    v_or_b32 v76, v76, v80
    v_or_b32 v77, v77, v80
    v_or_b32 v78, v78, v80
    s_nop 0
    v_max_u32_dpp v82, v76, v76 quad_perm:[1,0,3,2] row_mask:0xf bank_mask:0xf
    s_nop 1
    v_max_u32_dpp v82, v82, v82 quad_perm:[2,3,0,1] row_mask:0xf bank_mask:0xf
    s_nop 1
    v_max_u32_dpp v82, v82, v82 row_half_mirror row_mask:0xf bank_mask:0xf
    s_nop 1
    v_max_u32_dpp v82, v82, v82 row_mirror row_mask:0xf bank_mask:0xf
    s_nop 1
    v_max_u32_dpp v82, v82, v82 row_bcast:15 row_mask:0xa bank_mask:0xf
    s_nop 1
    v_max_u32_dpp v82, v82, v82 row_bcast:31 row_mask:0xc bank_mask:0xf
    s_nop 0
    v_readlane_b32 s74, v82, 63
    s_nop 1
    v_cmp_eq_u32 vcc, s74, v76
    v_mov_b32 v83, s74
    s_nop 0
    v_cndmask_b32 v76, v76, v77, vcc
    v_cndmask_b32 v77, v77, v78, vcc
    v_cndmask_b32 v78, v78, v81, vcc
    v_max_u32_dpp v82, v76, v76 quad_perm:[1,0,3,2] row_mask:0xf bank_mask:0xf
    v_cndmask_b32_e64 v79, v79, v83, s[62:63]
    s_lshl_b64 s[62:63], s[62:63], 1
    v_max_u32_dpp v82, v82, v82 quad_perm:[2,3,0,1] row_mask:0xf bank_mask:0xf
    s_nop 1
    v_max_u32_dpp v82, v82, v82 row_half_mirror row_mask:0xf bank_mask:0xf
    s_nop 1
    v_max_u32_dpp v82, v82, v82 row_mirror row_mask:0xf bank_mask:0xf
    s_nop 1
    v_max_u32_dpp v82, v82, v82 row_bcast:15 row_mask:0xa bank_mask:0xf
    s_nop 1
    v_max_u32_dpp v82, v82, v82 row_bcast:31 row_mask:0xc bank_mask:0xf
    s_nop 0
    v_readlane_b32 s74, v82, 63
    s_nop 1
    v_cmp_eq_u32 vcc, s74, v76
    v_mov_b32 v83, s74
    s_nop 0
    v_cndmask_b32 v76, v76, v77, vcc
    v_cndmask_b32 v77, v77, v78, vcc
    v_cndmask_b32 v78, v78, v81, vcc
    v_max_u32_dpp v82, v76, v76 quad_perm:[1,0,3,2] row_mask:0xf bank_mask:0xf
    v_cndmask_b32_e64 v79, v79, v83, s[62:63]
    s_lshl_b64 s[62:63], s[62:63], 1
    v_max_u32_dpp v82, v82, v82 quad_perm:[2,3,0,1] row_mask:0xf bank_mask:0xf
    s_nop 1
    v_max_u32_dpp v82, v82, v82 row_half_mirror row_mask:0xf bank_mask:0xf
    s_nop 1
    v_max_u32_dpp v82, v82, v82 row_mirror row_mask:0xf bank_mask:0xf
    s_nop 1
    v_max_u32_dpp v82, v82, v82 row_bcast:15 row_mask:0xa bank_mask:0xf
    s_nop 1
    v_max_u32_dpp v82, v82, v82 row_bcast:31 row_mask:0xc bank_mask:0xf
    s_nop 0
    v_readlane_b32 s74, v82, 63
    s_nop 1
    v_cmp_eq_u32 vcc, s74, v76
    v_mov_b32 v83, s74
    s_nop 0
    v_cndmask_b32 v76, v76, v77, vcc
    v_cndmask_b32 v77, v77, v78, vcc
    v_cndmask_b32 v78, v78, v81, vcc
    v_max_u32_dpp v82, v76, v76 quad_perm:[1,0,3,2] row_mask:0xf bank_mask:0xf
    v_cndmask_b32_e64 v79, v79, v83, s[62:63]
    s_lshl_b64 s[62:63], s[62:63], 1
    v_max_u32_dpp v82, v82, v82 quad_perm:[2,3,0,1] row_mask:0xf bank_mask:0xf
    s_nop 1
    v_max_u32_dpp v82, v82, v82 row_half_mirror row_mask:0xf bank_mask:0xf
    s_nop 1
    v_max_u32_dpp v82, v82, v82 row_mirror row_mask:0xf bank_mask:0xf
    s_nop 1
    v_max_u32_dpp v82, v82, v82 row_bcast:15 row_mask:0xa bank_mask:0xf
    s_nop 1
    v_max_u32_dpp v82, v82, v82 row_bcast:31 row_mask:0xc bank_mask:0xf
    s_nop 0
    v_readlane_b32 s74, v82, 63
    s_nop 1
    v_cmp_eq_u32 vcc, s74, v76
    v_mov_b32 v83, s74
    s_nop 0
    v_cndmask_b32 v76, v76, v77, vcc
    v_cndmask_b32 v77, v77, v78, vcc
    v_cndmask_b32 v78, v78, v81, vcc
    v_max_u32_dpp v82, v76, v76 quad_perm:[1,0,3,2] row_mask:0xf bank_mask:0xf
    v_cndmask_b32_e64 v79, v79, v83, s[62:63]
    s_lshl_b64 s[62:63], s[62:63], 1
    v_max_u32_dpp v82, v82, v82 quad_perm:[2,3,0,1] row_mask:0xf bank_mask:0xf
    s_nop 1
    v_max_u32_dpp v82, v82, v82 row_half_mirror row_mask:0xf bank_mask:0xf
    s_nop 1
    v_max_u32_dpp v82, v82, v82 row_mirror row_mask:0xf bank_mask:0xf
    s_nop 1
    v_max_u32_dpp v82, v82, v82 row_bcast:15 row_mask:0xa bank_mask:0xf
    s_nop 1
    v_max_u32_dpp v82, v82, v82 row_bcast:31 row_mask:0xc bank_mask:0xf
    s_nop 0
    v_readlane_b32 s74, v82, 63
    s_nop 1
    v_cmp_eq_u32 vcc, s74, v76
    v_mov_b32 v83, s74
    s_nop 0
    v_cndmask_b32 v76, v76, v77, vcc
    v_cndmask_b32 v77, v77, v78, vcc
    v_cndmask_b32 v78, v78, v81, vcc
    v_max_u32_dpp v82, v76, v76 quad_perm:[1,0,3,2] row_mask:0xf bank_mask:0xf
    v_cndmask_b32_e64 v79, v79, v83, s[62:63]
    s_lshl_b64 s[62:63], s[62:63], 1
    v_max_u32_dpp v82, v82, v82 quad_perm:[2,3,0,1] row_mask:0xf bank_mask:0xf
    s_nop 1
    v_max_u32_dpp v82, v82, v82 row_half_mirror row_mask:0xf bank_mask:0xf
    s_nop 1
    v_max_u32_dpp v82, v82, v82 row_mirror row_mask:0xf bank_mask:0xf
    s_nop 1
    v_max_u32_dpp v82, v82, v82 row_bcast:15 row_mask:0xa bank_mask:0xf
    s_nop 1
    v_max_u32_dpp v82, v82, v82 row_bcast:31 row_mask:0xc bank_mask:0xf
    s_nop 0
    v_readlane_b32 s74, v82, 63
    s_nop 1
    v_cmp_eq_u32 vcc, s74, v76
    v_mov_b32 v83, s74
    s_nop 0
    v_cndmask_b32 v76, v76, v77, vcc
    v_cndmask_b32 v77, v77, v78, vcc
    v_cndmask_b32 v78, v78, v81, vcc
    v_max_u32_dpp v82, v76, v76 quad_perm:[1,0,3,2] row_mask:0xf bank_mask:0xf
    v_cndmask_b32_e64 v79, v79, v83, s[62:63]
    s_lshl_b64 s[62:63], s[62:63], 1
    v_max_u32_dpp v82, v82, v82 quad_perm:[2,3,0,1] row_mask:0xf bank_mask:0xf
    s_nop 1
    v_max_u32_dpp v82, v82, v82 row_half_mirror row_mask:0xf bank_mask:0xf
    s_nop 1
    v_max_u32_dpp v82, v82, v82 row_mirror row_mask:0xf bank_mask:0xf
    s_nop 1
    v_max_u32_dpp v82, v82, v82 row_bcast:15 row_mask:0xa bank_mask:0xf
    s_nop 1
    v_max_u32_dpp v82, v82, v82 row_bcast:31 row_mask:0xc bank_mask:0xf
    s_nop 0
    v_readlane_b32 s74, v82, 63
    s_nop 1
    v_cmp_eq_u32 vcc, s74, v76
    v_mov_b32 v83, s74
    s_nop 0
    v_cndmask_b32 v76, v76, v77, vcc
    v_cndmask_b32 v77, v77, v78, vcc
    v_cndmask_b32 v78, v78, v81, vcc
    v_max_u32_dpp v82, v76, v76 quad_perm:[1,0,3,2] row_mask:0xf bank_mask:0xf
    v_cndmask_b32_e64 v79, v79, v83, s[62:63]
    s_lshl_b64 s[62:63], s[62:63], 1
    v_max_u32_dpp v82, v82, v82 quad_perm:[2,3,0,1] row_mask:0xf bank_mask:0xf
    s_nop 1
    v_max_u32_dpp v82, v82, v82 row_half_mirror row_mask:0xf bank_mask:0xf
    s_nop 1
    v_max_u32_dpp v82, v82, v82 row_mirror row_mask:0xf bank_mask:0xf
    s_nop 1
    v_max_u32_dpp v82, v82, v82 row_bcast:15 row_mask:0xa bank_mask:0xf
    s_nop 1
    v_max_u32_dpp v82, v82, v82 row_bcast:31 row_mask:0xc bank_mask:0xf
    s_nop 0
    v_readlane_b32 s74, v82, 63
    s_nop 1
    v_cmp_eq_u32 vcc, s74, v76
    v_mov_b32 v83, s74
    s_nop 0
    s_branch L_tfin
L_tslow:
    v_mov_b32 v13, 0
    v_max3_u32 v76, v160, v161, v162
    v_med3_u32 v77, v160, v161, v162
    v_min3_u32 v78, v160, v161, v162
    v_med3_u32 v78, v77, v78, v163
    v_med3_u32 v77, v76, v77, v163
    v_max_u32 v76, v76, v163
    v_med3_u32 v78, v77, v78, v164
    v_med3_u32 v77, v76, v77, v164
    v_max_u32 v76, v76, v164
    v_med3_u32 v78, v77, v78, v165
    v_med3_u32 v77, v76, v77, v165
    v_max_u32 v76, v76, v165
    v_med3_u32 v78, v77, v78, v166
    v_med3_u32 v77, v76, v77, v166
    v_max_u32 v76, v76, v166
    v_med3_u32 v78, v77, v78, v167
    v_med3_u32 v77, v76, v77, v167
    v_max_u32 v76, v76, v167
    v_med3_u32 v78, v77, v78, v168
    v_med3_u32 v77, v76, v77, v168
    v_max_u32 v76, v76, v168
    v_med3_u32 v78, v77, v78, v169
    v_med3_u32 v77, v76, v77, v169
    v_max_u32 v76, v76, v169
    v_med3_u32 v78, v77, v78, v170
    v_med3_u32 v77, v76, v77, v170
    v_max_u32 v76, v76, v170
    v_med3_u32 v78, v77, v78, v171
    v_med3_u32 v77, v76, v77, v171
    v_max_u32 v76, v76, v171
    v_med3_u32 v78, v77, v78, v172
    v_med3_u32 v77, v76, v77, v172
    v_max_u32 v76, v76, v172
    v_med3_u32 v78, v77, v78, v173
    v_med3_u32 v77, v76, v77, v173
    v_max_u32 v76, v76, v173
    v_med3_u32 v78, v77, v78, v174
    v_med3_u32 v77, v76, v77, v174
    v_max_u32 v76, v76, v174
    v_med3_u32 v78, v77, v78, v175
    v_med3_u32 v77, v76, v77, v175
    v_max_u32 v76, v76, v175
    v_med3_u32 v78, v77, v78, v176
    v_med3_u32 v77, v76, v77, v176
    v_max_u32 v76, v76, v176
    v_med3_u32 v78, v77, v78, v177
    v_med3_u32 v77, v76, v77, v177
    v_max_u32 v76, v76, v177
    v_med3_u32 v78, v77, v78, v178
    v_med3_u32 v77, v76, v77, v178
    v_max_u32 v76, v76, v178
    v_med3_u32 v78, v77, v78, v179
    v_med3_u32 v77, v76, v77, v179
    v_max_u32 v76, v76, v179
    v_med3_u32 v78, v77, v78, v180
    v_med3_u32 v77, v76, v77, v180
    v_max_u32 v76, v76, v180
    v_med3_u32 v78, v77, v78, v181
    v_med3_u32 v77, v76, v77, v181
    v_max_u32 v76, v76, v181
    v_med3_u32 v78, v77, v78, v182
    v_med3_u32 v77, v76, v77, v182
    v_max_u32 v76, v76, v182
    v_med3_u32 v78, v77, v78, v183
    v_med3_u32 v77, v76, v77, v183
    v_max_u32 v76, v76, v183
    v_med3_u32 v78, v77, v78, v184
    v_med3_u32 v77, v76, v77, v184
    v_max_u32 v76, v76, v184
    v_med3_u32 v78, v77, v78, v185
    v_med3_u32 v77, v76, v77, v185
    v_max_u32 v76, v76, v185
    v_med3_u32 v78, v77, v78, v186
    v_med3_u32 v77, v76, v77, v186
    v_max_u32 v76, v76, v186
    v_med3_u32 v78, v77, v78, v187
    v_med3_u32 v77, v76, v77, v187
    v_max_u32 v76, v76, v187
    v_med3_u32 v78, v77, v78, v188
    v_med3_u32 v77, v76, v77, v188
    v_max_u32 v76, v76, v188
    v_med3_u32 v78, v77, v78, v189
    v_med3_u32 v77, v76, v77, v189
    v_max_u32 v76, v76, v189
    v_med3_u32 v78, v77, v78, v190
    v_med3_u32 v77, v76, v77, v190
    v_max_u32 v76, v76, v190
    v_med3_u32 v78, v77, v78, v191
    v_med3_u32 v77, v76, v77, v191
    v_max_u32 v76, v76, v191
    v_or_b32 v76, v76, v80
    v_or_b32 v77, v77, v80
    v_or_b32 v78, v78, v80
    s_mov_b32 m0, 0
L_rnd:
    s_nop 4
    v_max_u32_dpp v4, v76, v76 quad_perm:[1,0,3,2] row_mask:0xf bank_mask:0xf
    s_nop 1
    v_max_u32_dpp v4, v4, v4 quad_perm:[2,3,0,1] row_mask:0xf bank_mask:0xf
    s_nop 1
    v_max_u32_dpp v4, v4, v4 row_half_mirror row_mask:0xf bank_mask:0xf
    s_nop 1
    v_max_u32_dpp v4, v4, v4 row_mirror row_mask:0xf bank_mask:0xf
    s_nop 1
    v_readlane_b32 s74, v4, 0
    v_readlane_b32 s60, v4, 16
    v_readlane_b32 s61, v4, 32
    v_readlane_b32 s62, v4, 48
    s_max_u32 s74, s74, s60
    s_max_u32 s61, s61, s62
    s_max_u32 s74, s74, s61
    s_lshr_b32 s75, s74, 5
    v_writelane_b32 v79, s74, m0
    s_lshl_b64 exec, 1, s75
    v_cmp_eq_u32 vcc, 2, v13
    v_mov_b32 v76, v77
    v_mov_b32 v77, v78
    v_add_u32 v13, 1, v13
    s_cbranch_vccnz L_rebuild
L_rbd:
    s_mov_b64 exec, -1
    s_add_u32 m0, m0, 1
    s_cmp_lt_u32 m0, 8
    s_cbranch_scc1 L_rnd
    v_and_b32 v4, 7, v1
    v_lshlrev_b32 v4, 2, v4
    ds_bpermute_b32 v79, v4, v79
    s_waitcnt lgkmcnt(0)
    s_branch L_tdone
L_rebuild:
    v_mov_b32 v13, 0
    v_mov_b32 v76, 0
    v_mov_b32 v77, 0
    v_mov_b32 v78, 0
    s_and_b32 s60, s74, 0xffff001f
    v_cmp_gt_u32 vcc, s60, v160
    s_nop 1
    v_cndmask_b32 v4, 0, v160, vcc
    v_med3_u32 v78, v77, v78, v4
    v_med3_u32 v77, v76, v77, v4
    v_max_u32 v76, v76, v4
    v_cmp_gt_u32 vcc, s60, v161
    s_nop 1
    v_cndmask_b32 v4, 0, v161, vcc
    v_med3_u32 v78, v77, v78, v4
    v_med3_u32 v77, v76, v77, v4
    v_max_u32 v76, v76, v4
    v_cmp_gt_u32 vcc, s60, v162
    s_nop 1
    v_cndmask_b32 v4, 0, v162, vcc
    v_med3_u32 v78, v77, v78, v4
    v_med3_u32 v77, v76, v77, v4
    v_max_u32 v76, v76, v4
    v_cmp_gt_u32 vcc, s60, v163
    s_nop 1
    v_cndmask_b32 v4, 0, v163, vcc
    v_med3_u32 v78, v77, v78, v4
    v_med3_u32 v77, v76, v77, v4
    v_max_u32 v76, v76, v4
    v_cmp_gt_u32 vcc, s60, v164
    s_nop 1
    v_cndmask_b32 v4, 0, v164, vcc
    v_med3_u32 v78, v77, v78, v4
    v_med3_u32 v77, v76, v77, v4
    v_max_u32 v76, v76, v4
    v_cmp_gt_u32 vcc, s60, v165
    s_nop 1
    v_cndmask_b32 v4, 0, v165, vcc
    v_med3_u32 v78, v77, v78, v4
    v_med3_u32 v77, v76, v77, v4
    v_max_u32 v76, v76, v4
    v_cmp_gt_u32 vcc, s60, v166
    s_nop 1
    v_cndmask_b32 v4, 0, v166, vcc
    v_med3_u32 v78, v77, v78, v4
    v_med3_u32 v77, v76, v77, v4
    v_max_u32 v76, v76, v4
    v_cmp_gt_u32 vcc, s60, v167
    s_nop 1
    v_cndmask_b32 v4, 0, v167, vcc
    v_med3_u32 v78, v77, v78, v4
    v_med3_u32 v77, v76, v77, v4
    v_max_u32 v76, v76, v4
    v_cmp_gt_u32 vcc, s60, v168
    s_nop 1
    v_cndmask_b32 v4, 0, v168, vcc
    v_med3_u32 v78, v77, v78, v4
    v_med3_u32 v77, v76, v77, v4
    v_max_u32 v76, v76, v4
    v_cmp_gt_u32 vcc, s60, v169
    s_nop 1
    v_cndmask_b32 v4, 0, v169, vcc
    v_med3_u32 v78, v77, v78, v4
    v_med3_u32 v77, v76, v77, v4
    v_max_u32 v76, v76, v4
    v_cmp_gt_u32 vcc, s60, v170
    s_nop 1
    v_cndmask_b32 v4, 0, v170, vcc
    v_med3_u32 v78, v77, v78, v4
    v_med3_u32 v77, v76, v77, v4
    v_max_u32 v76, v76, v4
    v_cmp_gt_u32 vcc, s60, v171
    s_nop 1
    v_cndmask_b32 v4, 0, v171, vcc
    v_med3_u32 v78, v77, v78, v4
    v_med3_u32 v77, v76, v77, v4
    v_max_u32 v76, v76, v4
    v_cmp_gt_u32 vcc, s60, v172
    s_nop 1
    v_cndmask_b32 v4, 0, v172, vcc
    v_med3_u32 v78, v77, v78, v4
    v_med3_u32 v77, v76, v77, v4
    v_max_u32 v76, v76, v4
    v_cmp_gt_u32 vcc, s60, v173
    s_nop 1
    v_cndmask_b32 v4, 0, v173, vcc
    v_med3_u32 v78, v77, v78, v4
    v_med3_u32 v77, v76, v77, v4
    v_max_u32 v76, v76, v4
    v_cmp_gt_u32 vcc, s60, v174
    s_nop 1
    v_cndmask_b32 v4, 0, v174, vcc
    v_med3_u32 v78, v77, v78, v4
    v_med3_u32 v77, v76, v77, v4
    v_max_u32 v76, v76, v4
    v_cmp_gt_u32 vcc, s60, v175
    s_nop 1
    v_cndmask_b32 v4, 0, v175, vcc
    v_med3_u32 v78, v77, v78, v4
    v_med3_u32 v77, v76, v77, v4
    v_max_u32 v76, v76, v4
    v_cmp_gt_u32 vcc, s60, v176
    s_nop 1
    v_cndmask_b32 v4, 0, v176, vcc
    v_med3_u32 v78, v77, v78, v4
    v_med3_u32 v77, v76, v77, v4
    v_max_u32 v76, v76, v4
    v_cmp_gt_u32 vcc, s60, v177
    s_nop 1
    v_cndmask_b32 v4, 0, v177, vcc
    v_med3_u32 v78, v77, v78, v4
    v_med3_u32 v77, v76, v77, v4
    v_max_u32 v76, v76, v4
    v_cmp_gt_u32 vcc, s60, v178
    s_nop 1
    v_cndmask_b32 v4, 0, v178, vcc
    v_med3_u32 v78, v77, v78, v4
    v_med3_u32 v77, v76, v77, v4
    v_max_u32 v76, v76, v4
    v_cmp_gt_u32 vcc, s60, v179
    s_nop 1
    v_cndmask_b32 v4, 0, v179, vcc
    v_med3_u32 v78, v77, v78, v4
    v_med3_u32 v77, v76, v77, v4
    v_max_u32 v76, v76, v4
    v_cmp_gt_u32 vcc, s60, v180
    s_nop 1
    v_cndmask_b32 v4, 0, v180, vcc
    v_med3_u32 v78, v77, v78, v4
    v_med3_u32 v77, v76, v77, v4
    v_max_u32 v76, v76, v4
    v_cmp_gt_u32 vcc, s60, v181
    s_nop 1
    v_cndmask_b32 v4, 0, v181, vcc
    v_med3_u32 v78, v77, v78, v4
    v_med3_u32 v77, v76, v77, v4
    v_max_u32 v76, v76, v4
    v_cmp_gt_u32 vcc, s60, v182
    s_nop 1
    v_cndmask_b32 v4, 0, v182, vcc
    v_med3_u32 v78, v77, v78, v4
    v_med3_u32 v77, v76, v77, v4
    v_max_u32 v76, v76, v4
    v_cmp_gt_u32 vcc, s60, v183
    s_nop 1
    v_cndmask_b32 v4, 0, v183, vcc
    v_med3_u32 v78, v77, v78, v4
    v_med3_u32 v77, v76, v77, v4
    v_max_u32 v76, v76, v4
    v_cmp_gt_u32 vcc, s60, v184
    s_nop 1
    v_cndmask_b32 v4, 0, v184, vcc
    v_med3_u32 v78, v77, v78, v4
    v_med3_u32 v77, v76, v77, v4
    v_max_u32 v76, v76, v4
    v_cmp_gt_u32 vcc, s60, v185
    s_nop 1
    v_cndmask_b32 v4, 0, v185, vcc
    v_med3_u32 v78, v77, v78, v4
    v_med3_u32 v77, v76, v77, v4
    v_max_u32 v76, v76, v4
    v_cmp_gt_u32 vcc, s60, v186
    s_nop 1
    v_cndmask_b32 v4, 0, v186, vcc
    v_med3_u32 v78, v77, v78, v4
    v_med3_u32 v77, v76, v77, v4
    v_max_u32 v76, v76, v4
    v_cmp_gt_u32 vcc, s60, v187
    s_nop 1
    v_cndmask_b32 v4, 0, v187, vcc
    v_med3_u32 v78, v77, v78, v4
    v_med3_u32 v77, v76, v77, v4
    v_max_u32 v76, v76, v4
    v_cmp_gt_u32 vcc, s60, v188
    s_nop 1
    v_cndmask_b32 v4, 0, v188, vcc
    v_med3_u32 v78, v77, v78, v4
    v_med3_u32 v77, v76, v77, v4
    v_max_u32 v76, v76, v4
    v_cmp_gt_u32 vcc, s60, v189
    s_nop 1
    v_cndmask_b32 v4, 0, v189, vcc
    v_med3_u32 v78, v77, v78, v4
    v_med3_u32 v77, v76, v77, v4
    v_max_u32 v76, v76, v4
    v_cmp_gt_u32 vcc, s60, v190
    s_nop 1
    v_cndmask_b32 v4, 0, v190, vcc
    v_med3_u32 v78, v77, v78, v4
    v_med3_u32 v77, v76, v77, v4
    v_max_u32 v76, v76, v4
    v_cmp_gt_u32 vcc, s60, v191
    s_nop 1
    v_cndmask_b32 v4, 0, v191, vcc
    v_med3_u32 v78, v77, v78, v4
    v_med3_u32 v77, v76, v77, v4
    v_max_u32 v76, v76, v4
    v_or_b32 v76, v76, v80
    v_or_b32 v77, v77, v80
    v_or_b32 v78, v78, v80
    s_branch L_rbd
L_bump:
    s_sub_u32 s68, s65, 2654435768
    v_mov_b32 v4, s68
    s_mov_b64 exec, 1
    buffer_store_dword v4, v81, s[40:43], 0 offen offset:0 sc1
    s_mov_b64 exec, -1
    s_branch L_nobump
L_sg6:
    s_mov_b32 s76, 0
L_sg6b:
    buffer_load_dwordx2 v[28:29], v6, s[40:43], s55 offen sc1
    s_add_u32 s76, s76, 1
    s_waitcnt vmcnt(0)
    v_cmp_ne_u32 vcc, s65, v29
    v_lshlrev_b32 v30, 16, v28
    s_cbranch_vccz L_sg6d
    s_cmp_lt_u32 s76, 65536
    s_cbranch_scc1 L_sg6b
    s_branch L_sg6d
L_pgr:
    s_add_u32 s76, s76, 1
    s_cmp_lt_u32 s76, 65536
    s_cbranch_scc0 L_pgd
    buffer_load_dwordx4 v[160:163], v68, s[40:43], s62 offen offset:0 sc1
    buffer_load_dwordx4 v[164:167], v68, s[40:43], s62 offen offset:1024 sc1
    buffer_load_dwordx4 v[168:171], v68, s[40:43], s63 offen offset:0 sc1
    buffer_load_dwordx4 v[172:175], v68, s[40:43], s63 offen offset:1024 sc1
    buffer_load_dwordx4 v[176:179], v68, s[40:43], s53 offen offset:0 sc1
    buffer_load_dwordx4 v[180:183], v68, s[40:43], s53 offen offset:1024 sc1
    s_branch L_pgs
L_ys0r:
    s_add_u32 s76, s76, 1
    s_cmp_lt_u32 s76, 65536
    s_cbranch_scc0 L_ys0d
    buffer_load_dwordx4 v[128:131], v68, s[40:43], s52 offen offset:0 sc1
    buffer_load_dwordx4 v[132:135], v68, s[40:43], s52 offen offset:1024 sc1
    buffer_load_dwordx4 v[136:139], v68, s[40:43], s52 offen offset:2048 sc1
    buffer_load_dwordx4 v[140:143], v68, s[40:43], s52 offen offset:3072 sc1
    buffer_load_dwordx4 v[144:147], v68, s[40:43], s53 offen offset:0 sc1
    buffer_load_dwordx4 v[148:151], v68, s[40:43], s53 offen offset:1024 sc1
    buffer_load_dwordx4 v[152:155], v68, s[40:43], s53 offen offset:2048 sc1
    buffer_load_dwordx4 v[156:159], v68, s[40:43], s53 offen offset:3072 sc1
    buffer_load_dwordx4 v[160:163], v68, s[40:43], s54 offen offset:0 sc1
    buffer_load_dwordx4 v[164:167], v68, s[40:43], s54 offen offset:1024 sc1
    buffer_load_dwordx4 v[168:171], v68, s[40:43], s54 offen offset:2048 sc1
    buffer_load_dwordx4 v[172:175], v68, s[40:43], s54 offen offset:3072 sc1
    buffer_load_dwordx4 v[176:179], v68, s[40:43], s55 offen offset:0 sc1
    buffer_load_dwordx4 v[180:183], v68, s[40:43], s55 offen offset:1024 sc1
    s_waitcnt vmcnt(0)
    s_branch L_ys0
L_ys2r:
    s_add_u32 s76, s76, 1
    s_cmp_lt_u32 s76, 65536
    s_cbranch_scc0 L_ys2d
    buffer_load_dwordx4 v[128:131], v68, s[40:43], s52 offen offset:0 sc1
    buffer_load_dwordx4 v[132:135], v68, s[40:43], s52 offen offset:1024 sc1
    buffer_load_dwordx4 v[136:139], v68, s[40:43], s52 offen offset:2048 sc1
    buffer_load_dwordx4 v[140:143], v68, s[40:43], s52 offen offset:3072 sc1
    buffer_load_dwordx4 v[144:147], v68, s[40:43], s53 offen offset:0 sc1
    buffer_load_dwordx4 v[148:151], v68, s[40:43], s53 offen offset:1024 sc1
    buffer_load_dwordx4 v[152:155], v68, s[40:43], s53 offen offset:2048 sc1
    buffer_load_dwordx4 v[156:159], v68, s[40:43], s53 offen offset:3072 sc1
    buffer_load_dwordx4 v[160:163], v68, s[40:43], s54 offen offset:0 sc1
    buffer_load_dwordx4 v[164:167], v68, s[40:43], s54 offen offset:1024 sc1
    buffer_load_dwordx4 v[168:171], v68, s[40:43], s54 offen offset:2048 sc1
    buffer_load_dwordx4 v[172:175], v68, s[40:43], s54 offen offset:3072 sc1
    buffer_load_dwordx4 v[176:179], v68, s[40:43], s55 offen offset:0 sc1
    buffer_load_dwordx4 v[180:183], v68, s[40:43], s55 offen offset:1024 sc1
    s_waitcnt vmcnt(0)
    s_branch L_ys2
L_ys3r:
    s_add_u32 s76, s76, 1
    s_cmp_lt_u32 s76, 65536
    s_cbranch_scc0 L_ys3d
    buffer_load_dwordx4 v[184:187], v68, s[40:43], s61 offen offset:0 sc1
    buffer_load_dwordx4 v[188:191], v68, s[40:43], s61 offen offset:1024 sc1
    buffer_load_dwordx4 v[192:195], v68, s[40:43], s61 offen offset:2048 sc1
    buffer_load_dwordx4 v[196:199], v68, s[40:43], s61 offen offset:3072 sc1
    buffer_load_dwordx4 v[200:203], v68, s[40:43], s62 offen offset:0 sc1
    buffer_load_dwordx4 v[204:207], v68, s[40:43], s62 offen offset:1024 sc1
    buffer_load_dwordx4 v[208:211], v68, s[40:43], s62 offen offset:2048 sc1
    buffer_load_dwordx4 v[212:215], v68, s[40:43], s62 offen offset:3072 sc1
    buffer_load_dwordx4 v[216:219], v68, s[40:43], s63 offen offset:0 sc1
    buffer_load_dwordx4 v[220:223], v68, s[40:43], s63 offen offset:1024 sc1
    buffer_load_dwordx4 v[224:227], v68, s[40:43], s63 offen offset:2048 sc1
    buffer_load_dwordx4 v[228:231], v68, s[40:43], s63 offen offset:3072 sc1
    buffer_load_dwordx4 v[232:235], v68, s[40:43], s45 offen offset:0 sc1
    buffer_load_dwordx4 v[236:239], v68, s[40:43], s45 offen offset:1024 sc1
    s_waitcnt vmcnt(0)
    s_branch L_ys3
    s_endpgm
L_aux7:
    v_lshrrev_b32 v26, 3, v1
    v_and_b32 v25, 7, v1
    v_lshlrev_b32 v25, 2, v25
    v_lshl_add_u32 v26, v26, 7, v25
    s_lshl_b32 s72, s27, 5
    s_add_u32 s72, s72, s26
    s_lshl_b32 s72, s72, 8
    s_add_u32 s72, s72, 1048576
    s_min_u32 s73, s26, 4
    s_lshl_b32 s73, s73, 1
    s_bfm_b32 s73, s73, 0
    s_mul_i32 s73, s73, 0x101
    s_not_b32 s74, s73
    s_setprio 3
    s_mov_b32 s67, 0
W_46:
    ds_read_b32 v4, v2 offset:72
    s_waitcnt lgkmcnt(0)
    v_readfirstlane_b32 s68, v4
    s_cmp_ge_u32 s68, 1
    s_cbranch_scc1 D_47
    s_add_u32 s67, s67, 1
    s_cmp_lt_u32 s67, 4194304
    s_cbranch_scc1 W_46
D_47:
    s_mov_b32 s67, 0
L_kvp:
    s_mov_b32 exec_hi, 0
    s_mov_b32 exec_lo, s73
    v_mov_b32 v27, 0
    buffer_atomic_or v27, v26, s[40:43], s72 offen sc0 sc1
    s_mov_b64 exec, -1
    s_waitcnt vmcnt(0)
    v_cmp_eq_u32 vcc, s65, v27
    s_add_u32 s67, s67, 1
    s_cmp_lt_u32 s67, 65536
    s_cselect_b32 s75, vcc_lo, -1
    s_or_b32 s75, s75, s74
    v_mov_b32 v4, s75
    ds_write_b32 v2, v4 offset:40
    s_cmp_lg_u32 s75, -1
    s_cbranch_scc1 L_kvp
    s_setprio 0
    v_and_b32 v204, 31, v1
    v_bfe_u32 v200, v1, 1, 3
    v_lshlrev_b32 v200, 4, v200
    v_lshl_add_u32 v200, v204, 7, v200
    v_lshrrev_b32 v205, 5, v1
    v_lshl_add_u32 v200, v205, 3, v200
    s_and_b32 s61, s26, 3
    s_lshl_b32 s61, s61, 13
    s_lshl_b32 s62, 2, 5
    v_xor_b32 v200, s62, v200
    v_add_u32 v200, s61, v200
    v_lshl_add_u32 v204, v204, 2, v2
    s_lshl_b32 s62, 2, 10
    v_lshl_add_u32 v205, v1, 4, v2
    v_add_u32 v205, s62, v205
    s_mov_b32 s60, 0xbfb8aa3b
    ds_read_b32 v212, v204 offset:1792
    ds_read_b32 v214, v204 offset:1536
    ds_read_b64 v[216:217], v200 offset:0
    v_xor_b32 v201, 16, v200
    ds_read_b64 v[218:219], v201 offset:0
    v_xor_b32 v201, 32, v200
    ds_read_b64 v[220:221], v201 offset:0
    v_xor_b32 v201, 48, v200
    ds_read_b64 v[222:223], v201 offset:0
    s_waitcnt lgkmcnt(4)
    v_mul_f32_e64 v214, -v214, v212
    s_waitcnt lgkmcnt(2)
    v_lshlrev_b32 v232, 16, v216
    v_and_b32 v233, 0xffff0000, v216
    v_lshlrev_b32 v234, 16, v217
    v_and_b32 v235, 0xffff0000, v217
    v_lshlrev_b32 v236, 16, v218
    v_and_b32 v237, 0xffff0000, v218
    v_lshlrev_b32 v238, 16, v219
    v_and_b32 v239, 0xffff0000, v219
    v_pk_fma_f32 v[232:233], v[232:233], v[212:213], v[214:215] op_sel_hi:[1,0,0]
    v_pk_fma_f32 v[234:235], v[234:235], v[212:213], v[214:215] op_sel_hi:[1,0,0]
    v_pk_fma_f32 v[236:237], v[236:237], v[212:213], v[214:215] op_sel_hi:[1,0,0]
    v_pk_fma_f32 v[238:239], v[238:239], v[212:213], v[214:215] op_sel_hi:[1,0,0]
    v_pk_mul_f32 v[240:241], v[232:233], s[60:61] op_sel_hi:[1,0]
    v_pk_mul_f32 v[242:243], v[234:235], s[60:61] op_sel_hi:[1,0]
    v_pk_mul_f32 v[244:245], v[236:237], s[60:61] op_sel_hi:[1,0]
    v_pk_mul_f32 v[246:247], v[238:239], s[60:61] op_sel_hi:[1,0]
    v_exp_f32 v240, v240
    v_exp_f32 v241, v241
    v_exp_f32 v242, v242
    v_exp_f32 v243, v243
    v_exp_f32 v244, v244
    v_exp_f32 v245, v245
    v_exp_f32 v246, v246
    v_exp_f32 v247, v247
    v_pk_add_f32 v[240:241], v[240:241], 1.0 op_sel_hi:[1,0]
    v_pk_add_f32 v[242:243], v[242:243], 1.0 op_sel_hi:[1,0]
    v_pk_add_f32 v[244:245], v[244:245], 1.0 op_sel_hi:[1,0]
    v_pk_add_f32 v[246:247], v[246:247], 1.0 op_sel_hi:[1,0]
    v_rcp_f32 v240, v240
    v_rcp_f32 v241, v241
    v_rcp_f32 v242, v242
    v_rcp_f32 v243, v243
    v_rcp_f32 v244, v244
    v_rcp_f32 v245, v245
    v_rcp_f32 v246, v246
    v_rcp_f32 v247, v247
    v_pk_mul_f32 v[240:241], v[240:241], v[232:233]
    v_pk_mul_f32 v[242:243], v[242:243], v[234:235]
    v_pk_mul_f32 v[244:245], v[244:245], v[236:237]
    v_pk_mul_f32 v[246:247], v[246:247], v[238:239]
    v_cvt_pk_bf16_f32 v216, v240, v241
    v_cvt_pk_bf16_f32 v217, v242, v243
    v_cvt_pk_bf16_f32 v218, v244, v245
    v_cvt_pk_bf16_f32 v219, v246, v247
    ds_write_b128 v205, v[216:219] offset:8192
    s_waitcnt lgkmcnt(1)
    v_lshlrev_b32 v232, 16, v220
    v_and_b32 v233, 0xffff0000, v220
    v_lshlrev_b32 v234, 16, v221
    v_and_b32 v235, 0xffff0000, v221
    v_lshlrev_b32 v236, 16, v222
    v_and_b32 v237, 0xffff0000, v222
    v_lshlrev_b32 v238, 16, v223
    v_and_b32 v239, 0xffff0000, v223
    v_pk_fma_f32 v[232:233], v[232:233], v[212:213], v[214:215] op_sel_hi:[1,0,0]
    v_pk_fma_f32 v[234:235], v[234:235], v[212:213], v[214:215] op_sel_hi:[1,0,0]
    v_pk_fma_f32 v[236:237], v[236:237], v[212:213], v[214:215] op_sel_hi:[1,0,0]
    v_pk_fma_f32 v[238:239], v[238:239], v[212:213], v[214:215] op_sel_hi:[1,0,0]
    v_pk_mul_f32 v[240:241], v[232:233], s[60:61] op_sel_hi:[1,0]
    v_pk_mul_f32 v[242:243], v[234:235], s[60:61] op_sel_hi:[1,0]
    v_pk_mul_f32 v[244:245], v[236:237], s[60:61] op_sel_hi:[1,0]
    v_pk_mul_f32 v[246:247], v[238:239], s[60:61] op_sel_hi:[1,0]
    v_exp_f32 v240, v240
    v_exp_f32 v241, v241
    v_exp_f32 v242, v242
    v_exp_f32 v243, v243
    v_exp_f32 v244, v244
    v_exp_f32 v245, v245
    v_exp_f32 v246, v246
    v_exp_f32 v247, v247
    v_pk_add_f32 v[240:241], v[240:241], 1.0 op_sel_hi:[1,0]
    v_pk_add_f32 v[242:243], v[242:243], 1.0 op_sel_hi:[1,0]
    v_pk_add_f32 v[244:245], v[244:245], 1.0 op_sel_hi:[1,0]
    v_pk_add_f32 v[246:247], v[246:247], 1.0 op_sel_hi:[1,0]
    v_rcp_f32 v240, v240
    v_rcp_f32 v241, v241
    v_rcp_f32 v242, v242
    v_rcp_f32 v243, v243
    v_rcp_f32 v244, v244
    v_rcp_f32 v245, v245
    v_rcp_f32 v246, v246
    v_rcp_f32 v247, v247
    v_pk_mul_f32 v[240:241], v[240:241], v[232:233]
    v_pk_mul_f32 v[242:243], v[242:243], v[234:235]
    v_pk_mul_f32 v[244:245], v[244:245], v[236:237]
    v_pk_mul_f32 v[246:247], v[246:247], v[238:239]
    v_cvt_pk_bf16_f32 v220, v240, v241
    v_cvt_pk_bf16_f32 v221, v242, v243
    v_cvt_pk_bf16_f32 v222, v244, v245
    v_cvt_pk_bf16_f32 v223, v246, v247
    ds_write_b128 v205, v[220:223] offset:9216
    s_mov_b64 exec, 1
    v_mov_b32 v200, 2
    ds_add_u32 v2, v200 offset:68
    s_mov_b64 exec, -1
    s_setprio 3
    s_mov_b32 s67, 0
W_48:
    ds_read_b32 v4, v2 offset:76
    s_waitcnt lgkmcnt(0)
    v_readfirstlane_b32 s68, v4
    s_cmp_ge_u32 s68, 1
    s_cbranch_scc1 D_49
    s_add_u32 s67, s67, 1
    s_cmp_lt_u32 s67, 4194304
    s_cbranch_scc1 W_48
D_49:
    s_lshl_b32 s72, s26, 3
    s_add_u32 s72, s72, s27
    s_lshl_b32 s72, s72, 10
    s_add_u32 s72, s72, 1310720
    s_mov_b32 s67, 0
    s_mov_b64 s[74:75], 0
    s_mov_b32 s76, -1
    s_mov_b32 s77, 0
    v_mov_b32 v27, 0
    v_mov_b32 v28, 0
L_ofp:
    s_andn2_b64 exec, s[76:77], s[74:75]
    v_mov_b32 v27, 0
    buffer_atomic_or v27, v26, s[40:43], s72 offen sc0 sc1
    s_waitcnt vmcnt(0)
    s_mov_b64 exec, -1
    v_cmp_eq_u32 vcc, s65, v27
    s_mov_b64 exec, 1
    s_add_u32 s67, s67, 1
    s_or_b64 s[74:75], s[74:75], vcc
    s_cmp_lt_u32 s67, 65536
    s_cselect_b64 s[74:75], s[74:75], -1
    v_mov_b32 v4, s74
    v_mov_b32 v5, s75
    ds_write_b64 v2, v[4:5] offset:32
    s_cmp_eq_u32 s74, -1
    s_cselect_b32 s77, -1, s77
    s_cmp_lg_u64 s[74:75], -1
    s_cbranch_scc1 L_ofp
    s_mov_b64 exec, -1
    s_waitcnt lgkmcnt(0)
    s_endpgm
L_end:
    s_endpgm
.section .rodata,"a"
.p2align 6
.amdhsa_kernel recurrent_scan__sliding_block__moe_arch_mod__prompt_kernel
  .amdhsa_next_free_vgpr 256
  .amdhsa_next_free_sgpr 102
  .amdhsa_accum_offset 256
  .amdhsa_group_segment_fixed_size 0
  .amdhsa_kernarg_size 88
  .amdhsa_user_sgpr_count 2
  .amdhsa_user_sgpr_kernarg_segment_ptr 1
  .amdhsa_system_sgpr_workgroup_id_x 1
.end_amdhsa_kernel
```
